```python
import torch

def _softmax(x, axis=-1):
    return torch.softmax(x, dim=axis)
def _gelu(x):
    return torch.nn.functional.gelu(x, approximate="tanh")
def _silu(x):
    return torch.nn.functional.silu(x)
def _sigmoid(x):
    return torch.sigmoid(x)
def _layernorm(x, axis=-1, eps=1e-5):
    m = x.mean(dim=axis, keepdim=True)
    v = x.var(dim=axis, keepdim=True, unbiased=False)
    return (x - m) / torch.sqrt(v + eps)
def _scatter_add(tgt, idx, src, axis=0):
    return tgt.clone().index_add_(axis, idx, src)
def _segment_sum(src, seg, n):
    out = torch.zeros((n,) + src.shape[1:], dtype=src.dtype)
    return out.index_add_(0, seg, src)
def _pad(x, pw):
    flat = tuple(v for pair in reversed(pw) for v in pair)
    return torch.nn.functional.pad(x, flat)

kernel_name = 'gated_mix__compressed_kv_cla__moe_arch_mod__prompt'

def setup_inputs():

    _w = (lambda a: (lambda t: t.to(torch.bfloat16) if t.is_floating_point() else t)(torch.as_tensor(a)))
    def _A_setup():
        B, H, Sq, Sk, D, M = 1, 32, 2048, 2048, 128, 512
        Dc = 4 * D
        return {
            "x": _w((lambda *s: torch.randn(*s, dtype=torch.bfloat16) * 0.05)(B, Sq, M)),
            "c_kv": _w((lambda *s: torch.randn(*s, dtype=torch.bfloat16) * 0.8)(B, Sk, Dc)),
            "w_q": _w((lambda *s: torch.randn(*s, dtype=torch.bfloat16) * 6.4)(M, H, D) * (M ** -0.5)),
            "w_uk": _w((lambda *s: torch.randn(*s, dtype=torch.bfloat16) * 6.4)(Dc, H, D) * (Dc ** -0.5)),
            "w_uv": _w((lambda *s: torch.randn(*s, dtype=torch.bfloat16) * 0.8)(Dc, H, D) * (Dc ** -0.5)),
            "w_o": _w((lambda *s: torch.randn(*s, dtype=torch.bfloat16) * 0.8)(H, D, M) * ((H * D) ** -0.5)),
        }
    _A_in = _A_setup()

    def _B_setup():
        B, S, D, F, C = 1, 2048, 512, 1792, 2
        return {
            "x": _w((lambda *s: torch.randn(*s, dtype=torch.bfloat16) * 0.05)(B, S, D)),
            "w_r": _w((lambda *s: torch.randn(*s, dtype=torch.bfloat16) * 3.2)(D)),
            "w_gate": _w((lambda *s: torch.randn(*s, dtype=torch.bfloat16) * 0.2)(D, F)),
            "w_up": _w((lambda *s: torch.randn(*s, dtype=torch.bfloat16) * 0.2)(D, F)),
            "w_down": _w((lambda *s: torch.randn(*s, dtype=torch.bfloat16) * 0.2)(F, D)),
        }
    _B_in = _B_setup()

    return {
        "A_x": _A_in["x"],
        "A_c_kv": _A_in["c_kv"],
        "A_w_q": _A_in["w_q"],
        "A_w_uk": _A_in["w_uk"],
        "A_w_uv": _A_in["w_uv"],
        "A_w_o": _A_in["w_o"],
        "B_x": _B_in["x"],
        "B_w_r": _B_in["w_r"],
        "B_w_gate": _B_in["w_gate"],
        "B_w_up": _B_in["w_up"],
        "B_w_down": _B_in["w_down"],
        "gate_w": _w((lambda *s: torch.randn(*s, dtype=torch.bfloat16) * 0.05)(512) * 16.0),
    }

def reference(A_x, A_c_kv, A_w_q, A_w_uk, A_w_uv, A_w_o, B_x, B_w_r, B_w_gate, B_w_up, B_w_down, gate_w):
    def _A_ref(x, c_kv, w_q, w_uk, w_uv, w_o):
        B, Sq, M = x.shape[0], x.shape[1], x.shape[2]
        Sk = c_kv.shape[1]
        H, D = w_q.shape[1], w_q.shape[2]
        q = torch.einsum("bqm,mhd->bhqd", x, w_q)
        k = torch.einsum("bkc,chd->bhkd", c_kv, w_uk)
        v = torch.einsum("bkc,chd->bhkd", c_kv, w_uv)
        scores = torch.einsum("bhqd,bhkd->bhqk", q, k) * (D ** -0.5)
        off = Sk - Sq
        qi = torch.arange(Sq)[:, None]
        kj = torch.arange(Sk)[None, :]
        cmask = kj <= (qi + off)
        scores = torch.where(cmask[None, None], scores, -1e9)
        p = _softmax(scores, axis=-1)
        ctx = torch.einsum("bhqk,bhkd->bhqd", p, v)
        return torch.einsum("bhqd,hdm->bqm", ctx, w_o)

    def _B_ref(x, w_r, w_gate, w_up, w_down):
        B, S, D = x.shape
        C = 2
        r = x @ w_r
        idx = torch.argsort(-r, axis=-1)[:, :C]
        idx_e = (lambda x, n, axis: torch.repeat_interleave(x, n, dim=axis))(idx.reshape(B, C, 1), D, axis=2)
        x_sel = (lambda x, i, axis: torch.take_along_dim(x, i, dim=axis))(x, idx_e, axis=1)
        g = _silu(x_sel @ w_gate)
        u = x_sel @ w_up
        y = (g * u) @ w_down
        r_sel = _sigmoid((lambda x, i, axis: torch.take_along_dim(x, i, dim=axis))(r, idx, axis=1))
        y = y * r_sel.reshape(B, C, 1)
        b_off = (torch.arange(B) * S).reshape(B, 1)
        flat_idx = (idx + b_off).reshape(B * C)
        zero = (x * 0.0).reshape(B * S, D)
        upd = _scatter_add(zero, flat_idx, y.reshape(B * C, D), axis=0)
        return x + upd.reshape(B, S, D)

    x = A_x
    g = _sigmoid((x * gate_w).sum(-1, keepdims=True))
    a = _A_ref(x, A_c_kv, A_w_q, A_w_uk, A_w_uv, A_w_o)
    b = _B_ref(x, B_w_r, B_w_gate, B_w_up, B_w_down)
    return g * a + (1 - g) * b
```

```asm
; @launch kernel=gated_mix__compressed_kv_cla__moe_arch_mod__prompt_kernel grid=(256,1,1) block=(256,1,1) lds=163840
.amdgcn_target "amdgcn-amd-amdhsa--gfx950"
.text
.globl gated_mix__compressed_kv_cla__moe_arch_mod__prompt_kernel
.p2align 8
.type gated_mix__compressed_kv_cla__moe_arch_mod__prompt_kernel,@function
gated_mix__compressed_kv_cla__moe_arch_mod__prompt_kernel:
    s_cmp_ge_u32 s2, 256
    s_cbranch_scc1 gated_mix__compressed_kv_cla__moe_arch_mod__prompt_kernel_end
    s_load_dwordx8 s[64:71], s[0:1], 0
    s_load_dwordx2 s[72:73], s[0:1], 32
    s_load_dwordx4 s[76:79], s[0:1], 104
    s_load_dwordx2 s[80:81], s[0:1], 56
    s_load_dwordx2 s[82:83], s[0:1], 88
    v_lshrrev_b32 v26, 6, v0
    v_and_b32 v1, 63, v0
    v_readfirstlane_b32 s3, v26
    s_and_b32 s46, s2, 7
    s_lshr_b32 s47, s2, 3
    s_lshl_b32 s4, s46, 2
    s_and_b32 s48, s47, 3
    s_add_u32 s4, s4, s48
    s_lshr_b32 s5, s47, 2
    v_lshrrev_b32 v27, 4, v1
    v_lshrrev_b32 v28, 3, v1
    v_lshlrev_b32 v19, 13, v28
    v_and_b32 v20, 1, v27
    v_lshlrev_b32 v20, 1, v20
    v_and_b32 v23, 7, v1
    v_xor_b32 v21, v23, v20
    v_lshl_add_u32 v22, v21, 4, v19
    v_add_u32 v8, 0, v22
    v_xor_b32 v22, 4, v21
    v_lshl_add_u32 v22, v22, 4, v19
    v_add_u32 v9, 64512, v22
    v_lshl_add_u32 v22, v21, 4, v19
    v_add_u32 v10, 129024, v22
    v_xor_b32 v22, 4, v21
    v_lshl_add_u32 v22, v22, 4, v19
    v_add_u32 v11, 193536, v22
    v_lshlrev_b32 v19, 10, v28
    v_xor_b32 v21, v23, v27
    v_lshl_add_u32 v22, v21, 4, v19
    v_add_u32 v4, 0, v22
    v_xor_b32 v22, 4, v21
    v_lshl_add_u32 v22, v22, 4, v19
    v_add_u32 v5, 7168, v22
    v_lshl_add_u32 v22, v21, 4, v19
    v_add_u32 v6, 14336, v22
    v_xor_b32 v22, 4, v21
    v_lshl_add_u32 v22, v22, 4, v19
    v_add_u32 v7, 21504, v22
    s_lshl_b32 s40, s3, 12
    s_lshl_b32 s46, s4, 8
    s_lshl_b32 s47, s3, 18
    s_add_u32 s41, s46, s47
    s_lshr_b32 s47, s3, 1
    s_lshl_b32 s47, s47, 18
    s_add_u32 s46, s46, s47
    s_and_b32 s47, s3, 1
    s_lshl_b32 s47, s47, 7
    s_add_u32 s43, s46, s47
    s_and_b32 s46, s2, 7
    s_lshl_b32 s45, s46, 7
    s_lshl_b32 s46, s46, 19
    s_add_u32 s41, s41, s46
    s_add_u32 s43, s43, s46
    s_mul_i32 s36, s3, 24576
    s_add_u32 s36, s36, 65536
    s_lshl_b32 s32, s5, 18
    s_lshl_b32 s46, s3, 16
    s_add_u32 s32, s32, s46
    s_add_u32 s33, s32, 32768
    s_waitcnt lgkmcnt(0)
    s_mov_b32 s16, s70
    s_and_b32 s17, s71, 0xffff
    s_mov_b32 s18, 0x400000
    s_mov_b32 s19, 0x00020000
    s_mov_b32 s8, s66
    s_and_b32 s9, s67, 0xffff
    s_mov_b32 s10, 0x200000
    s_mov_b32 s11, 0x00020000
    s_add_u32 m0, s40, 0
    s_add_u32 s46, s43, 0
    s_and_b32 s46, s46, 0x3fffff
    buffer_load_dwordx4 v8, s[16:19], s46 offen offset:0 lds
    buffer_load_dwordx4 v9, s[16:19], s46 offen offset:1024 lds
    buffer_load_dwordx4 v10, s[16:19], s46 offen offset:2048 lds
    buffer_load_dwordx4 v11, s[16:19], s46 offen offset:3072 lds
    s_add_u32 s37, s45, 0
    s_and_b32 s37, s37, 0x3ff
    s_add_u32 m0, s36, 0
    s_add_u32 s46, s32, s37
    buffer_load_dwordx4 v4, s[8:11], s46 offen offset:0 lds
    buffer_load_dwordx4 v5, s[8:11], s46 offen offset:1024 lds
    buffer_load_dwordx4 v6, s[8:11], s46 offen offset:2048 lds
    buffer_load_dwordx4 v7, s[8:11], s46 offen offset:3072 lds
    s_add_u32 m0, s36, 4096
    s_add_u32 s46, s33, s37
    buffer_load_dwordx4 v4, s[8:11], s46 offen offset:0 lds
    buffer_load_dwordx4 v5, s[8:11], s46 offen offset:1024 lds
    buffer_load_dwordx4 v6, s[8:11], s46 offen offset:2048 lds
    buffer_load_dwordx4 v7, s[8:11], s46 offen offset:3072 lds
    s_lshl_b32 s6, s5, 2
    s_add_u32 s6, s6, s3
    s_sub_u32 s7, 63, s6
    s_lshl_b32 s34, s6, 15
    s_lshl_b32 s35, s7, 15
    s_lshl_b32 s46, s4, 6
    s_lshl_b32 s47, s5, 3
    s_add_u32 s46, s46, s47
    s_lshl_b32 s47, s3, 1
    s_add_u32 s46, s46, s47
    s_lshl_b32 s42, s46, 14
    s_mov_b32 s44, 0x3e0293ee
    v_bfe_u32 v18, v1, 2, 2
    v_lshl_add_u32 v19, v27, 3, v18
    v_lshlrev_b32 v19, 7, v19
    v_and_b32 v21, 3, v1
    v_lshl_add_u32 v19, v21, 3, v19
    v_lshrrev_b32 v18, 1, v18
    v_add_u32 v18, v18, v20
    v_xor_b32 v21, 0, v18
    v_lshl_add_u32 v12, v21, 5, v19
    v_xor_b32 v21, 1, v18
    v_lshl_add_u32 v13, v21, 5, v19
    v_xor_b32 v21, 2, v18
    v_lshl_add_u32 v14, v21, 5, v19
    v_xor_b32 v21, 3, v18
    v_lshl_add_u32 v15, v21, 5, v19
    v_and_b32 v21, 15, v1
    v_lshlrev_b32 v21, 7, v21
    v_add_u32 v21, s36, v21
    v_bfe_u32 v23, v1, 1, 3
    v_xor_b32 v23, v23, v27
    v_lshl_add_u32 v16, v23, 4, v21
    v_xor_b32 v23, 4, v23
    v_lshl_add_u32 v17, v23, 4, v21
    v_lshlrev_b32 v2, 4, v1
    s_mov_b32 s20, s72
    s_and_b32 s21, s73, 0xffff
    s_mov_b32 s22, 0x400000
    s_mov_b32 s23, 0x00020000
    s_mov_b32 s12, s64
    s_and_b32 s13, s65, 0xffff
    s_mov_b32 s14, 0x200000
    s_mov_b32 s15, 0x00020000
    s_mov_b32 s24, s68
    s_and_b32 s25, s69, 0xffff
    s_mov_b32 s26, 0x400000
    s_mov_b32 s27, 0x00020000
    s_mov_b32 s28, s78
    s_and_b32 s29, s79, 0xffff
    s_mov_b32 s30, 0xa000000
    s_mov_b32 s31, 0x00020000
    s_mov_b32 s60, s76
    s_and_b32 s61, s77, 0xffff
    s_mov_b32 s62, 0x100
    s_mov_b32 s63, 0x00020000
    s_lshl_b32 s50, s3, 2
    s_or_b32 s50, s2, s50
    s_cmp_gt_u32 s50, 3
    s_cbranch_scc1 init_skip
    v_mov_b32 v96, 0
    v_mov_b32 v97, 0
    v_mov_b32 v98, 0
    v_mov_b32 v99, 0
    s_mul_i32 s48, s2, 14336
    s_add_u32 s48, s48, 0x3400000
    buffer_store_dwordx4 v[96:99], v2, s[28:31], s48 offen offset:0 sc1
    buffer_store_dwordx4 v[96:99], v2, s[28:31], s48 offen offset:1024 sc1
    buffer_store_dwordx4 v[96:99], v2, s[28:31], s48 offen offset:2048 sc1
    buffer_store_dwordx4 v[96:99], v2, s[28:31], s48 offen offset:3072 sc1
    s_add_u32 s48, s48, 0x1000
    buffer_store_dwordx4 v[96:99], v2, s[28:31], s48 offen offset:0 sc1
    buffer_store_dwordx4 v[96:99], v2, s[28:31], s48 offen offset:1024 sc1
    buffer_store_dwordx4 v[96:99], v2, s[28:31], s48 offen offset:2048 sc1
    buffer_store_dwordx4 v[96:99], v2, s[28:31], s48 offen offset:3072 sc1
    s_add_u32 s48, s48, 0x1000
    buffer_store_dwordx4 v[96:99], v2, s[28:31], s48 offen offset:0 sc1
    buffer_store_dwordx4 v[96:99], v2, s[28:31], s48 offen offset:1024 sc1
    buffer_store_dwordx4 v[96:99], v2, s[28:31], s48 offen offset:2048 sc1
    buffer_store_dwordx4 v[96:99], v2, s[28:31], s48 offen offset:3072 sc1
    s_add_u32 s48, s48, 0x1000
    buffer_store_dwordx4 v[96:99], v2, s[28:31], s48 offen offset:0 sc1
    buffer_store_dwordx4 v[96:99], v2, s[28:31], s48 offen offset:1024 sc1
init_skip:
    s_add_u32 m0, s40, 16384
    s_add_u32 s46, s43, 0
    s_and_b32 s46, s46, 0x3fffff
    buffer_load_dwordx4 v8, s[20:23], s46 offen offset:0 lds
    buffer_load_dwordx4 v9, s[20:23], s46 offen offset:1024 lds
    buffer_load_dwordx4 v10, s[20:23], s46 offen offset:2048 lds
    buffer_load_dwordx4 v11, s[20:23], s46 offen offset:3072 lds
    s_add_u32 s37, s45, 128
    s_and_b32 s37, s37, 0x3ff
    s_add_u32 m0, s36, 8192
    s_add_u32 s46, s32, s37
    buffer_load_dwordx4 v4, s[8:11], s46 offen offset:0 lds
    buffer_load_dwordx4 v5, s[8:11], s46 offen offset:1024 lds
    buffer_load_dwordx4 v6, s[8:11], s46 offen offset:2048 lds
    buffer_load_dwordx4 v7, s[8:11], s46 offen offset:3072 lds
    s_add_u32 m0, s36, 12288
    s_add_u32 s46, s33, s37
    buffer_load_dwordx4 v4, s[8:11], s46 offen offset:0 lds
    buffer_load_dwordx4 v5, s[8:11], s46 offen offset:1024 lds
    buffer_load_dwordx4 v6, s[8:11], s46 offen offset:2048 lds
    buffer_load_dwordx4 v7, s[8:11], s46 offen offset:3072 lds
    v_bfe_u32 v30, v1, 2, 2
    s_lshl_b32 s48, s6, 2
    v_add_u32 v30, s48, v30
    v_lshlrev_b32 v30, 13, v30
    v_and_b32 v31, 3, v1
    v_lshl_add_u32 v30, v31, 6, v30
    s_lshl_b32 s48, s4, 8
    v_add_u32 v30, s48, v30
    s_waitcnt vmcnt(12)
    s_lshl_b32 s50, s3, 2
    s_or_b32 s50, s2, s50
    s_cmp_gt_u32 s50, 3
    s_cbranch_scc1 init_skip2
    v_mov_b32 v100, 1
    s_lshl_b32 s50, s2, 2
    s_mov_b64 exec, 1
    buffer_store_dword v100, off, s[60:63], s50 sc1
    s_mov_b64 exec, -1
init_skip2:
    s_barrier
    ds_read_b128 a[0:3], v16 offset:0
    ds_read_b128 a[4:7], v16 offset:2048
    ds_read_b128 a[8:11], v16 offset:4096
    ds_read_b128 a[12:15], v16 offset:6144
    ds_read_b128 a[16:19], v17 offset:0
    ds_read_b128 a[20:23], v17 offset:2048
    ds_read_b128 a[24:27], v17 offset:4096
    ds_read_b128 a[28:31], v17 offset:6144
    ds_read_b64_tr_b16 v[64:65], v12 offset:0
    ds_read_b64_tr_b16 v[66:67], v12 offset:512
    ds_read_b64_tr_b16 v[68:69], v13 offset:0
    ds_read_b64_tr_b16 v[70:71], v13 offset:512
    ds_read_b64_tr_b16 v[72:73], v14 offset:0
    ds_read_b64_tr_b16 v[74:75], v14 offset:512
    ds_read_b64_tr_b16 v[76:77], v15 offset:0
    ds_read_b64_tr_b16 v[78:79], v15 offset:512
    s_waitcnt lgkmcnt(0)
    v_mfma_f32_16x16x32_bf16 v[128:131], v[64:67], a[0:3], 0
    s_add_u32 m0, s40, 32768
    ds_read_b64_tr_b16 v[80:81], v12 offset:4096
    ds_read_b64_tr_b16 v[82:83], v12 offset:4608
    v_mfma_f32_16x16x32_bf16 v[144:147], v[64:67], a[4:7], 0
    s_add_u32 s46, s43, 524288
    ds_read_b64_tr_b16 v[84:85], v13 offset:4096
    ds_read_b64_tr_b16 v[86:87], v13 offset:4608
    v_mfma_f32_16x16x32_bf16 v[160:163], v[64:67], a[8:11], 0
    s_and_b32 s46, s46, 0x3fffff
    ds_read_b64_tr_b16 v[88:89], v14 offset:4096
    ds_read_b64_tr_b16 v[90:91], v14 offset:4608
    v_mfma_f32_16x16x32_bf16 v[176:179], v[64:67], a[12:15], 0
    ds_read_b64_tr_b16 v[92:93], v15 offset:4096
    ds_read_b64_tr_b16 v[94:95], v15 offset:4608
    v_mfma_f32_16x16x32_bf16 v[132:135], v[68:71], a[0:3], 0
    buffer_load_dwordx4 v8, s[16:19], s46 offen offset:0 lds
    v_mfma_f32_16x16x32_bf16 v[148:151], v[68:71], a[4:7], 0
    v_mfma_f32_16x16x32_bf16 v[164:167], v[68:71], a[8:11], 0
    buffer_load_dwordx4 v9, s[16:19], s46 offen offset:1024 lds
    v_mfma_f32_16x16x32_bf16 v[180:183], v[68:71], a[12:15], 0
    v_mfma_f32_16x16x32_bf16 v[136:139], v[72:75], a[0:3], 0
    buffer_load_dwordx4 v10, s[16:19], s46 offen offset:2048 lds
    v_mfma_f32_16x16x32_bf16 v[152:155], v[72:75], a[4:7], 0
    v_mfma_f32_16x16x32_bf16 v[168:171], v[72:75], a[8:11], 0
    buffer_load_dwordx4 v11, s[16:19], s46 offen offset:3072 lds
    v_mfma_f32_16x16x32_bf16 v[184:187], v[72:75], a[12:15], 0
    s_add_u32 m0, s40, 49152
    v_mfma_f32_16x16x32_bf16 v[140:143], v[76:79], a[0:3], 0
    s_add_u32 s46, s43, 524288
    v_mfma_f32_16x16x32_bf16 v[156:159], v[76:79], a[4:7], 0
    s_and_b32 s46, s46, 0x3fffff
    buffer_load_dwordx4 v8, s[20:23], s46 offen offset:0 lds
    v_mfma_f32_16x16x32_bf16 v[172:175], v[76:79], a[8:11], 0
    v_mfma_f32_16x16x32_bf16 v[188:191], v[76:79], a[12:15], 0
    s_waitcnt lgkmcnt(0)
    buffer_load_dwordx4 v9, s[20:23], s46 offen offset:1024 lds
    v_mfma_f32_16x16x32_bf16 v[192:195], v[80:83], a[0:3], 0
    ds_read_b64_tr_b16 v[64:65], v12 offset:8192
    ds_read_b64_tr_b16 v[66:67], v12 offset:8704
    v_mfma_f32_16x16x32_bf16 v[208:211], v[80:83], a[4:7], 0
    ds_read_b64_tr_b16 v[68:69], v13 offset:8192
    ds_read_b64_tr_b16 v[70:71], v13 offset:8704
    v_mfma_f32_16x16x32_bf16 v[224:227], v[80:83], a[8:11], 0
    ds_read_b64_tr_b16 v[72:73], v14 offset:8192
    ds_read_b64_tr_b16 v[74:75], v14 offset:8704
    v_mfma_f32_16x16x32_bf16 v[240:243], v[80:83], a[12:15], 0
    ds_read_b64_tr_b16 v[76:77], v15 offset:8192
    ds_read_b64_tr_b16 v[78:79], v15 offset:8704
    v_mfma_f32_16x16x32_bf16 v[196:199], v[84:87], a[0:3], 0
    buffer_load_dwordx4 v10, s[20:23], s46 offen offset:2048 lds
    v_mfma_f32_16x16x32_bf16 v[212:215], v[84:87], a[4:7], 0
    v_mfma_f32_16x16x32_bf16 v[228:231], v[84:87], a[8:11], 0
    buffer_load_dwordx4 v11, s[20:23], s46 offen offset:3072 lds
    v_mfma_f32_16x16x32_bf16 v[244:247], v[84:87], a[12:15], 0
    s_lshl_b32 s39, s45, 12
    v_mfma_f32_16x16x32_bf16 v[200:203], v[88:91], a[0:3], 0
    s_add_u32 s39, s39, 0x100000
    v_mfma_f32_16x16x32_bf16 v[216:219], v[88:91], a[4:7], 0
    s_and_b32 s39, s39, 0x300000
    buffer_load_dword v31, v30, s[16:19], s39 offen
    v_mfma_f32_16x16x32_bf16 v[232:235], v[88:91], a[8:11], 0
    v_mfma_f32_16x16x32_bf16 v[248:251], v[88:91], a[12:15], 0
    v_mfma_f32_16x16x32_bf16 v[204:207], v[92:95], a[0:3], 0
    v_mfma_f32_16x16x32_bf16 v[220:223], v[92:95], a[4:7], 0
    v_mfma_f32_16x16x32_bf16 v[236:239], v[92:95], a[8:11], 0
    v_mfma_f32_16x16x32_bf16 v[252:255], v[92:95], a[12:15], 0
    s_waitcnt lgkmcnt(0)
    v_mfma_f32_16x16x32_bf16 v[128:131], v[64:67], a[16:19], v[128:131]
    s_add_u32 s37, s45, 256
    ds_read_b64_tr_b16 v[80:81], v12 offset:12288
    ds_read_b64_tr_b16 v[82:83], v12 offset:12800
    v_mfma_f32_16x16x32_bf16 v[144:147], v[64:67], a[20:23], v[144:147]
    s_and_b32 s37, s37, 0x3ff
    ds_read_b64_tr_b16 v[84:85], v13 offset:12288
    ds_read_b64_tr_b16 v[86:87], v13 offset:12800
    v_mfma_f32_16x16x32_bf16 v[160:163], v[64:67], a[24:27], v[160:163]
    s_add_u32 m0, s36, 16384
    ds_read_b64_tr_b16 v[88:89], v14 offset:12288
    ds_read_b64_tr_b16 v[90:91], v14 offset:12800
    v_mfma_f32_16x16x32_bf16 v[176:179], v[64:67], a[28:31], v[176:179]
    s_add_u32 s46, s32, s37
    ds_read_b64_tr_b16 v[92:93], v15 offset:12288
    ds_read_b64_tr_b16 v[94:95], v15 offset:12800
    v_mfma_f32_16x16x32_bf16 v[132:135], v[68:71], a[16:19], v[132:135]
    buffer_load_dwordx4 v4, s[8:11], s46 offen offset:0 lds
    v_mfma_f32_16x16x32_bf16 v[148:151], v[68:71], a[20:23], v[148:151]
    v_mfma_f32_16x16x32_bf16 v[164:167], v[68:71], a[24:27], v[164:167]
    buffer_load_dwordx4 v5, s[8:11], s46 offen offset:1024 lds
    v_mfma_f32_16x16x32_bf16 v[180:183], v[68:71], a[28:31], v[180:183]
    v_mfma_f32_16x16x32_bf16 v[136:139], v[72:75], a[16:19], v[136:139]
    buffer_load_dwordx4 v6, s[8:11], s46 offen offset:2048 lds
    v_mfma_f32_16x16x32_bf16 v[152:155], v[72:75], a[20:23], v[152:155]
    v_mfma_f32_16x16x32_bf16 v[168:171], v[72:75], a[24:27], v[168:171]
    buffer_load_dwordx4 v7, s[8:11], s46 offen offset:3072 lds
    v_mfma_f32_16x16x32_bf16 v[184:187], v[72:75], a[28:31], v[184:187]
    s_add_u32 m0, s36, 20480
    v_mfma_f32_16x16x32_bf16 v[140:143], v[76:79], a[16:19], v[140:143]
    s_add_u32 s46, s33, s37
    buffer_load_dwordx4 v4, s[8:11], s46 offen offset:0 lds
    v_mfma_f32_16x16x32_bf16 v[156:159], v[76:79], a[20:23], v[156:159]
    v_mfma_f32_16x16x32_bf16 v[172:175], v[76:79], a[24:27], v[172:175]
    buffer_load_dwordx4 v5, s[8:11], s46 offen offset:1024 lds
    v_mfma_f32_16x16x32_bf16 v[188:191], v[76:79], a[28:31], v[188:191]
    s_waitcnt lgkmcnt(0)
    v_mfma_f32_16x16x32_bf16 v[192:195], v[80:83], a[16:19], v[192:195]
    s_waitcnt vmcnt(23)
    v_mfma_f32_16x16x32_bf16 v[208:211], v[80:83], a[20:23], v[208:211]
    s_barrier
    ds_read_b64_tr_b16 v[64:65], v12 offset:16384
    ds_read_b64_tr_b16 v[66:67], v12 offset:16896
    v_mfma_f32_16x16x32_bf16 v[224:227], v[80:83], a[24:27], v[224:227]
    ds_read_b64_tr_b16 v[68:69], v13 offset:16384
    ds_read_b64_tr_b16 v[70:71], v13 offset:16896
    v_mfma_f32_16x16x32_bf16 v[240:243], v[80:83], a[28:31], v[240:243]
    ds_read_b64_tr_b16 v[72:73], v14 offset:16384
    ds_read_b64_tr_b16 v[74:75], v14 offset:16896
    v_mfma_f32_16x16x32_bf16 v[196:199], v[84:87], a[16:19], v[196:199]
    ds_read_b64_tr_b16 v[76:77], v15 offset:16384
    ds_read_b64_tr_b16 v[78:79], v15 offset:16896
    v_mfma_f32_16x16x32_bf16 v[212:215], v[84:87], a[20:23], v[212:215]
    buffer_load_dwordx4 v6, s[8:11], s46 offen offset:2048 lds
    v_mfma_f32_16x16x32_bf16 v[228:231], v[84:87], a[24:27], v[228:231]
    v_mfma_f32_16x16x32_bf16 v[244:247], v[84:87], a[28:31], v[244:247]
    buffer_load_dwordx4 v7, s[8:11], s46 offen offset:3072 lds
    v_mfma_f32_16x16x32_bf16 v[200:203], v[88:91], a[16:19], v[200:203]
    s_add_u32 m0, s40, 0
    v_mfma_f32_16x16x32_bf16 v[216:219], v[88:91], a[20:23], v[216:219]
    s_add_u32 s46, s43, 1048576
    v_mfma_f32_16x16x32_bf16 v[232:235], v[88:91], a[24:27], v[232:235]
    s_and_b32 s46, s46, 0x3fffff
    buffer_load_dwordx4 v8, s[16:19], s46 offen offset:0 lds
    v_mfma_f32_16x16x32_bf16 v[248:251], v[88:91], a[28:31], v[248:251]
    v_mfma_f32_16x16x32_bf16 v[204:207], v[92:95], a[16:19], v[204:207]
    buffer_load_dwordx4 v9, s[16:19], s46 offen offset:1024 lds
    v_mfma_f32_16x16x32_bf16 v[220:223], v[92:95], a[20:23], v[220:223]
    v_mfma_f32_16x16x32_bf16 v[236:239], v[92:95], a[24:27], v[236:239]
    buffer_load_dwordx4 v10, s[16:19], s46 offen offset:2048 lds
    v_mfma_f32_16x16x32_bf16 v[252:255], v[92:95], a[28:31], v[252:255]
    s_waitcnt lgkmcnt(0)
    v_mfma_f32_16x16x32_bf16 a[128:131], a[0:3], v[64:67], 0
    ds_read_b64_tr_b16 v[80:81], v12 offset:20480
    ds_read_b64_tr_b16 v[82:83], v12 offset:20992
    v_mfma_f32_16x16x32_bf16 a[132:135], a[4:7], v[64:67], 0
    ds_read_b64_tr_b16 v[84:85], v13 offset:20480
    ds_read_b64_tr_b16 v[86:87], v13 offset:20992
    v_mfma_f32_16x16x32_bf16 a[160:163], a[8:11], v[64:67], 0
    ds_read_b64_tr_b16 v[88:89], v14 offset:20480
    ds_read_b64_tr_b16 v[90:91], v14 offset:20992
    v_mfma_f32_16x16x32_bf16 a[164:167], a[12:15], v[64:67], 0
    ds_read_b64_tr_b16 v[92:93], v15 offset:20480
    ds_read_b64_tr_b16 v[94:95], v15 offset:20992
    v_mfma_f32_16x16x32_bf16 a[136:139], a[0:3], v[68:71], 0
    buffer_load_dwordx4 v11, s[16:19], s46 offen offset:3072 lds
    v_mfma_f32_16x16x32_bf16 a[140:143], a[4:7], v[68:71], 0
    s_lshl_b32 s39, s45, 12
    v_mfma_f32_16x16x32_bf16 a[168:171], a[8:11], v[68:71], 0
    s_add_u32 s39, s39, 0x100000
    v_mfma_f32_16x16x32_bf16 a[172:175], a[12:15], v[68:71], 0
    s_and_b32 s39, s39, 0x300000
    buffer_load_dword v31, v30, s[20:23], s39 offen
    v_mfma_f32_16x16x32_bf16 a[144:147], a[0:3], v[72:75], 0
    v_mfma_f32_16x16x32_bf16 a[148:151], a[4:7], v[72:75], 0
    v_mfma_f32_16x16x32_bf16 a[176:179], a[8:11], v[72:75], 0
    v_mfma_f32_16x16x32_bf16 a[180:183], a[12:15], v[72:75], 0
    v_mfma_f32_16x16x32_bf16 a[152:155], a[0:3], v[76:79], 0
    v_mfma_f32_16x16x32_bf16 a[156:159], a[4:7], v[76:79], 0
    v_mfma_f32_16x16x32_bf16 a[184:187], a[8:11], v[76:79], 0
    v_mfma_f32_16x16x32_bf16 a[188:191], a[12:15], v[76:79], 0
    s_waitcnt lgkmcnt(0)
    v_mfma_f32_16x16x32_bf16 a[192:195], a[0:3], v[80:83], 0
    s_lshl_b32 s39, s45, 12
    ds_read_b64_tr_b16 v[64:65], v12 offset:24576
    ds_read_b64_tr_b16 v[66:67], v12 offset:25088
    v_mfma_f32_16x16x32_bf16 a[196:199], a[4:7], v[80:83], 0
    s_add_u32 s39, s39, 0x200000
    ds_read_b64_tr_b16 v[68:69], v13 offset:24576
    ds_read_b64_tr_b16 v[70:71], v13 offset:25088
    v_mfma_f32_16x16x32_bf16 a[224:227], a[8:11], v[80:83], 0
    s_and_b32 s39, s39, 0x300000
    ds_read_b64_tr_b16 v[72:73], v14 offset:24576
    ds_read_b64_tr_b16 v[74:75], v14 offset:25088
    v_mfma_f32_16x16x32_bf16 a[228:231], a[12:15], v[80:83], 0
    ds_read_b64_tr_b16 v[76:77], v15 offset:24576
    ds_read_b64_tr_b16 v[78:79], v15 offset:25088
    v_mfma_f32_16x16x32_bf16 a[200:203], a[0:3], v[84:87], 0
    buffer_load_dword v31, v30, s[16:19], s39 offen
    v_mfma_f32_16x16x32_bf16 a[204:207], a[4:7], v[84:87], 0
    v_mfma_f32_16x16x32_bf16 a[232:235], a[8:11], v[84:87], 0
    v_mfma_f32_16x16x32_bf16 a[236:239], a[12:15], v[84:87], 0
    v_mfma_f32_16x16x32_bf16 a[208:211], a[0:3], v[88:91], 0
    v_mfma_f32_16x16x32_bf16 a[212:215], a[4:7], v[88:91], 0
    v_mfma_f32_16x16x32_bf16 a[240:243], a[8:11], v[88:91], 0
    v_mfma_f32_16x16x32_bf16 a[244:247], a[12:15], v[88:91], 0
    v_mfma_f32_16x16x32_bf16 a[216:219], a[0:3], v[92:95], 0
    v_mfma_f32_16x16x32_bf16 a[220:223], a[4:7], v[92:95], 0
    v_mfma_f32_16x16x32_bf16 a[248:251], a[8:11], v[92:95], 0
    v_mfma_f32_16x16x32_bf16 a[252:255], a[12:15], v[92:95], 0
    s_waitcnt lgkmcnt(0)
    v_mfma_f32_16x16x32_bf16 a[128:131], a[16:19], v[64:67], a[128:131]
    s_waitcnt vmcnt(23)
    ds_read_b64_tr_b16 v[80:81], v12 offset:28672
    ds_read_b64_tr_b16 v[82:83], v12 offset:29184
    v_mfma_f32_16x16x32_bf16 a[132:135], a[20:23], v[64:67], a[132:135]
    s_add_u32 s37, s45, 384
    ds_read_b64_tr_b16 v[84:85], v13 offset:28672
    ds_read_b64_tr_b16 v[86:87], v13 offset:29184
    v_mfma_f32_16x16x32_bf16 a[160:163], a[24:27], v[64:67], a[160:163]
    s_and_b32 s37, s37, 0x3ff
    ds_read_b64_tr_b16 v[88:89], v14 offset:28672
    ds_read_b64_tr_b16 v[90:91], v14 offset:29184
    v_mfma_f32_16x16x32_bf16 a[164:167], a[28:31], v[64:67], a[164:167]
    s_add_u32 m0, s36, 0
    ds_read_b64_tr_b16 v[92:93], v15 offset:28672
    ds_read_b64_tr_b16 v[94:95], v15 offset:29184
    v_mfma_f32_16x16x32_bf16 a[136:139], a[16:19], v[68:71], a[136:139]
    s_add_u32 s46, s32, s37
    ds_read_b128 a[32:35], v16 offset:8192
    ds_read_b128 a[36:39], v16 offset:10240
    v_mfma_f32_16x16x32_bf16 a[140:143], a[20:23], v[68:71], a[140:143]
    ds_read_b128 a[40:43], v16 offset:12288
    ds_read_b128 a[44:47], v16 offset:14336
    v_mfma_f32_16x16x32_bf16 a[168:171], a[24:27], v[68:71], a[168:171]
    ds_read_b128 a[48:51], v17 offset:8192
    ds_read_b128 a[52:55], v17 offset:10240
    v_mfma_f32_16x16x32_bf16 a[172:175], a[28:31], v[68:71], a[172:175]
    ds_read_b128 a[56:59], v17 offset:12288
    ds_read_b128 a[60:63], v17 offset:14336
    v_mfma_f32_16x16x32_bf16 a[144:147], a[16:19], v[72:75], a[144:147]
    buffer_load_dwordx4 v4, s[8:11], s46 offen offset:0 lds
    v_mfma_f32_16x16x32_bf16 a[148:151], a[20:23], v[72:75], a[148:151]
    v_mfma_f32_16x16x32_bf16 a[176:179], a[24:27], v[72:75], a[176:179]
    buffer_load_dwordx4 v5, s[8:11], s46 offen offset:1024 lds
    v_mfma_f32_16x16x32_bf16 a[180:183], a[28:31], v[72:75], a[180:183]
    v_mfma_f32_16x16x32_bf16 a[152:155], a[16:19], v[76:79], a[152:155]
    buffer_load_dwordx4 v6, s[8:11], s46 offen offset:2048 lds
    v_mfma_f32_16x16x32_bf16 a[156:159], a[20:23], v[76:79], a[156:159]
    v_mfma_f32_16x16x32_bf16 a[184:187], a[24:27], v[76:79], a[184:187]
    buffer_load_dwordx4 v7, s[8:11], s46 offen offset:3072 lds
    v_mfma_f32_16x16x32_bf16 a[188:191], a[28:31], v[76:79], a[188:191]
    s_waitcnt lgkmcnt(0)
    v_mfma_f32_16x16x32_bf16 a[192:195], a[16:19], v[80:83], a[192:195]
    s_waitcnt vmcnt(23)
    v_mfma_f32_16x16x32_bf16 a[196:199], a[20:23], v[80:83], a[196:199]
    s_barrier
    ds_read_b64_tr_b16 v[64:65], v12 offset:32768
    ds_read_b64_tr_b16 v[66:67], v12 offset:33280
    v_mfma_f32_16x16x32_bf16 a[224:227], a[24:27], v[80:83], a[224:227]
    s_add_u32 m0, s36, 4096
    ds_read_b64_tr_b16 v[68:69], v13 offset:32768
    ds_read_b64_tr_b16 v[70:71], v13 offset:33280
    v_mfma_f32_16x16x32_bf16 a[228:231], a[28:31], v[80:83], a[228:231]
    s_add_u32 s46, s33, s37
    ds_read_b64_tr_b16 v[72:73], v14 offset:32768
    ds_read_b64_tr_b16 v[74:75], v14 offset:33280
    v_mfma_f32_16x16x32_bf16 a[200:203], a[16:19], v[84:87], a[200:203]
    ds_read_b64_tr_b16 v[76:77], v15 offset:32768
    ds_read_b64_tr_b16 v[78:79], v15 offset:33280
    v_mfma_f32_16x16x32_bf16 a[204:207], a[20:23], v[84:87], a[204:207]
    buffer_load_dwordx4 v4, s[8:11], s46 offen offset:0 lds
    v_mfma_f32_16x16x32_bf16 a[232:235], a[24:27], v[84:87], a[232:235]
    v_mfma_f32_16x16x32_bf16 a[236:239], a[28:31], v[84:87], a[236:239]
    buffer_load_dwordx4 v5, s[8:11], s46 offen offset:1024 lds
    v_mfma_f32_16x16x32_bf16 a[208:211], a[16:19], v[88:91], a[208:211]
    v_mfma_f32_16x16x32_bf16 a[212:215], a[20:23], v[88:91], a[212:215]
    buffer_load_dwordx4 v6, s[8:11], s46 offen offset:2048 lds
    v_mfma_f32_16x16x32_bf16 a[240:243], a[24:27], v[88:91], a[240:243]
    v_mfma_f32_16x16x32_bf16 a[244:247], a[28:31], v[88:91], a[244:247]
    buffer_load_dwordx4 v7, s[8:11], s46 offen offset:3072 lds
    v_mfma_f32_16x16x32_bf16 a[216:219], a[16:19], v[92:95], a[216:219]
    s_add_u32 m0, s40, 16384
    v_mfma_f32_16x16x32_bf16 a[220:223], a[20:23], v[92:95], a[220:223]
    s_add_u32 s46, s43, 1048576
    v_mfma_f32_16x16x32_bf16 a[248:251], a[24:27], v[92:95], a[248:251]
    s_and_b32 s46, s46, 0x3fffff
    buffer_load_dwordx4 v8, s[20:23], s46 offen offset:0 lds
    v_mfma_f32_16x16x32_bf16 a[252:255], a[28:31], v[92:95], a[252:255]
    s_waitcnt lgkmcnt(0)
    v_mfma_f32_16x16x32_bf16 v[128:131], v[64:67], a[32:35], v[128:131]
    ds_read_b64_tr_b16 v[80:81], v12 offset:36864
    ds_read_b64_tr_b16 v[82:83], v12 offset:37376
    v_mfma_f32_16x16x32_bf16 v[144:147], v[64:67], a[36:39], v[144:147]
    ds_read_b64_tr_b16 v[84:85], v13 offset:36864
    ds_read_b64_tr_b16 v[86:87], v13 offset:37376
    v_mfma_f32_16x16x32_bf16 v[160:163], v[64:67], a[40:43], v[160:163]
    ds_read_b64_tr_b16 v[88:89], v14 offset:36864
    ds_read_b64_tr_b16 v[90:91], v14 offset:37376
    v_mfma_f32_16x16x32_bf16 v[176:179], v[64:67], a[44:47], v[176:179]
    ds_read_b64_tr_b16 v[92:93], v15 offset:36864
    ds_read_b64_tr_b16 v[94:95], v15 offset:37376
    v_mfma_f32_16x16x32_bf16 v[132:135], v[68:71], a[32:35], v[132:135]
    buffer_load_dwordx4 v9, s[20:23], s46 offen offset:1024 lds
    v_mfma_f32_16x16x32_bf16 v[148:151], v[68:71], a[36:39], v[148:151]
    v_mfma_f32_16x16x32_bf16 v[164:167], v[68:71], a[40:43], v[164:167]
    buffer_load_dwordx4 v10, s[20:23], s46 offen offset:2048 lds
    v_mfma_f32_16x16x32_bf16 v[180:183], v[68:71], a[44:47], v[180:183]
    v_mfma_f32_16x16x32_bf16 v[136:139], v[72:75], a[32:35], v[136:139]
    buffer_load_dwordx4 v11, s[20:23], s46 offen offset:3072 lds
    v_mfma_f32_16x16x32_bf16 v[152:155], v[72:75], a[36:39], v[152:155]
    s_lshl_b32 s39, s45, 12
    v_mfma_f32_16x16x32_bf16 v[168:171], v[72:75], a[40:43], v[168:171]
    s_add_u32 s39, s39, 0x200000
    v_mfma_f32_16x16x32_bf16 v[184:187], v[72:75], a[44:47], v[184:187]
    s_and_b32 s39, s39, 0x300000
    buffer_load_dword v31, v30, s[20:23], s39 offen
    v_mfma_f32_16x16x32_bf16 v[140:143], v[76:79], a[32:35], v[140:143]
    s_lshl_b32 s48, s2, 13
    v_mfma_f32_16x16x32_bf16 v[156:159], v[76:79], a[36:39], v[156:159]
    s_lshl_b32 s49, s3, 11
    v_mfma_f32_16x16x32_bf16 v[172:175], v[76:79], a[40:43], v[172:175]
    s_add_u32 s48, s48, s49
    buffer_load_dwordx4 v[32:35], v2, s[12:15], s48 offen
    v_mfma_f32_16x16x32_bf16 v[188:191], v[76:79], a[44:47], v[188:191]
    s_waitcnt lgkmcnt(0)
    v_mfma_f32_16x16x32_bf16 v[192:195], v[80:83], a[32:35], v[192:195]
    ds_read_b64_tr_b16 v[64:65], v12 offset:40960
    ds_read_b64_tr_b16 v[66:67], v12 offset:41472
    v_mfma_f32_16x16x32_bf16 v[208:211], v[80:83], a[36:39], v[208:211]
    ds_read_b64_tr_b16 v[68:69], v13 offset:40960
    ds_read_b64_tr_b16 v[70:71], v13 offset:41472
    v_mfma_f32_16x16x32_bf16 v[224:227], v[80:83], a[40:43], v[224:227]
    ds_read_b64_tr_b16 v[72:73], v14 offset:40960
    ds_read_b64_tr_b16 v[74:75], v14 offset:41472
    v_mfma_f32_16x16x32_bf16 v[240:243], v[80:83], a[44:47], v[240:243]
    ds_read_b64_tr_b16 v[76:77], v15 offset:40960
    ds_read_b64_tr_b16 v[78:79], v15 offset:41472
    v_mfma_f32_16x16x32_bf16 v[196:199], v[84:87], a[32:35], v[196:199]
    buffer_load_dwordx4 v[36:39], v2, s[12:15], s48 offen offset:1024
    v_mfma_f32_16x16x32_bf16 v[212:215], v[84:87], a[36:39], v[212:215]
    v_mfma_f32_16x16x32_bf16 v[228:231], v[84:87], a[40:43], v[228:231]
    global_load_dwordx4 v[40:43], v2, s[80:81]
    v_mfma_f32_16x16x32_bf16 v[244:247], v[84:87], a[44:47], v[244:247]
    v_mfma_f32_16x16x32_bf16 v[200:203], v[88:91], a[32:35], v[200:203]
    global_load_dwordx4 v[44:47], v2, s[82:83]
    v_mfma_f32_16x16x32_bf16 v[216:219], v[88:91], a[36:39], v[216:219]
    s_lshl_b32 s39, s45, 12
    v_mfma_f32_16x16x32_bf16 v[232:235], v[88:91], a[40:43], v[232:235]
    s_add_u32 s39, s39, 0x300000
    v_mfma_f32_16x16x32_bf16 v[248:251], v[88:91], a[44:47], v[248:251]
    s_and_b32 s39, s39, 0x300000
    buffer_load_dword v31, v30, s[16:19], s39 offen
    v_mfma_f32_16x16x32_bf16 v[204:207], v[92:95], a[32:35], v[204:207]
    v_mfma_f32_16x16x32_bf16 v[220:223], v[92:95], a[36:39], v[220:223]
    v_mfma_f32_16x16x32_bf16 v[236:239], v[92:95], a[40:43], v[236:239]
    v_mfma_f32_16x16x32_bf16 v[252:255], v[92:95], a[44:47], v[252:255]
    s_waitcnt lgkmcnt(0)
    v_mfma_f32_16x16x32_bf16 v[128:131], v[64:67], a[48:51], v[128:131]
    s_add_u32 s37, s45, 512
    ds_read_b64_tr_b16 v[80:81], v12 offset:45056
    ds_read_b64_tr_b16 v[82:83], v12 offset:45568
    v_mfma_f32_16x16x32_bf16 v[144:147], v[64:67], a[52:55], v[144:147]
    s_and_b32 s37, s37, 0x3ff
    ds_read_b64_tr_b16 v[84:85], v13 offset:45056
    ds_read_b64_tr_b16 v[86:87], v13 offset:45568
    v_mfma_f32_16x16x32_bf16 v[160:163], v[64:67], a[56:59], v[160:163]
    s_add_u32 m0, s36, 8192
    ds_read_b64_tr_b16 v[88:89], v14 offset:45056
    ds_read_b64_tr_b16 v[90:91], v14 offset:45568
    v_mfma_f32_16x16x32_bf16 v[176:179], v[64:67], a[60:63], v[176:179]
    s_add_u32 s46, s32, s37
    ds_read_b64_tr_b16 v[92:93], v15 offset:45056
    ds_read_b64_tr_b16 v[94:95], v15 offset:45568
    v_mfma_f32_16x16x32_bf16 v[132:135], v[68:71], a[48:51], v[132:135]
    buffer_load_dwordx4 v4, s[8:11], s46 offen offset:0 lds
    v_mfma_f32_16x16x32_bf16 v[148:151], v[68:71], a[52:55], v[148:151]
    v_mfma_f32_16x16x32_bf16 v[164:167], v[68:71], a[56:59], v[164:167]
    buffer_load_dwordx4 v5, s[8:11], s46 offen offset:1024 lds
    v_mfma_f32_16x16x32_bf16 v[180:183], v[68:71], a[60:63], v[180:183]
    v_mfma_f32_16x16x32_bf16 v[136:139], v[72:75], a[48:51], v[136:139]
    buffer_load_dwordx4 v6, s[8:11], s46 offen offset:2048 lds
    v_mfma_f32_16x16x32_bf16 v[152:155], v[72:75], a[52:55], v[152:155]
    v_mfma_f32_16x16x32_bf16 v[168:171], v[72:75], a[56:59], v[168:171]
    buffer_load_dwordx4 v7, s[8:11], s46 offen offset:3072 lds
    v_mfma_f32_16x16x32_bf16 v[184:187], v[72:75], a[60:63], v[184:187]
    s_add_u32 m0, s36, 12288
    v_mfma_f32_16x16x32_bf16 v[140:143], v[76:79], a[48:51], v[140:143]
    s_add_u32 s46, s33, s37
    buffer_load_dwordx4 v4, s[8:11], s46 offen offset:0 lds
    v_mfma_f32_16x16x32_bf16 v[156:159], v[76:79], a[52:55], v[156:159]
    v_mfma_f32_16x16x32_bf16 v[172:175], v[76:79], a[56:59], v[172:175]
    buffer_load_dwordx4 v5, s[8:11], s46 offen offset:1024 lds
    v_mfma_f32_16x16x32_bf16 v[188:191], v[76:79], a[60:63], v[188:191]
    s_waitcnt lgkmcnt(0)
    v_mfma_f32_16x16x32_bf16 v[192:195], v[80:83], a[48:51], v[192:195]
    s_waitcnt vmcnt(39)
    v_mfma_f32_16x16x32_bf16 v[208:211], v[80:83], a[52:55], v[208:211]
    s_barrier
    ds_read_b64_tr_b16 v[64:65], v12 offset:49152
    ds_read_b64_tr_b16 v[66:67], v12 offset:49664
    v_mfma_f32_16x16x32_bf16 v[224:227], v[80:83], a[56:59], v[224:227]
    ds_read_b64_tr_b16 v[68:69], v13 offset:49152
    ds_read_b64_tr_b16 v[70:71], v13 offset:49664
    v_mfma_f32_16x16x32_bf16 v[240:243], v[80:83], a[60:63], v[240:243]
    ds_read_b64_tr_b16 v[72:73], v14 offset:49152
    ds_read_b64_tr_b16 v[74:75], v14 offset:49664
    v_mfma_f32_16x16x32_bf16 v[196:199], v[84:87], a[48:51], v[196:199]
    ds_read_b64_tr_b16 v[76:77], v15 offset:49152
    ds_read_b64_tr_b16 v[78:79], v15 offset:49664
    v_mfma_f32_16x16x32_bf16 v[212:215], v[84:87], a[52:55], v[212:215]
    buffer_load_dwordx4 v6, s[8:11], s46 offen offset:2048 lds
    v_mfma_f32_16x16x32_bf16 v[228:231], v[84:87], a[56:59], v[228:231]
    v_mfma_f32_16x16x32_bf16 v[244:247], v[84:87], a[60:63], v[244:247]
    buffer_load_dwordx4 v7, s[8:11], s46 offen offset:3072 lds
    v_mfma_f32_16x16x32_bf16 v[200:203], v[88:91], a[48:51], v[200:203]
    s_add_u32 m0, s40, 32768
    v_mfma_f32_16x16x32_bf16 v[216:219], v[88:91], a[52:55], v[216:219]
    s_add_u32 s46, s43, 1572864
    v_mfma_f32_16x16x32_bf16 v[232:235], v[88:91], a[56:59], v[232:235]
    s_and_b32 s46, s46, 0x3fffff
    buffer_load_dwordx4 v8, s[16:19], s46 offen offset:0 lds
    v_mfma_f32_16x16x32_bf16 v[248:251], v[88:91], a[60:63], v[248:251]
    v_mfma_f32_16x16x32_bf16 v[204:207], v[92:95], a[48:51], v[204:207]
    buffer_load_dwordx4 v9, s[16:19], s46 offen offset:1024 lds
    v_mfma_f32_16x16x32_bf16 v[220:223], v[92:95], a[52:55], v[220:223]
    v_mfma_f32_16x16x32_bf16 v[236:239], v[92:95], a[56:59], v[236:239]
    buffer_load_dwordx4 v10, s[16:19], s46 offen offset:2048 lds
    v_mfma_f32_16x16x32_bf16 v[252:255], v[92:95], a[60:63], v[252:255]
    s_waitcnt lgkmcnt(0)
    v_mfma_f32_16x16x32_bf16 a[128:131], a[32:35], v[64:67], a[128:131]
    s_waitcnt vmcnt(35)
    ds_read_b64_tr_b16 v[80:81], v12 offset:53248
    ds_read_b64_tr_b16 v[82:83], v12 offset:53760
    v_mfma_f32_16x16x32_bf16 a[132:135], a[36:39], v[64:67], a[132:135]
    ds_read_b64_tr_b16 v[84:85], v13 offset:53248
    ds_read_b64_tr_b16 v[86:87], v13 offset:53760
    v_mfma_f32_16x16x32_bf16 a[160:163], a[40:43], v[64:67], a[160:163]
    ds_read_b64_tr_b16 v[88:89], v14 offset:53248
    ds_read_b64_tr_b16 v[90:91], v14 offset:53760
    v_mfma_f32_16x16x32_bf16 a[164:167], a[44:47], v[64:67], a[164:167]
    ds_read_b64_tr_b16 v[92:93], v15 offset:53248
    ds_read_b64_tr_b16 v[94:95], v15 offset:53760
    v_mfma_f32_16x16x32_bf16 a[136:139], a[32:35], v[68:71], a[136:139]
    ds_read_b128 a[64:67], v16 offset:16384
    ds_read_b128 a[68:71], v16 offset:18432
    v_mfma_f32_16x16x32_bf16 a[140:143], a[36:39], v[68:71], a[140:143]
    ds_read_b128 a[72:75], v16 offset:20480
    ds_read_b128 a[76:79], v16 offset:22528
    v_mfma_f32_16x16x32_bf16 a[168:171], a[40:43], v[68:71], a[168:171]
    ds_read_b128 a[80:83], v17 offset:16384
    ds_read_b128 a[84:87], v17 offset:18432
    v_mfma_f32_16x16x32_bf16 a[172:175], a[44:47], v[68:71], a[172:175]
    ds_read_b128 a[88:91], v17 offset:20480
    ds_read_b128 a[92:95], v17 offset:22528
    v_mfma_f32_16x16x32_bf16 a[144:147], a[32:35], v[72:75], a[144:147]
    buffer_load_dwordx4 v11, s[16:19], s46 offen offset:3072 lds
    v_mfma_f32_16x16x32_bf16 a[148:151], a[36:39], v[72:75], a[148:151]
    s_lshl_b32 s39, s45, 12
    v_mfma_f32_16x16x32_bf16 a[176:179], a[40:43], v[72:75], a[176:179]
    s_add_u32 s39, s39, 0x300000
    v_mfma_f32_16x16x32_bf16 a[180:183], a[44:47], v[72:75], a[180:183]
    s_and_b32 s39, s39, 0x300000
    buffer_load_dword v31, v30, s[20:23], s39 offen
    v_mfma_f32_16x16x32_bf16 a[152:155], a[32:35], v[76:79], a[152:155]
    v_mfma_f32_16x16x32_bf16 a[156:159], a[36:39], v[76:79], a[156:159]
    v_mfma_f32_16x16x32_bf16 a[184:187], a[40:43], v[76:79], a[184:187]
    v_mfma_f32_16x16x32_bf16 a[188:191], a[44:47], v[76:79], a[188:191]
    s_waitcnt lgkmcnt(0)
    v_mfma_f32_16x16x32_bf16 a[192:195], a[32:35], v[80:83], a[192:195]
    s_lshl_b32 s39, s45, 12
    ds_read_b64_tr_b16 v[64:65], v12 offset:57344
    ds_read_b64_tr_b16 v[66:67], v12 offset:57856
    v_mfma_f32_16x16x32_bf16 a[196:199], a[36:39], v[80:83], a[196:199]
    s_add_u32 s39, s39, 0x0
    ds_read_b64_tr_b16 v[68:69], v13 offset:57344
    ds_read_b64_tr_b16 v[70:71], v13 offset:57856
    v_mfma_f32_16x16x32_bf16 a[224:227], a[40:43], v[80:83], a[224:227]
    s_and_b32 s39, s39, 0x300000
    ds_read_b64_tr_b16 v[72:73], v14 offset:57344
    ds_read_b64_tr_b16 v[74:75], v14 offset:57856
    v_mfma_f32_16x16x32_bf16 a[228:231], a[44:47], v[80:83], a[228:231]
    ds_read_b64_tr_b16 v[76:77], v15 offset:57344
    ds_read_b64_tr_b16 v[78:79], v15 offset:57856
    v_mfma_f32_16x16x32_bf16 a[200:203], a[32:35], v[84:87], a[200:203]
    buffer_load_dword v31, v30, s[24:27], s39 offen
    v_mfma_f32_16x16x32_bf16 a[204:207], a[36:39], v[84:87], a[204:207]
    v_mfma_f32_16x16x32_bf16 a[232:235], a[40:43], v[84:87], a[232:235]
    v_mfma_f32_16x16x32_bf16 a[236:239], a[44:47], v[84:87], a[236:239]
    v_mfma_f32_16x16x32_bf16 a[208:211], a[32:35], v[88:91], a[208:211]
    v_mfma_f32_16x16x32_bf16 a[212:215], a[36:39], v[88:91], a[212:215]
    v_mfma_f32_16x16x32_bf16 a[240:243], a[40:43], v[88:91], a[240:243]
    v_mfma_f32_16x16x32_bf16 a[244:247], a[44:47], v[88:91], a[244:247]
    v_mfma_f32_16x16x32_bf16 a[216:219], a[32:35], v[92:95], a[216:219]
    v_mfma_f32_16x16x32_bf16 a[220:223], a[36:39], v[92:95], a[220:223]
    v_mfma_f32_16x16x32_bf16 a[248:251], a[40:43], v[92:95], a[248:251]
    v_mfma_f32_16x16x32_bf16 a[252:255], a[44:47], v[92:95], a[252:255]
    s_waitcnt lgkmcnt(0)
    v_mfma_f32_16x16x32_bf16 a[128:131], a[48:51], v[64:67], a[128:131]
    s_add_u32 s37, s45, 640
    ds_read_b64_tr_b16 v[80:81], v12 offset:61440
    ds_read_b64_tr_b16 v[82:83], v12 offset:61952
    v_mfma_f32_16x16x32_bf16 a[132:135], a[52:55], v[64:67], a[132:135]
    s_and_b32 s37, s37, 0x3ff
    ds_read_b64_tr_b16 v[84:85], v13 offset:61440
    ds_read_b64_tr_b16 v[86:87], v13 offset:61952
    v_mfma_f32_16x16x32_bf16 a[160:163], a[56:59], v[64:67], a[160:163]
    s_add_u32 m0, s36, 16384
    ds_read_b64_tr_b16 v[88:89], v14 offset:61440
    ds_read_b64_tr_b16 v[90:91], v14 offset:61952
    v_mfma_f32_16x16x32_bf16 a[164:167], a[60:63], v[64:67], a[164:167]
    s_add_u32 s46, s32, s37
    ds_read_b64_tr_b16 v[92:93], v15 offset:61440
    ds_read_b64_tr_b16 v[94:95], v15 offset:61952
    v_mfma_f32_16x16x32_bf16 a[136:139], a[48:51], v[68:71], a[136:139]
    buffer_load_dwordx4 v4, s[8:11], s46 offen offset:0 lds
    v_mfma_f32_16x16x32_bf16 a[140:143], a[52:55], v[68:71], a[140:143]
    v_mfma_f32_16x16x32_bf16 a[168:171], a[56:59], v[68:71], a[168:171]
    v_mfma_f32_16x16x32_bf16 a[172:175], a[60:63], v[68:71], a[172:175]
    buffer_load_dwordx4 v5, s[8:11], s46 offen offset:1024 lds
    v_mfma_f32_16x16x32_bf16 a[144:147], a[48:51], v[72:75], a[144:147]
    v_mfma_f32_16x16x32_bf16 a[148:151], a[52:55], v[72:75], a[148:151]
    v_mfma_f32_16x16x32_bf16 a[176:179], a[56:59], v[72:75], a[176:179]
    buffer_load_dwordx4 v6, s[8:11], s46 offen offset:2048 lds
    v_mfma_f32_16x16x32_bf16 a[180:183], a[60:63], v[72:75], a[180:183]
    v_mfma_f32_16x16x32_bf16 a[152:155], a[48:51], v[76:79], a[152:155]
    v_mfma_f32_16x16x32_bf16 a[156:159], a[52:55], v[76:79], a[156:159]
    buffer_load_dwordx4 v7, s[8:11], s46 offen offset:3072 lds
    v_mfma_f32_16x16x32_bf16 a[184:187], a[56:59], v[76:79], a[184:187]
    s_add_u32 m0, s36, 20480
    v_mfma_f32_16x16x32_bf16 a[188:191], a[60:63], v[76:79], a[188:191]
    s_waitcnt lgkmcnt(0)
    v_mfma_f32_16x16x32_bf16 a[192:195], a[48:51], v[80:83], a[192:195]
    s_waitcnt vmcnt(38)
    v_mfma_f32_16x16x32_bf16 a[196:199], a[52:55], v[80:83], a[196:199]
    s_barrier
    ds_read_b64_tr_b16 v[64:65], v12 offset:0
    ds_read_b64_tr_b16 v[66:67], v12 offset:512
    v_mfma_f32_16x16x32_bf16 a[224:227], a[56:59], v[80:83], a[224:227]
    s_add_u32 s46, s33, s37
    ds_read_b64_tr_b16 v[68:69], v13 offset:0
    ds_read_b64_tr_b16 v[70:71], v13 offset:512
    v_mfma_f32_16x16x32_bf16 a[228:231], a[60:63], v[80:83], a[228:231]
    ds_read_b64_tr_b16 v[72:73], v14 offset:0
    ds_read_b64_tr_b16 v[74:75], v14 offset:512
    v_mfma_f32_16x16x32_bf16 a[200:203], a[48:51], v[84:87], a[200:203]
    ds_read_b64_tr_b16 v[76:77], v15 offset:0
    ds_read_b64_tr_b16 v[78:79], v15 offset:512
    v_mfma_f32_16x16x32_bf16 a[204:207], a[52:55], v[84:87], a[204:207]
    buffer_load_dwordx4 v4, s[8:11], s46 offen offset:0 lds
    v_mfma_f32_16x16x32_bf16 a[232:235], a[56:59], v[84:87], a[232:235]
    v_mfma_f32_16x16x32_bf16 a[236:239], a[60:63], v[84:87], a[236:239]
    v_mfma_f32_16x16x32_bf16 a[208:211], a[48:51], v[88:91], a[208:211]
    buffer_load_dwordx4 v5, s[8:11], s46 offen offset:1024 lds
    v_mfma_f32_16x16x32_bf16 a[212:215], a[52:55], v[88:91], a[212:215]
    v_mfma_f32_16x16x32_bf16 a[240:243], a[56:59], v[88:91], a[240:243]
    v_mfma_f32_16x16x32_bf16 a[244:247], a[60:63], v[88:91], a[244:247]
    buffer_load_dwordx4 v6, s[8:11], s46 offen offset:2048 lds
    v_mfma_f32_16x16x32_bf16 a[216:219], a[48:51], v[92:95], a[216:219]
    v_mfma_f32_16x16x32_bf16 a[220:223], a[52:55], v[92:95], a[220:223]
    v_mfma_f32_16x16x32_bf16 a[248:251], a[56:59], v[92:95], a[248:251]
    buffer_load_dwordx4 v7, s[8:11], s46 offen offset:3072 lds
    v_mfma_f32_16x16x32_bf16 a[252:255], a[60:63], v[92:95], a[252:255]
    s_waitcnt lgkmcnt(0)
    v_mfma_f32_16x16x32_bf16 v[128:131], v[64:67], a[64:67], v[128:131]
    s_add_u32 m0, s40, 49152
    ds_read_b64_tr_b16 v[80:81], v12 offset:4096
    ds_read_b64_tr_b16 v[82:83], v12 offset:4608
    v_mfma_f32_16x16x32_bf16 v[144:147], v[64:67], a[68:71], v[144:147]
    s_add_u32 s46, s43, 1572864
    ds_read_b64_tr_b16 v[84:85], v13 offset:4096
    ds_read_b64_tr_b16 v[86:87], v13 offset:4608
    v_mfma_f32_16x16x32_bf16 v[160:163], v[64:67], a[72:75], v[160:163]
    s_and_b32 s46, s46, 0x3fffff
    ds_read_b64_tr_b16 v[88:89], v14 offset:4096
    ds_read_b64_tr_b16 v[90:91], v14 offset:4608
    v_mfma_f32_16x16x32_bf16 v[176:179], v[64:67], a[76:79], v[176:179]
    ds_read_b64_tr_b16 v[92:93], v15 offset:4096
    ds_read_b64_tr_b16 v[94:95], v15 offset:4608
    v_mfma_f32_16x16x32_bf16 v[132:135], v[68:71], a[64:67], v[132:135]
    buffer_load_dwordx4 v8, s[20:23], s46 offen offset:0 lds
    v_mfma_f32_16x16x32_bf16 v[148:151], v[68:71], a[68:71], v[148:151]
    v_mfma_f32_16x16x32_bf16 v[164:167], v[68:71], a[72:75], v[164:167]
    v_mfma_f32_16x16x32_bf16 v[180:183], v[68:71], a[76:79], v[180:183]
    buffer_load_dwordx4 v9, s[20:23], s46 offen offset:1024 lds
    v_mfma_f32_16x16x32_bf16 v[136:139], v[72:75], a[64:67], v[136:139]
    v_mfma_f32_16x16x32_bf16 v[152:155], v[72:75], a[68:71], v[152:155]
    v_mfma_f32_16x16x32_bf16 v[168:171], v[72:75], a[72:75], v[168:171]
    buffer_load_dwordx4 v10, s[20:23], s46 offen offset:2048 lds
    v_mfma_f32_16x16x32_bf16 v[184:187], v[72:75], a[76:79], v[184:187]
    v_mfma_f32_16x16x32_bf16 v[140:143], v[76:79], a[64:67], v[140:143]
    v_mfma_f32_16x16x32_bf16 v[156:159], v[76:79], a[68:71], v[156:159]
    buffer_load_dwordx4 v11, s[20:23], s46 offen offset:3072 lds
    v_mfma_f32_16x16x32_bf16 v[172:175], v[76:79], a[72:75], v[172:175]
    s_lshl_b32 s39, s45, 12
    v_mfma_f32_16x16x32_bf16 v[188:191], v[76:79], a[76:79], v[188:191]
    s_waitcnt lgkmcnt(0)
    v_mfma_f32_16x16x32_bf16 v[192:195], v[80:83], a[64:67], v[192:195]
    s_add_u32 s39, s39, 0x100000
    ds_read_b64_tr_b16 v[64:65], v12 offset:8192
    ds_read_b64_tr_b16 v[66:67], v12 offset:8704
    v_mfma_f32_16x16x32_bf16 v[208:211], v[80:83], a[68:71], v[208:211]
    s_and_b32 s39, s39, 0x300000
    ds_read_b64_tr_b16 v[68:69], v13 offset:8192
    ds_read_b64_tr_b16 v[70:71], v13 offset:8704
    v_mfma_f32_16x16x32_bf16 v[224:227], v[80:83], a[72:75], v[224:227]
    ds_read_b64_tr_b16 v[72:73], v14 offset:8192
    ds_read_b64_tr_b16 v[74:75], v14 offset:8704
    v_mfma_f32_16x16x32_bf16 v[240:243], v[80:83], a[76:79], v[240:243]
    ds_read_b64_tr_b16 v[76:77], v15 offset:8192
    ds_read_b64_tr_b16 v[78:79], v15 offset:8704
    v_mfma_f32_16x16x32_bf16 v[196:199], v[84:87], a[64:67], v[196:199]
    buffer_load_dword v31, v30, s[24:27], s39 offen
    v_mfma_f32_16x16x32_bf16 v[212:215], v[84:87], a[68:71], v[212:215]
    s_lshl_b32 s39, s45, 12
    v_mfma_f32_16x16x32_bf16 v[228:231], v[84:87], a[72:75], v[228:231]
    s_add_u32 s39, s39, 0x200000
    v_mfma_f32_16x16x32_bf16 v[244:247], v[84:87], a[76:79], v[244:247]
    s_and_b32 s39, s39, 0x300000
    buffer_load_dword v31, v30, s[24:27], s39 offen
    v_mfma_f32_16x16x32_bf16 v[200:203], v[88:91], a[64:67], v[200:203]
    v_mfma_f32_16x16x32_bf16 v[216:219], v[88:91], a[68:71], v[216:219]
    v_mfma_f32_16x16x32_bf16 v[232:235], v[88:91], a[72:75], v[232:235]
    v_mfma_f32_16x16x32_bf16 v[248:251], v[88:91], a[76:79], v[248:251]
    v_mfma_f32_16x16x32_bf16 v[204:207], v[92:95], a[64:67], v[204:207]
    v_mfma_f32_16x16x32_bf16 v[220:223], v[92:95], a[68:71], v[220:223]
    v_mfma_f32_16x16x32_bf16 v[236:239], v[92:95], a[72:75], v[236:239]
    v_mfma_f32_16x16x32_bf16 v[252:255], v[92:95], a[76:79], v[252:255]
    s_waitcnt lgkmcnt(0)
    v_mfma_f32_16x16x32_bf16 v[128:131], v[64:67], a[80:83], v[128:131]
    s_waitcnt vmcnt(38)
    ds_read_b64_tr_b16 v[80:81], v12 offset:12288
    ds_read_b64_tr_b16 v[82:83], v12 offset:12800
    v_mfma_f32_16x16x32_bf16 v[144:147], v[64:67], a[84:87], v[144:147]
    ds_read_b64_tr_b16 v[84:85], v13 offset:12288
    ds_read_b64_tr_b16 v[86:87], v13 offset:12800
    v_mfma_f32_16x16x32_bf16 v[160:163], v[64:67], a[88:91], v[160:163]
    ds_read_b64_tr_b16 v[88:89], v14 offset:12288
    ds_read_b64_tr_b16 v[90:91], v14 offset:12800
    v_mfma_f32_16x16x32_bf16 v[176:179], v[64:67], a[92:95], v[176:179]
    ds_read_b64_tr_b16 v[92:93], v15 offset:12288
    ds_read_b64_tr_b16 v[94:95], v15 offset:12800
    v_mfma_f32_16x16x32_bf16 v[132:135], v[68:71], a[80:83], v[132:135]
    ds_read_b128 a[96:99], v16 offset:0
    ds_read_b128 a[100:103], v16 offset:2048
    v_mfma_f32_16x16x32_bf16 v[148:151], v[68:71], a[84:87], v[148:151]
    ds_read_b128 a[104:107], v16 offset:4096
    ds_read_b128 a[108:111], v16 offset:6144
    v_mfma_f32_16x16x32_bf16 v[164:167], v[68:71], a[88:91], v[164:167]
    ds_read_b128 a[112:115], v17 offset:0
    ds_read_b128 a[116:119], v17 offset:2048
    v_mfma_f32_16x16x32_bf16 v[180:183], v[68:71], a[92:95], v[180:183]
    ds_read_b128 a[120:123], v17 offset:4096
    ds_read_b128 a[124:127], v17 offset:6144
    v_mfma_f32_16x16x32_bf16 v[136:139], v[72:75], a[80:83], v[136:139]
    v_mfma_f32_16x16x32_bf16 v[152:155], v[72:75], a[84:87], v[152:155]
    v_mfma_f32_16x16x32_bf16 v[168:171], v[72:75], a[88:91], v[168:171]
    v_mfma_f32_16x16x32_bf16 v[184:187], v[72:75], a[92:95], v[184:187]
    v_mfma_f32_16x16x32_bf16 v[140:143], v[76:79], a[80:83], v[140:143]
    v_mfma_f32_16x16x32_bf16 v[156:159], v[76:79], a[84:87], v[156:159]
    v_mfma_f32_16x16x32_bf16 v[172:175], v[76:79], a[88:91], v[172:175]
    v_mfma_f32_16x16x32_bf16 v[188:191], v[76:79], a[92:95], v[188:191]
    s_waitcnt lgkmcnt(0)
    v_mfma_f32_16x16x32_bf16 v[192:195], v[80:83], a[80:83], v[192:195]
    s_waitcnt vmcnt(34)
    v_mfma_f32_16x16x32_bf16 v[208:211], v[80:83], a[84:87], v[208:211]
    s_barrier
    ds_read_b64_tr_b16 v[64:65], v12 offset:16384
    ds_read_b64_tr_b16 v[66:67], v12 offset:16896
    v_mfma_f32_16x16x32_bf16 v[224:227], v[80:83], a[88:91], v[224:227]
    s_add_u32 m0, s40, 0
    ds_read_b64_tr_b16 v[68:69], v13 offset:16384
    ds_read_b64_tr_b16 v[70:71], v13 offset:16896
    v_mfma_f32_16x16x32_bf16 v[240:243], v[80:83], a[92:95], v[240:243]
    s_add_u32 s46, s41, 2097152
    ds_read_b64_tr_b16 v[72:73], v14 offset:16384
    ds_read_b64_tr_b16 v[74:75], v14 offset:16896
    v_mfma_f32_16x16x32_bf16 v[196:199], v[84:87], a[80:83], v[196:199]
    s_and_b32 s46, s46, 0x3fffff
    ds_read_b64_tr_b16 v[76:77], v15 offset:16384
    ds_read_b64_tr_b16 v[78:79], v15 offset:16896
    v_mfma_f32_16x16x32_bf16 v[212:215], v[84:87], a[84:87], v[212:215]
    s_waitcnt vmcnt(29)
    buffer_load_dwordx4 v8, s[16:19], s46 offen offset:0 lds
    v_mfma_f32_16x16x32_bf16 v[228:231], v[84:87], a[88:91], v[228:231]
    v_dot2_f32_bf16 v48, v32, v40, 0
    v_mfma_f32_16x16x32_bf16 v[244:247], v[84:87], a[92:95], v[244:247]
    v_dot2_f32_bf16 v49, v36, v40, 0
    v_mfma_f32_16x16x32_bf16 v[200:203], v[88:91], a[80:83], v[200:203]
    buffer_load_dwordx4 v9, s[16:19], s46 offen offset:1024 lds
    v_mfma_f32_16x16x32_bf16 v[216:219], v[88:91], a[84:87], v[216:219]
    v_dot2_f32_bf16 v50, v32, v44, 0
    v_mfma_f32_16x16x32_bf16 v[232:235], v[88:91], a[88:91], v[232:235]
    v_dot2_f32_bf16 v51, v36, v44, 0
    v_mfma_f32_16x16x32_bf16 v[248:251], v[88:91], a[92:95], v[248:251]
    buffer_load_dwordx4 v10, s[16:19], s46 offen offset:2048 lds
    v_mfma_f32_16x16x32_bf16 v[204:207], v[92:95], a[80:83], v[204:207]
    v_dot2_f32_bf16 v48, v33, v41, v48
    v_mfma_f32_16x16x32_bf16 v[220:223], v[92:95], a[84:87], v[220:223]
    v_dot2_f32_bf16 v49, v37, v41, v49
    v_mfma_f32_16x16x32_bf16 v[236:239], v[92:95], a[88:91], v[236:239]
    buffer_load_dwordx4 v11, s[16:19], s46 offen offset:3072 lds
    v_mfma_f32_16x16x32_bf16 v[252:255], v[92:95], a[92:95], v[252:255]
    s_waitcnt lgkmcnt(0)
    v_dot2_f32_bf16 v50, v33, v45, v50
    v_mfma_f32_16x16x32_bf16 a[128:131], a[64:67], v[64:67], a[128:131]
    s_add_u32 s37, s45, 768
    ds_read_b64_tr_b16 v[80:81], v12 offset:20480
    ds_read_b64_tr_b16 v[82:83], v12 offset:20992
    v_mfma_f32_16x16x32_bf16 a[132:135], a[68:71], v[64:67], a[132:135]
    s_and_b32 s37, s37, 0x3ff
    ds_read_b64_tr_b16 v[84:85], v13 offset:20480
    ds_read_b64_tr_b16 v[86:87], v13 offset:20992
    v_mfma_f32_16x16x32_bf16 a[160:163], a[72:75], v[64:67], a[160:163]
    buffer_load_dword v18, v19, s[60:63], 0 offen sc1
    ds_read_b64_tr_b16 v[88:89], v14 offset:20480
    ds_read_b64_tr_b16 v[90:91], v14 offset:20992
    v_mfma_f32_16x16x32_bf16 a[164:167], a[76:79], v[64:67], a[164:167]
    s_add_u32 m0, s36, 0
    ds_read_b64_tr_b16 v[92:93], v15 offset:20480
    ds_read_b64_tr_b16 v[94:95], v15 offset:20992
    v_mfma_f32_16x16x32_bf16 a[136:139], a[64:67], v[68:71], a[136:139]
    s_add_u32 s46, s32, s37
    buffer_load_dwordx4 v4, s[8:11], s46 offen offset:0 lds
    v_mfma_f32_16x16x32_bf16 a[140:143], a[68:71], v[68:71], a[140:143]
    v_dot2_f32_bf16 v51, v37, v45, v51
    v_mfma_f32_16x16x32_bf16 a[168:171], a[72:75], v[68:71], a[168:171]
    v_dot2_f32_bf16 v48, v34, v42, v48
    v_mfma_f32_16x16x32_bf16 a[172:175], a[76:79], v[68:71], a[172:175]
    buffer_load_dwordx4 v5, s[8:11], s46 offen offset:1024 lds
    v_mfma_f32_16x16x32_bf16 a[144:147], a[64:67], v[72:75], a[144:147]
    v_dot2_f32_bf16 v49, v38, v42, v49
    v_mfma_f32_16x16x32_bf16 a[148:151], a[68:71], v[72:75], a[148:151]
    v_dot2_f32_bf16 v50, v34, v46, v50
    v_mfma_f32_16x16x32_bf16 a[176:179], a[72:75], v[72:75], a[176:179]
    buffer_load_dwordx4 v6, s[8:11], s46 offen offset:2048 lds
    v_mfma_f32_16x16x32_bf16 a[180:183], a[76:79], v[72:75], a[180:183]
    v_dot2_f32_bf16 v51, v38, v46, v51
    v_mfma_f32_16x16x32_bf16 a[152:155], a[64:67], v[76:79], a[152:155]
    v_dot2_f32_bf16 v48, v35, v43, v48
    v_mfma_f32_16x16x32_bf16 a[156:159], a[68:71], v[76:79], a[156:159]
    buffer_load_dwordx4 v7, s[8:11], s46 offen offset:3072 lds
    v_mfma_f32_16x16x32_bf16 a[184:187], a[72:75], v[76:79], a[184:187]
    s_add_u32 m0, s36, 4096
    v_dot2_f32_bf16 v49, v39, v43, v49
    v_mfma_f32_16x16x32_bf16 a[188:191], a[76:79], v[76:79], a[188:191]
    s_waitcnt lgkmcnt(0)
    v_dot2_f32_bf16 v50, v35, v47, v50
    v_mfma_f32_16x16x32_bf16 a[192:195], a[64:67], v[80:83], a[192:195]
    s_add_u32 s46, s33, s37
    ds_read_b64_tr_b16 v[64:65], v12 offset:24576
    ds_read_b64_tr_b16 v[66:67], v12 offset:25088
    v_mfma_f32_16x16x32_bf16 a[196:199], a[68:71], v[80:83], a[196:199]
    ds_read_b64_tr_b16 v[68:69], v13 offset:24576
    ds_read_b64_tr_b16 v[70:71], v13 offset:25088
    v_mfma_f32_16x16x32_bf16 a[224:227], a[72:75], v[80:83], a[224:227]
    ds_read_b64_tr_b16 v[72:73], v14 offset:24576
    ds_read_b64_tr_b16 v[74:75], v14 offset:25088
    v_mfma_f32_16x16x32_bf16 a[228:231], a[76:79], v[80:83], a[228:231]
    ds_read_b64_tr_b16 v[76:77], v15 offset:24576
    ds_read_b64_tr_b16 v[78:79], v15 offset:25088
    v_mfma_f32_16x16x32_bf16 a[200:203], a[64:67], v[84:87], a[200:203]
    buffer_load_dwordx4 v4, s[8:11], s46 offen offset:0 lds
    v_mfma_f32_16x16x32_bf16 a[204:207], a[68:71], v[84:87], a[204:207]
    v_dot2_f32_bf16 v51, v39, v47, v51
    v_mfma_f32_16x16x32_bf16 a[232:235], a[72:75], v[84:87], a[232:235]
    v_add_f32_dpp v48, v48, v48 row_shr:1 row_mask:0xf bank_mask:0xf bound_ctrl:0
    v_add_f32_dpp v49, v49, v49 row_shr:1 row_mask:0xf bank_mask:0xf bound_ctrl:0
    v_mfma_f32_16x16x32_bf16 a[236:239], a[76:79], v[84:87], a[236:239]
    buffer_load_dwordx4 v5, s[8:11], s46 offen offset:1024 lds
    v_mfma_f32_16x16x32_bf16 a[208:211], a[64:67], v[88:91], a[208:211]
    v_add_f32_dpp v50, v50, v50 row_shr:1 row_mask:0xf bank_mask:0xf bound_ctrl:0
    v_add_f32_dpp v51, v51, v51 row_shr:1 row_mask:0xf bank_mask:0xf bound_ctrl:0
    v_mfma_f32_16x16x32_bf16 a[212:215], a[68:71], v[88:91], a[212:215]
    v_add_f32_dpp v48, v48, v48 row_shr:2 row_mask:0xf bank_mask:0xf bound_ctrl:0
    v_add_f32_dpp v49, v49, v49 row_shr:2 row_mask:0xf bank_mask:0xf bound_ctrl:0
    v_mfma_f32_16x16x32_bf16 a[240:243], a[72:75], v[88:91], a[240:243]
    buffer_load_dwordx4 v6, s[8:11], s46 offen offset:2048 lds
    v_mfma_f32_16x16x32_bf16 a[244:247], a[76:79], v[88:91], a[244:247]
    v_add_f32_dpp v50, v50, v50 row_shr:2 row_mask:0xf bank_mask:0xf bound_ctrl:0
    v_add_f32_dpp v51, v51, v51 row_shr:2 row_mask:0xf bank_mask:0xf bound_ctrl:0
    v_mfma_f32_16x16x32_bf16 a[216:219], a[64:67], v[92:95], a[216:219]
    v_add_f32_dpp v48, v48, v48 row_shr:4 row_mask:0xf bank_mask:0xf bound_ctrl:0
    v_add_f32_dpp v49, v49, v49 row_shr:4 row_mask:0xf bank_mask:0xf bound_ctrl:0
    v_mfma_f32_16x16x32_bf16 a[220:223], a[68:71], v[92:95], a[220:223]
    buffer_load_dwordx4 v7, s[8:11], s46 offen offset:3072 lds
    v_mfma_f32_16x16x32_bf16 a[248:251], a[72:75], v[92:95], a[248:251]
    s_lshl_b32 s39, s45, 12
    v_add_f32_dpp v50, v50, v50 row_shr:4 row_mask:0xf bank_mask:0xf bound_ctrl:0
    v_add_f32_dpp v51, v51, v51 row_shr:4 row_mask:0xf bank_mask:0xf bound_ctrl:0
    v_mfma_f32_16x16x32_bf16 a[252:255], a[76:79], v[92:95], a[252:255]
    s_waitcnt lgkmcnt(0)
    v_add_f32_dpp v48, v48, v48 row_shr:8 row_mask:0xf bank_mask:0xf bound_ctrl:0
    v_add_f32_dpp v49, v49, v49 row_shr:8 row_mask:0xf bank_mask:0xf bound_ctrl:0
    v_mfma_f32_16x16x32_bf16 a[128:131], a[80:83], v[64:67], a[128:131]
    s_add_u32 s39, s39, 0x300000
    ds_read_b64_tr_b16 v[80:81], v12 offset:28672
    ds_read_b64_tr_b16 v[82:83], v12 offset:29184
    v_mfma_f32_16x16x32_bf16 a[132:135], a[84:87], v[64:67], a[132:135]
    s_and_b32 s39, s39, 0x300000
    ds_read_b64_tr_b16 v[84:85], v13 offset:28672
    ds_read_b64_tr_b16 v[86:87], v13 offset:29184
    v_mfma_f32_16x16x32_bf16 a[160:163], a[88:91], v[64:67], a[160:163]
    ds_read_b64_tr_b16 v[88:89], v14 offset:28672
    ds_read_b64_tr_b16 v[90:91], v14 offset:29184
    v_mfma_f32_16x16x32_bf16 a[164:167], a[92:95], v[64:67], a[164:167]
    ds_read_b64_tr_b16 v[92:93], v15 offset:28672
    ds_read_b64_tr_b16 v[94:95], v15 offset:29184
    v_mfma_f32_16x16x32_bf16 a[136:139], a[80:83], v[68:71], a[136:139]
    buffer_load_dword v31, v30, s[24:27], s39 offen
    v_mfma_f32_16x16x32_bf16 a[140:143], a[84:87], v[68:71], a[140:143]
    v_and_b32 v19, 3, v1
    v_lshlrev_b32 v19, 2, v19
    v_mfma_f32_16x16x32_bf16 a[168:171], a[88:91], v[68:71], a[168:171]
    v_add_f32_dpp v50, v50, v50 row_shr:8 row_mask:0xf bank_mask:0xf bound_ctrl:0
    v_add_f32_dpp v51, v51, v51 row_shr:8 row_mask:0xf bank_mask:0xf bound_ctrl:0
    v_mfma_f32_16x16x32_bf16 a[172:175], a[92:95], v[68:71], a[172:175]
    v_add_f32_dpp v48, v48, v48 row_bcast:15 row_mask:0xa bank_mask:0xf
    v_add_f32_dpp v49, v49, v49 row_bcast:15 row_mask:0xa bank_mask:0xf
    v_mfma_f32_16x16x32_bf16 a[144:147], a[80:83], v[72:75], a[144:147]
    v_add_f32_dpp v50, v50, v50 row_bcast:15 row_mask:0xa bank_mask:0xf
    v_add_f32_dpp v51, v51, v51 row_bcast:15 row_mask:0xa bank_mask:0xf
    v_mfma_f32_16x16x32_bf16 a[148:151], a[84:87], v[72:75], a[148:151]
    v_add_f32_dpp v48, v48, v48 row_bcast:31 row_mask:0xc bank_mask:0xf
    v_add_f32_dpp v49, v49, v49 row_bcast:31 row_mask:0xc bank_mask:0xf
    v_mfma_f32_16x16x32_bf16 a[176:179], a[88:91], v[72:75], a[176:179]
    v_add_f32_dpp v50, v50, v50 row_bcast:31 row_mask:0xc bank_mask:0xf
    v_add_f32_dpp v51, v51, v51 row_bcast:31 row_mask:0xc bank_mask:0xf
    v_mfma_f32_16x16x32_bf16 a[180:183], a[92:95], v[72:75], a[180:183]
    s_lshl_b32 s50, s2, 3
    v_mfma_f32_16x16x32_bf16 a[152:155], a[80:83], v[76:79], a[152:155]
    s_lshl_b32 s51, s3, 1
    v_mfma_f32_16x16x32_bf16 a[156:159], a[84:87], v[76:79], a[156:159]
    s_add_u32 s50, s50, s51
    v_mfma_f32_16x16x32_bf16 a[184:187], a[88:91], v[76:79], a[184:187]
    s_sub_u32 s50, 2047, s50
    v_mfma_f32_16x16x32_bf16 a[188:191], a[92:95], v[76:79], a[188:191]
    s_waitcnt lgkmcnt(0)
    v_mfma_f32_16x16x32_bf16 a[192:195], a[80:83], v[80:83], a[192:195]
    s_waitcnt vmcnt(30)
    v_mfma_f32_16x16x32_bf16 a[196:199], a[84:87], v[80:83], a[196:199]
    s_barrier
    ds_read_b64_tr_b16 v[64:65], v12 offset:32768
    ds_read_b64_tr_b16 v[66:67], v12 offset:33280
    v_mfma_f32_16x16x32_bf16 a[224:227], a[88:91], v[80:83], a[224:227]
    s_add_u32 m0, s40, 16384
    ds_read_b64_tr_b16 v[68:69], v13 offset:32768
    ds_read_b64_tr_b16 v[70:71], v13 offset:33280
    v_mfma_f32_16x16x32_bf16 a[228:231], a[92:95], v[80:83], a[228:231]
    s_add_u32 s46, s41, 3145728
    ds_read_b64_tr_b16 v[72:73], v14 offset:32768
    ds_read_b64_tr_b16 v[74:75], v14 offset:33280
    v_mfma_f32_16x16x32_bf16 a[200:203], a[80:83], v[84:87], a[200:203]
    s_and_b32 s46, s46, 0x3fffff
    ds_read_b64_tr_b16 v[76:77], v15 offset:32768
    ds_read_b64_tr_b16 v[78:79], v15 offset:33280
    v_mfma_f32_16x16x32_bf16 a[204:207], a[84:87], v[84:87], a[204:207]
    s_sub_u32 s51, s50, 1
    buffer_load_dwordx4 v8, s[16:19], s46 offen offset:0 lds
    v_mfma_f32_16x16x32_bf16 a[232:235], a[88:91], v[84:87], a[232:235]
    v_ashrrev_i32 v52, 31, v48
    v_or_b32 v52, 0x80000000, v52
    v_mfma_f32_16x16x32_bf16 a[236:239], a[92:95], v[84:87], a[236:239]
    v_xor_b32 v48, v48, v52
    v_and_b32 v48, 0xfffff800, v48
    v_mfma_f32_16x16x32_bf16 a[208:211], a[80:83], v[88:91], a[208:211]
    buffer_load_dwordx4 v9, s[16:19], s46 offen offset:1024 lds
    v_mfma_f32_16x16x32_bf16 a[212:215], a[84:87], v[88:91], a[212:215]
    v_or_b32 v48, s50, v48
    v_ashrrev_i32 v53, 31, v49
    v_mfma_f32_16x16x32_bf16 a[240:243], a[88:91], v[88:91], a[240:243]
    v_or_b32 v53, 0x80000000, v53
    v_xor_b32 v49, v49, v53
    v_mfma_f32_16x16x32_bf16 a[244:247], a[92:95], v[88:91], a[244:247]
    buffer_load_dwordx4 v10, s[16:19], s46 offen offset:2048 lds
    v_mfma_f32_16x16x32_bf16 a[216:219], a[80:83], v[92:95], a[216:219]
    v_and_b32 v49, 0xfffff800, v49
    v_or_b32 v49, s51, v49
    v_mfma_f32_16x16x32_bf16 a[220:223], a[84:87], v[92:95], a[220:223]
    v_mul_f32 v50, 0xbfb8aa3b, v50
    v_mul_f32 v51, 0xbfb8aa3b, v51
    v_mfma_f32_16x16x32_bf16 a[248:251], a[88:91], v[92:95], a[248:251]
    buffer_load_dwordx4 v11, s[16:19], s46 offen offset:3072 lds
    v_mfma_f32_16x16x32_bf16 a[252:255], a[92:95], v[92:95], a[252:255]
    s_waitcnt lgkmcnt(0)
    v_exp_f32 v50, v50
    v_mfma_f32_16x16x32_bf16 v[128:131], v[64:67], a[96:99], v[128:131]
    s_waitcnt vmcnt(38)
    ds_read_b64_tr_b16 v[80:81], v12 offset:36864
    ds_read_b64_tr_b16 v[82:83], v12 offset:37376
    v_mfma_f32_16x16x32_bf16 v[144:147], v[64:67], a[100:103], v[144:147]
    ds_read_b64_tr_b16 v[84:85], v13 offset:36864
    ds_read_b64_tr_b16 v[86:87], v13 offset:37376
    v_mfma_f32_16x16x32_bf16 v[160:163], v[64:67], a[104:107], v[160:163]
    ds_read_b64_tr_b16 v[88:89], v14 offset:36864
    ds_read_b64_tr_b16 v[90:91], v14 offset:37376
    v_mfma_f32_16x16x32_bf16 v[176:179], v[64:67], a[108:111], v[176:179]
    ds_read_b64_tr_b16 v[92:93], v15 offset:36864
    ds_read_b64_tr_b16 v[94:95], v15 offset:37376
    v_mfma_f32_16x16x32_bf16 v[132:135], v[68:71], a[96:99], v[132:135]
    ds_read_b128 a[0:3], v16 offset:8192
    ds_read_b128 a[4:7], v16 offset:10240
    v_mfma_f32_16x16x32_bf16 v[148:151], v[68:71], a[100:103], v[148:151]
    ds_read_b128 a[8:11], v16 offset:12288
    ds_read_b128 a[12:15], v16 offset:14336
    v_mfma_f32_16x16x32_bf16 v[164:167], v[68:71], a[104:107], v[164:167]
    ds_read_b128 a[16:19], v17 offset:8192
    ds_read_b128 a[20:23], v17 offset:10240
    v_mfma_f32_16x16x32_bf16 v[180:183], v[68:71], a[108:111], v[180:183]
    ds_read_b128 a[24:27], v17 offset:12288
    ds_read_b128 a[28:31], v17 offset:14336
    v_mfma_f32_16x16x32_bf16 v[136:139], v[72:75], a[96:99], v[136:139]
    v_exp_f32 v51, v51
    v_mfma_f32_16x16x32_bf16 v[152:155], v[72:75], a[100:103], v[152:155]
    v_add_f32 v50, 1.0, v50
    v_add_f32 v51, 1.0, v51
    v_mfma_f32_16x16x32_bf16 v[168:171], v[72:75], a[104:107], v[168:171]
    v_rcp_f32 v50, v50
    v_mfma_f32_16x16x32_bf16 v[184:187], v[72:75], a[108:111], v[184:187]
    v_rcp_f32 v51, v51
    v_mfma_f32_16x16x32_bf16 v[140:143], v[76:79], a[96:99], v[140:143]
    s_nop 0
    v_or_b32 v50, 1, v50
    v_or_b32 v51, 1, v51
    v_mfma_f32_16x16x32_bf16 v[156:159], v[76:79], a[100:103], v[156:159]
    v_mfma_f32_16x16x32_bf16 v[172:175], v[76:79], a[104:107], v[172:175]
    v_mfma_f32_16x16x32_bf16 v[188:191], v[76:79], a[108:111], v[188:191]
    s_waitcnt lgkmcnt(0)
    v_mfma_f32_16x16x32_bf16 v[192:195], v[80:83], a[96:99], v[192:195]
    s_add_u32 s37, s45, 896
    ds_read_b64_tr_b16 v[64:65], v12 offset:40960
    ds_read_b64_tr_b16 v[66:67], v12 offset:41472
    v_mfma_f32_16x16x32_bf16 v[208:211], v[80:83], a[100:103], v[208:211]
    s_and_b32 s37, s37, 0x3ff
    ds_read_b64_tr_b16 v[68:69], v13 offset:40960
    ds_read_b64_tr_b16 v[70:71], v13 offset:41472
    v_mfma_f32_16x16x32_bf16 v[224:227], v[80:83], a[104:107], v[224:227]
    s_add_u32 m0, s36, 8192
    ds_read_b64_tr_b16 v[72:73], v14 offset:40960
    ds_read_b64_tr_b16 v[74:75], v14 offset:41472
    v_mfma_f32_16x16x32_bf16 v[240:243], v[80:83], a[108:111], v[240:243]
    s_add_u32 s46, s32, s37
    ds_read_b64_tr_b16 v[76:77], v15 offset:40960
    ds_read_b64_tr_b16 v[78:79], v15 offset:41472
    v_mfma_f32_16x16x32_bf16 v[196:199], v[84:87], a[96:99], v[196:199]
    buffer_load_dwordx4 v4, s[8:11], s46 offen offset:0 lds
    v_mfma_f32_16x16x32_bf16 v[212:215], v[84:87], a[100:103], v[212:215]
    v_mfma_f32_16x16x32_bf16 v[228:231], v[84:87], a[104:107], v[228:231]
    v_mfma_f32_16x16x32_bf16 v[244:247], v[84:87], a[108:111], v[244:247]
    buffer_load_dwordx4 v5, s[8:11], s46 offen offset:1024 lds
    v_mfma_f32_16x16x32_bf16 v[200:203], v[88:91], a[96:99], v[200:203]
    v_mfma_f32_16x16x32_bf16 v[216:219], v[88:91], a[100:103], v[216:219]
    v_mfma_f32_16x16x32_bf16 v[232:235], v[88:91], a[104:107], v[232:235]
    buffer_load_dwordx4 v6, s[8:11], s46 offen offset:2048 lds
    v_mfma_f32_16x16x32_bf16 v[248:251], v[88:91], a[108:111], v[248:251]
    v_mfma_f32_16x16x32_bf16 v[204:207], v[92:95], a[96:99], v[204:207]
    v_mfma_f32_16x16x32_bf16 v[220:223], v[92:95], a[100:103], v[220:223]
    buffer_load_dwordx4 v7, s[8:11], s46 offen offset:3072 lds
    v_mfma_f32_16x16x32_bf16 v[236:239], v[92:95], a[104:107], v[236:239]
    s_add_u32 m0, s36, 12288
    v_mfma_f32_16x16x32_bf16 v[252:255], v[92:95], a[108:111], v[252:255]
    s_waitcnt lgkmcnt(0)
    v_mfma_f32_16x16x32_bf16 v[128:131], v[64:67], a[112:115], v[128:131]
    s_add_u32 s46, s33, s37
    ds_read_b64_tr_b16 v[80:81], v12 offset:45056
    ds_read_b64_tr_b16 v[82:83], v12 offset:45568
    v_mfma_f32_16x16x32_bf16 v[144:147], v[64:67], a[116:119], v[144:147]
    ds_read_b64_tr_b16 v[84:85], v13 offset:45056
    ds_read_b64_tr_b16 v[86:87], v13 offset:45568
    v_mfma_f32_16x16x32_bf16 v[160:163], v[64:67], a[120:123], v[160:163]
    ds_read_b64_tr_b16 v[88:89], v14 offset:45056
    ds_read_b64_tr_b16 v[90:91], v14 offset:45568
    v_mfma_f32_16x16x32_bf16 v[176:179], v[64:67], a[124:127], v[176:179]
    ds_read_b64_tr_b16 v[92:93], v15 offset:45056
    ds_read_b64_tr_b16 v[94:95], v15 offset:45568
    v_mfma_f32_16x16x32_bf16 v[132:135], v[68:71], a[112:115], v[132:135]
    buffer_load_dwordx4 v4, s[8:11], s46 offen offset:0 lds
    v_mfma_f32_16x16x32_bf16 v[148:151], v[68:71], a[116:119], v[148:151]
    v_mfma_f32_16x16x32_bf16 v[164:167], v[68:71], a[120:123], v[164:167]
    v_mfma_f32_16x16x32_bf16 v[180:183], v[68:71], a[124:127], v[180:183]
    buffer_load_dwordx4 v5, s[8:11], s46 offen offset:1024 lds
    v_mfma_f32_16x16x32_bf16 v[136:139], v[72:75], a[112:115], v[136:139]
    v_mfma_f32_16x16x32_bf16 v[152:155], v[72:75], a[116:119], v[152:155]
    v_mfma_f32_16x16x32_bf16 v[168:171], v[72:75], a[120:123], v[168:171]
    buffer_load_dwordx4 v6, s[8:11], s46 offen offset:2048 lds
    v_mfma_f32_16x16x32_bf16 v[184:187], v[72:75], a[124:127], v[184:187]
    v_mfma_f32_16x16x32_bf16 v[140:143], v[76:79], a[112:115], v[140:143]
    v_mfma_f32_16x16x32_bf16 v[156:159], v[76:79], a[116:119], v[156:159]
    buffer_load_dwordx4 v7, s[8:11], s46 offen offset:3072 lds
    v_mfma_f32_16x16x32_bf16 v[172:175], v[76:79], a[120:123], v[172:175]
    v_mfma_f32_16x16x32_bf16 v[188:191], v[76:79], a[124:127], v[188:191]
    s_waitcnt lgkmcnt(0)
    v_mfma_f32_16x16x32_bf16 v[192:195], v[80:83], a[112:115], v[192:195]
    s_waitcnt vmcnt(28)
    v_mfma_f32_16x16x32_bf16 v[208:211], v[80:83], a[116:119], v[208:211]
    s_barrier
    ds_read_b64_tr_b16 v[64:65], v12 offset:49152
    ds_read_b64_tr_b16 v[66:67], v12 offset:49664
    v_mfma_f32_16x16x32_bf16 v[224:227], v[80:83], a[120:123], v[224:227]
    s_add_u32 m0, s40, 32768
    ds_read_b64_tr_b16 v[68:69], v13 offset:49152
    ds_read_b64_tr_b16 v[70:71], v13 offset:49664
    v_mfma_f32_16x16x32_bf16 v[240:243], v[80:83], a[124:127], v[240:243]
    s_add_u32 s46, s41, 2097280
    ds_read_b64_tr_b16 v[72:73], v14 offset:49152
    ds_read_b64_tr_b16 v[74:75], v14 offset:49664
    v_mfma_f32_16x16x32_bf16 v[196:199], v[84:87], a[112:115], v[196:199]
    s_and_b32 s46, s46, 0x3fffff
    ds_read_b64_tr_b16 v[76:77], v15 offset:49152
    ds_read_b64_tr_b16 v[78:79], v15 offset:49664
    v_mfma_f32_16x16x32_bf16 v[212:215], v[84:87], a[116:119], v[212:215]
    buffer_load_dwordx4 v8, s[16:19], s46 offen offset:0 lds
    v_mfma_f32_16x16x32_bf16 v[228:231], v[84:87], a[120:123], v[228:231]
    v_mfma_f32_16x16x32_bf16 v[244:247], v[84:87], a[124:127], v[244:247]
    v_mfma_f32_16x16x32_bf16 v[200:203], v[88:91], a[112:115], v[200:203]
    buffer_load_dwordx4 v9, s[16:19], s46 offen offset:1024 lds
    v_mfma_f32_16x16x32_bf16 v[216:219], v[88:91], a[116:119], v[216:219]
    v_mfma_f32_16x16x32_bf16 v[232:235], v[88:91], a[120:123], v[232:235]
    v_mfma_f32_16x16x32_bf16 v[248:251], v[88:91], a[124:127], v[248:251]
    buffer_load_dwordx4 v10, s[16:19], s46 offen offset:2048 lds
    v_mfma_f32_16x16x32_bf16 v[204:207], v[92:95], a[112:115], v[204:207]
    v_mfma_f32_16x16x32_bf16 v[220:223], v[92:95], a[116:119], v[220:223]
    v_mfma_f32_16x16x32_bf16 v[236:239], v[92:95], a[120:123], v[236:239]
    buffer_load_dwordx4 v11, s[16:19], s46 offen offset:3072 lds
    v_mfma_f32_16x16x32_bf16 v[252:255], v[92:95], a[124:127], v[252:255]
    s_waitcnt lgkmcnt(0)
    v_mfma_f32_16x16x32_bf16 a[128:131], a[96:99], v[64:67], a[128:131]
    s_waitcnt vmcnt(25)
    ds_read_b64_tr_b16 v[80:81], v12 offset:53248
    ds_read_b64_tr_b16 v[82:83], v12 offset:53760
    v_mfma_f32_16x16x32_bf16 a[132:135], a[100:103], v[64:67], a[132:135]
    ds_read_b64_tr_b16 v[84:85], v13 offset:53248
    ds_read_b64_tr_b16 v[86:87], v13 offset:53760
    v_mfma_f32_16x16x32_bf16 a[160:163], a[104:107], v[64:67], a[160:163]
    v_cmp_eq_u32 vcc, 0, v18
    s_nop 0
    s_cmp_lg_u64 vcc, 0
    s_cbranch_scc1 init_spin
    init_spin_ok:
    s_lshl_b32 s48, s2, 5
    s_lshl_b32 s49, s3, 3
    s_add_u32 s48, s48, s49
    s_add_u32 s49, s48, 0x3404000
    s_add_u32 s48, s48, 0x3402000
    s_lshl_b64 exec, 1, 63
    buffer_store_dwordx2 v[48:49], off, s[28:31], s48 sc1
    buffer_store_dwordx2 v[50:51], off, s[28:31], s49 sc1
    s_mov_b64 exec, -1
    v_mfma_f32_16x16x32_bf16 a[164:167], a[108:111], v[64:67], a[164:167]
    ds_read_b64_tr_b16 v[88:89], v14 offset:53248
    ds_read_b64_tr_b16 v[90:91], v14 offset:53760
    v_mfma_f32_16x16x32_bf16 a[136:139], a[96:99], v[68:71], a[136:139]
    ds_read_b64_tr_b16 v[92:93], v15 offset:53248
    ds_read_b64_tr_b16 v[94:95], v15 offset:53760
    v_mfma_f32_16x16x32_bf16 a[140:143], a[100:103], v[68:71], a[140:143]
    v_mfma_f32_16x16x32_bf16 a[168:171], a[104:107], v[68:71], a[168:171]
    v_mfma_f32_16x16x32_bf16 a[172:175], a[108:111], v[68:71], a[172:175]
    v_mfma_f32_16x16x32_bf16 a[144:147], a[96:99], v[72:75], a[144:147]
    v_mfma_f32_16x16x32_bf16 a[148:151], a[100:103], v[72:75], a[148:151]
    v_mfma_f32_16x16x32_bf16 a[176:179], a[104:107], v[72:75], a[176:179]
    v_mfma_f32_16x16x32_bf16 a[180:183], a[108:111], v[72:75], a[180:183]
    v_mfma_f32_16x16x32_bf16 a[152:155], a[96:99], v[76:79], a[152:155]
    v_mfma_f32_16x16x32_bf16 a[156:159], a[100:103], v[76:79], a[156:159]
    v_mfma_f32_16x16x32_bf16 a[184:187], a[104:107], v[76:79], a[184:187]
    v_mfma_f32_16x16x32_bf16 a[188:191], a[108:111], v[76:79], a[188:191]
    s_waitcnt lgkmcnt(0)
    v_mfma_f32_16x16x32_bf16 a[192:195], a[96:99], v[80:83], a[192:195]
    s_waitcnt vmcnt(38)
    ds_read_b64_tr_b16 v[64:65], v12 offset:57344
    ds_read_b64_tr_b16 v[66:67], v12 offset:57856
    v_mfma_f32_16x16x32_bf16 a[196:199], a[100:103], v[80:83], a[196:199]
    ds_read_b64_tr_b16 v[68:69], v13 offset:57344
    ds_read_b64_tr_b16 v[70:71], v13 offset:57856
    v_mfma_f32_16x16x32_bf16 a[224:227], a[104:107], v[80:83], a[224:227]
    s_load_dwordx2 s[8:9], s[0:1], 40
    s_load_dwordx2 s[80:81], s[0:1], 64
    s_load_dwordx2 s[72:73], s[0:1], 72
    s_load_dwordx2 s[60:61], s[0:1], 80
    v_mfma_f32_16x16x32_bf16 a[228:231], a[108:111], v[80:83], a[228:231]
    ds_read_b64_tr_b16 v[72:73], v14 offset:57344
    ds_read_b64_tr_b16 v[74:75], v14 offset:57856
    v_mfma_f32_16x16x32_bf16 a[200:203], a[96:99], v[84:87], a[200:203]
    ds_read_b64_tr_b16 v[76:77], v15 offset:57344
    ds_read_b64_tr_b16 v[78:79], v15 offset:57856
    v_mfma_f32_16x16x32_bf16 a[204:207], a[100:103], v[84:87], a[204:207]
    ds_read_b128 a[32:35], v16 offset:16384
    ds_read_b128 a[36:39], v16 offset:18432
    v_mfma_f32_16x16x32_bf16 a[232:235], a[104:107], v[84:87], a[232:235]
    ds_read_b128 a[40:43], v16 offset:20480
    ds_read_b128 a[44:47], v16 offset:22528
    v_mfma_f32_16x16x32_bf16 a[236:239], a[108:111], v[84:87], a[236:239]
    ds_read_b128 a[48:51], v17 offset:16384
    ds_read_b128 a[52:55], v17 offset:18432
    v_mfma_f32_16x16x32_bf16 a[208:211], a[96:99], v[88:91], a[208:211]
    ds_read_b128 a[56:59], v17 offset:20480
    ds_read_b128 a[60:63], v17 offset:22528
    v_mfma_f32_16x16x32_bf16 a[212:215], a[100:103], v[88:91], a[212:215]
    v_mfma_f32_16x16x32_bf16 a[240:243], a[104:107], v[88:91], a[240:243]
    v_mfma_f32_16x16x32_bf16 a[244:247], a[108:111], v[88:91], a[244:247]
    v_mfma_f32_16x16x32_bf16 a[216:219], a[96:99], v[92:95], a[216:219]
    v_mfma_f32_16x16x32_bf16 a[220:223], a[100:103], v[92:95], a[220:223]
    v_mfma_f32_16x16x32_bf16 a[248:251], a[104:107], v[92:95], a[248:251]
    v_mfma_f32_16x16x32_bf16 a[252:255], a[108:111], v[92:95], a[252:255]
    s_waitcnt lgkmcnt(0)
    v_mfma_f32_16x16x32_bf16 a[128:131], a[112:115], v[64:67], a[128:131]
    s_and_b32 s9, s9, 0xffff
    ds_read_b64_tr_b16 v[80:81], v12 offset:61440
    ds_read_b64_tr_b16 v[82:83], v12 offset:61952
    v_mfma_f32_16x16x32_bf16 a[132:135], a[116:119], v[64:67], a[132:135]
    s_mov_b32 s10, 0x400000
    ds_read_b64_tr_b16 v[84:85], v13 offset:61440
    ds_read_b64_tr_b16 v[86:87], v13 offset:61952
    v_mfma_f32_16x16x32_bf16 a[160:163], a[120:123], v[64:67], a[160:163]
    s_mov_b32 s11, 0x00020000
    ds_read_b64_tr_b16 v[88:89], v14 offset:61440
    ds_read_b64_tr_b16 v[90:91], v14 offset:61952
    v_mfma_f32_16x16x32_bf16 a[164:167], a[124:127], v[64:67], a[164:167]
    s_and_b32 s81, s81, 0xffff
    ds_read_b64_tr_b16 v[92:93], v15 offset:61440
    ds_read_b64_tr_b16 v[94:95], v15 offset:61952
    v_mfma_f32_16x16x32_bf16 a[136:139], a[112:115], v[68:71], a[136:139]
    s_mov_b32 s82, 0x1c0000
    v_mfma_f32_16x16x32_bf16 a[140:143], a[116:119], v[68:71], a[140:143]
    s_mov_b32 s83, 0x00020000
    v_mfma_f32_16x16x32_bf16 a[168:171], a[120:123], v[68:71], a[168:171]
    s_and_b32 s73, s73, 0xffff
    v_mfma_f32_16x16x32_bf16 a[172:175], a[124:127], v[68:71], a[172:175]
    s_mov_b32 s74, 0x1c0000
    v_mfma_f32_16x16x32_bf16 a[144:147], a[112:115], v[72:75], a[144:147]
    s_mov_b32 s75, 0x00020000
    v_mfma_f32_16x16x32_bf16 a[148:151], a[116:119], v[72:75], a[148:151]
    s_and_b32 s61, s61, 0xffff
    v_mfma_f32_16x16x32_bf16 a[176:179], a[120:123], v[72:75], a[176:179]
    s_mov_b32 s62, 0x1c0000
    v_mfma_f32_16x16x32_bf16 a[180:183], a[124:127], v[72:75], a[180:183]
    s_mov_b32 s63, 0x00020000
    v_mfma_f32_16x16x32_bf16 a[152:155], a[112:115], v[76:79], a[152:155]
    v_mfma_f32_16x16x32_bf16 a[156:159], a[116:119], v[76:79], a[156:159]
    v_mfma_f32_16x16x32_bf16 a[184:187], a[120:123], v[76:79], a[184:187]
    v_mfma_f32_16x16x32_bf16 a[188:191], a[124:127], v[76:79], a[188:191]
    s_waitcnt lgkmcnt(0)
    v_mfma_f32_16x16x32_bf16 a[192:195], a[112:115], v[80:83], a[192:195]
    s_waitcnt vmcnt(28)
    v_mfma_f32_16x16x32_bf16 a[196:199], a[116:119], v[80:83], a[196:199]
    s_barrier
    ds_read_b64_tr_b16 v[64:65], v12 offset:0
    ds_read_b64_tr_b16 v[66:67], v12 offset:512
    v_mfma_f32_16x16x32_bf16 a[224:227], a[120:123], v[80:83], a[224:227]
    s_add_u32 m0, s40, 49152
    ds_read_b64_tr_b16 v[68:69], v13 offset:0
    ds_read_b64_tr_b16 v[70:71], v13 offset:512
    v_mfma_f32_16x16x32_bf16 a[228:231], a[124:127], v[80:83], a[228:231]
    s_add_u32 s46, s41, 3145856
    ds_read_b64_tr_b16 v[72:73], v14 offset:0
    ds_read_b64_tr_b16 v[74:75], v14 offset:512
    v_mfma_f32_16x16x32_bf16 a[200:203], a[112:115], v[84:87], a[200:203]
    s_and_b32 s46, s46, 0x3fffff
    ds_read_b64_tr_b16 v[76:77], v15 offset:0
    ds_read_b64_tr_b16 v[78:79], v15 offset:512
    v_mfma_f32_16x16x32_bf16 a[204:207], a[116:119], v[84:87], a[204:207]
    buffer_load_dwordx4 v8, s[16:19], s46 offen offset:0 lds
    v_mfma_f32_16x16x32_bf16 a[232:235], a[120:123], v[84:87], a[232:235]
    v_mfma_f32_16x16x32_bf16 a[236:239], a[124:127], v[84:87], a[236:239]
    v_mfma_f32_16x16x32_bf16 a[208:211], a[112:115], v[88:91], a[208:211]
    buffer_load_dwordx4 v9, s[16:19], s46 offen offset:1024 lds
    v_mfma_f32_16x16x32_bf16 a[212:215], a[116:119], v[88:91], a[212:215]
    v_mfma_f32_16x16x32_bf16 a[240:243], a[120:123], v[88:91], a[240:243]
    v_mfma_f32_16x16x32_bf16 a[244:247], a[124:127], v[88:91], a[244:247]
    buffer_load_dwordx4 v10, s[16:19], s46 offen offset:2048 lds
    v_mfma_f32_16x16x32_bf16 a[216:219], a[112:115], v[92:95], a[216:219]
    v_mfma_f32_16x16x32_bf16 a[220:223], a[116:119], v[92:95], a[220:223]
    v_mfma_f32_16x16x32_bf16 a[248:251], a[120:123], v[92:95], a[248:251]
    buffer_load_dwordx4 v11, s[16:19], s46 offen offset:3072 lds
    v_mfma_f32_16x16x32_bf16 a[252:255], a[124:127], v[92:95], a[252:255]
    s_waitcnt lgkmcnt(0)
    v_mfma_f32_16x16x32_bf16 v[128:131], v[64:67], a[0:3], v[128:131]
    s_waitcnt vmcnt(23)
    ds_read_b64_tr_b16 v[80:81], v12 offset:4096
    ds_read_b64_tr_b16 v[82:83], v12 offset:4608
    v_mfma_f32_16x16x32_bf16 v[144:147], v[64:67], a[4:7], v[144:147]
    ds_read_b64_tr_b16 v[84:85], v13 offset:4096
    ds_read_b64_tr_b16 v[86:87], v13 offset:4608
    v_mfma_f32_16x16x32_bf16 v[160:163], v[64:67], a[8:11], v[160:163]
    ds_read_b64_tr_b16 v[88:89], v14 offset:4096
    ds_read_b64_tr_b16 v[90:91], v14 offset:4608
    v_mfma_f32_16x16x32_bf16 v[176:179], v[64:67], a[12:15], v[176:179]
    ds_read_b64_tr_b16 v[92:93], v15 offset:4096
    ds_read_b64_tr_b16 v[94:95], v15 offset:4608
    v_mfma_f32_16x16x32_bf16 v[132:135], v[68:71], a[0:3], v[132:135]
    ds_read_b128 a[64:67], v16 offset:0
    ds_read_b128 a[68:71], v16 offset:2048
    v_mfma_f32_16x16x32_bf16 v[148:151], v[68:71], a[4:7], v[148:151]
    ds_read_b128 a[72:75], v16 offset:4096
    ds_read_b128 a[76:79], v16 offset:6144
    v_mfma_f32_16x16x32_bf16 v[164:167], v[68:71], a[8:11], v[164:167]
    ds_read_b128 a[80:83], v17 offset:0
    ds_read_b128 a[84:87], v17 offset:2048
    v_mfma_f32_16x16x32_bf16 v[180:183], v[68:71], a[12:15], v[180:183]
    ds_read_b128 a[88:91], v17 offset:4096
    ds_read_b128 a[92:95], v17 offset:6144
    v_mfma_f32_16x16x32_bf16 v[136:139], v[72:75], a[0:3], v[136:139]
    v_mfma_f32_16x16x32_bf16 v[152:155], v[72:75], a[4:7], v[152:155]
    v_mfma_f32_16x16x32_bf16 v[168:171], v[72:75], a[8:11], v[168:171]
    v_mfma_f32_16x16x32_bf16 v[184:187], v[72:75], a[12:15], v[184:187]
    v_mfma_f32_16x16x32_bf16 v[140:143], v[76:79], a[0:3], v[140:143]
    v_mfma_f32_16x16x32_bf16 v[156:159], v[76:79], a[4:7], v[156:159]
    v_mfma_f32_16x16x32_bf16 v[172:175], v[76:79], a[8:11], v[172:175]
    v_mfma_f32_16x16x32_bf16 v[188:191], v[76:79], a[12:15], v[188:191]
    s_waitcnt lgkmcnt(0)
    v_mfma_f32_16x16x32_bf16 v[128:131], v[80:83], a[16:19], v[128:131]
    ds_read_b64_tr_b16 v[64:65], v12 offset:8192
    ds_read_b64_tr_b16 v[66:67], v12 offset:8704
    v_mfma_f32_16x16x32_bf16 v[144:147], v[80:83], a[20:23], v[144:147]
    ds_read_b64_tr_b16 v[68:69], v13 offset:8192
    ds_read_b64_tr_b16 v[70:71], v13 offset:8704
    v_mfma_f32_16x16x32_bf16 v[160:163], v[80:83], a[24:27], v[160:163]
    ds_read_b64_tr_b16 v[72:73], v14 offset:8192
    ds_read_b64_tr_b16 v[74:75], v14 offset:8704
    v_mfma_f32_16x16x32_bf16 v[176:179], v[80:83], a[28:31], v[176:179]
    ds_read_b64_tr_b16 v[76:77], v15 offset:8192
    ds_read_b64_tr_b16 v[78:79], v15 offset:8704
    v_mfma_f32_16x16x32_bf16 v[132:135], v[84:87], a[16:19], v[132:135]
    v_mfma_f32_16x16x32_bf16 v[148:151], v[84:87], a[20:23], v[148:151]
    v_mfma_f32_16x16x32_bf16 v[164:167], v[84:87], a[24:27], v[164:167]
    v_mfma_f32_16x16x32_bf16 v[180:183], v[84:87], a[28:31], v[180:183]
    v_mfma_f32_16x16x32_bf16 v[136:139], v[88:91], a[16:19], v[136:139]
    v_mfma_f32_16x16x32_bf16 v[152:155], v[88:91], a[20:23], v[152:155]
    v_mfma_f32_16x16x32_bf16 v[168:171], v[88:91], a[24:27], v[168:171]
    v_mfma_f32_16x16x32_bf16 v[184:187], v[88:91], a[28:31], v[184:187]
    v_mfma_f32_16x16x32_bf16 v[140:143], v[92:95], a[16:19], v[140:143]
    v_mfma_f32_16x16x32_bf16 v[156:159], v[92:95], a[20:23], v[156:159]
    v_mfma_f32_16x16x32_bf16 v[172:175], v[92:95], a[24:27], v[172:175]
    v_mfma_f32_16x16x32_bf16 v[188:191], v[92:95], a[28:31], v[188:191]
    s_waitcnt lgkmcnt(0)
    v_mfma_f32_16x16x32_bf16 v[128:131], v[64:67], a[32:35], v[128:131]
    ds_read_b64_tr_b16 v[80:81], v12 offset:12288
    ds_read_b64_tr_b16 v[82:83], v12 offset:12800
    v_mfma_f32_16x16x32_bf16 v[144:147], v[64:67], a[36:39], v[144:147]
    ds_read_b64_tr_b16 v[84:85], v13 offset:12288
    ds_read_b64_tr_b16 v[86:87], v13 offset:12800
    v_mfma_f32_16x16x32_bf16 v[160:163], v[64:67], a[40:43], v[160:163]
    ds_read_b64_tr_b16 v[88:89], v14 offset:12288
    ds_read_b64_tr_b16 v[90:91], v14 offset:12800
    v_mfma_f32_16x16x32_bf16 v[176:179], v[64:67], a[44:47], v[176:179]
    ds_read_b64_tr_b16 v[92:93], v15 offset:12288
    ds_read_b64_tr_b16 v[94:95], v15 offset:12800
    v_mfma_f32_16x16x32_bf16 v[132:135], v[68:71], a[32:35], v[132:135]
    v_and_b32 v19, 15, v1
    v_mul_u32_u24 v20, 3584, v19
    v_mfma_f32_16x16x32_bf16 v[148:151], v[68:71], a[36:39], v[148:151]
    v_lshlrev_b32 v19, 10, v19
    v_mfma_f32_16x16x32_bf16 v[164:167], v[68:71], a[40:43], v[164:167]
    s_bfe_u32 s76, s2, 0x30003
    v_mfma_f32_16x16x32_bf16 v[180:183], v[68:71], a[44:47], v[180:183]
    s_lshl_b32 s76, s76, 2
    v_mfma_f32_16x16x32_bf16 v[136:139], v[72:75], a[32:35], v[136:139]
    s_add_u32 s76, s76, s3
    v_mfma_f32_16x16x32_bf16 v[152:155], v[72:75], a[36:39], v[152:155]
    s_mul_i32 s76, s76, 57344
    v_mfma_f32_16x16x32_bf16 v[168:171], v[72:75], a[40:43], v[168:171]
    s_lshr_b32 s77, s2, 6
    v_mfma_f32_16x16x32_bf16 v[184:187], v[72:75], a[44:47], v[184:187]
    s_lshl_b32 s77, s77, 10
    v_mfma_f32_16x16x32_bf16 v[140:143], v[76:79], a[32:35], v[140:143]
    s_add_u32 s76, s76, s77
    v_mfma_f32_16x16x32_bf16 v[156:159], v[76:79], a[36:39], v[156:159]
    s_and_b32 s77, s2, 7
    v_mfma_f32_16x16x32_bf16 v[172:175], v[76:79], a[40:43], v[172:175]
    s_lshl_b32 s77, s77, 7
    v_mfma_f32_16x16x32_bf16 v[188:191], v[76:79], a[44:47], v[188:191]
    s_waitcnt lgkmcnt(0)
    v_mfma_f32_16x16x32_bf16 v[128:131], v[80:83], a[48:51], v[128:131]
    s_waitcnt vmcnt(18)
    v_mfma_f32_16x16x32_bf16 v[144:147], v[80:83], a[52:55], v[144:147]
    s_barrier
    ds_read_b64_tr_b16 v[64:65], v12 offset:16384
    ds_read_b64_tr_b16 v[66:67], v12 offset:16896
    v_mfma_f32_16x16x32_bf16 v[160:163], v[80:83], a[56:59], v[160:163]
    s_add_u32 m0, s40, 0
    ds_read_b64_tr_b16 v[68:69], v13 offset:16384
    ds_read_b64_tr_b16 v[70:71], v13 offset:16896
    v_mfma_f32_16x16x32_bf16 v[176:179], v[80:83], a[60:63], v[176:179]
    s_add_u32 s46, s41, 2097152
    ds_read_b64_tr_b16 v[72:73], v14 offset:16384
    ds_read_b64_tr_b16 v[74:75], v14 offset:16896
    v_mfma_f32_16x16x32_bf16 v[132:135], v[84:87], a[48:51], v[132:135]
    s_and_b32 s46, s46, 0x3fffff
    ds_read_b64_tr_b16 v[76:77], v15 offset:16384
    ds_read_b64_tr_b16 v[78:79], v15 offset:16896
    v_mfma_f32_16x16x32_bf16 v[148:151], v[84:87], a[52:55], v[148:151]
    s_add_u32 s76, s76, s77
    buffer_load_dwordx4 v8, s[20:23], s46 offen offset:0 lds
    v_mfma_f32_16x16x32_bf16 v[164:167], v[84:87], a[56:59], v[164:167]
    v_mfma_f32_16x16x32_bf16 v[180:183], v[84:87], a[60:63], v[180:183]
    v_mfma_f32_16x16x32_bf16 v[136:139], v[88:91], a[48:51], v[136:139]
    buffer_load_dwordx4 v9, s[20:23], s46 offen offset:1024 lds
    v_mfma_f32_16x16x32_bf16 v[152:155], v[88:91], a[52:55], v[152:155]
    v_mfma_f32_16x16x32_bf16 v[168:171], v[88:91], a[56:59], v[168:171]
    v_mfma_f32_16x16x32_bf16 v[184:187], v[88:91], a[60:63], v[184:187]
    buffer_load_dwordx4 v10, s[20:23], s46 offen offset:2048 lds
    v_mfma_f32_16x16x32_bf16 v[140:143], v[92:95], a[48:51], v[140:143]
    v_mfma_f32_16x16x32_bf16 v[156:159], v[92:95], a[52:55], v[156:159]
    v_mfma_f32_16x16x32_bf16 v[172:175], v[92:95], a[56:59], v[172:175]
    buffer_load_dwordx4 v11, s[20:23], s46 offen offset:3072 lds
    v_mfma_f32_16x16x32_bf16 v[188:191], v[92:95], a[60:63], v[188:191]
    s_waitcnt lgkmcnt(0)
    v_mfma_f32_16x16x32_bf16 v[128:131], v[64:67], a[64:67], v[128:131]
    s_waitcnt vmcnt(14)
    ds_read_b64_tr_b16 v[80:81], v12 offset:20480
    ds_read_b64_tr_b16 v[82:83], v12 offset:20992
    v_mfma_f32_16x16x32_bf16 v[144:147], v[64:67], a[68:71], v[144:147]
    ds_read_b64_tr_b16 v[84:85], v13 offset:20480
    ds_read_b64_tr_b16 v[86:87], v13 offset:20992
    v_mfma_f32_16x16x32_bf16 v[160:163], v[64:67], a[72:75], v[160:163]
    ds_read_b64_tr_b16 v[88:89], v14 offset:20480
    ds_read_b64_tr_b16 v[90:91], v14 offset:20992
    v_mfma_f32_16x16x32_bf16 v[176:179], v[64:67], a[76:79], v[176:179]
    ds_read_b64_tr_b16 v[92:93], v15 offset:20480
    ds_read_b64_tr_b16 v[94:95], v15 offset:20992
    v_mfma_f32_16x16x32_bf16 v[132:135], v[68:71], a[64:67], v[132:135]
    ds_read_b128 a[96:99], v16 offset:8192
    ds_read_b128 a[100:103], v16 offset:10240
    v_mfma_f32_16x16x32_bf16 v[148:151], v[68:71], a[68:71], v[148:151]
    ds_read_b128 a[104:107], v16 offset:12288
    ds_read_b128 a[108:111], v16 offset:14336
    v_mfma_f32_16x16x32_bf16 v[164:167], v[68:71], a[72:75], v[164:167]
    ds_read_b128 a[112:115], v17 offset:8192
    ds_read_b128 a[116:119], v17 offset:10240
    v_mfma_f32_16x16x32_bf16 v[180:183], v[68:71], a[76:79], v[180:183]
    ds_read_b128 a[120:123], v17 offset:12288
    ds_read_b128 a[124:127], v17 offset:14336
    v_mfma_f32_16x16x32_bf16 v[136:139], v[72:75], a[64:67], v[136:139]
    buffer_load_dword v31, v20, s[80:83], s76 offen
    v_mfma_f32_16x16x32_bf16 v[152:155], v[72:75], a[68:71], v[152:155]
    v_mfma_f32_16x16x32_bf16 v[168:171], v[72:75], a[72:75], v[168:171]
    v_mfma_f32_16x16x32_bf16 v[184:187], v[72:75], a[76:79], v[184:187]
    v_mfma_f32_16x16x32_bf16 v[140:143], v[76:79], a[64:67], v[140:143]
    v_mfma_f32_16x16x32_bf16 v[156:159], v[76:79], a[68:71], v[156:159]
    v_mfma_f32_16x16x32_bf16 v[172:175], v[76:79], a[72:75], v[172:175]
    v_mfma_f32_16x16x32_bf16 v[188:191], v[76:79], a[76:79], v[188:191]
    s_waitcnt lgkmcnt(0)
    v_mfma_f32_16x16x32_bf16 v[128:131], v[80:83], a[80:83], v[128:131]
    ds_read_b64_tr_b16 v[64:65], v12 offset:24576
    ds_read_b64_tr_b16 v[66:67], v12 offset:25088
    v_mfma_f32_16x16x32_bf16 v[144:147], v[80:83], a[84:87], v[144:147]
    ds_read_b64_tr_b16 v[68:69], v13 offset:24576
    ds_read_b64_tr_b16 v[70:71], v13 offset:25088
    v_mfma_f32_16x16x32_bf16 v[160:163], v[80:83], a[88:91], v[160:163]
    ds_read_b64_tr_b16 v[72:73], v14 offset:24576
    ds_read_b64_tr_b16 v[74:75], v14 offset:25088
    v_mfma_f32_16x16x32_bf16 v[176:179], v[80:83], a[92:95], v[176:179]
    ds_read_b64_tr_b16 v[76:77], v15 offset:24576
    ds_read_b64_tr_b16 v[78:79], v15 offset:25088
    v_mfma_f32_16x16x32_bf16 v[132:135], v[84:87], a[80:83], v[132:135]
    v_mfma_f32_16x16x32_bf16 v[148:151], v[84:87], a[84:87], v[148:151]
    v_mfma_f32_16x16x32_bf16 v[164:167], v[84:87], a[88:91], v[164:167]
    v_mfma_f32_16x16x32_bf16 v[180:183], v[84:87], a[92:95], v[180:183]
    v_mfma_f32_16x16x32_bf16 v[136:139], v[88:91], a[80:83], v[136:139]
    buffer_load_dword v31, v20, s[72:75], s76 offen
    v_mfma_f32_16x16x32_bf16 v[152:155], v[88:91], a[84:87], v[152:155]
    s_lshr_b32 s76, s2, 3
    v_mfma_f32_16x16x32_bf16 v[168:171], v[88:91], a[88:91], v[168:171]
    s_lshl_b32 s76, s76, 2
    v_mfma_f32_16x16x32_bf16 v[184:187], v[88:91], a[92:95], v[184:187]
    s_add_u32 s76, s76, s3
    v_mfma_f32_16x16x32_bf16 v[140:143], v[92:95], a[80:83], v[140:143]
    s_mul_i32 s76, s76, 14336
    v_mfma_f32_16x16x32_bf16 v[156:159], v[92:95], a[84:87], v[156:159]
    s_add_u32 s76, s76, s77
    v_mfma_f32_16x16x32_bf16 v[172:175], v[92:95], a[88:91], v[172:175]
    v_mfma_f32_16x16x32_bf16 v[188:191], v[92:95], a[92:95], v[188:191]
    s_waitcnt lgkmcnt(0)
    v_mfma_f32_16x16x32_bf16 v[128:131], v[64:67], a[96:99], v[128:131]
    ds_read_b64_tr_b16 v[80:81], v12 offset:28672
    ds_read_b64_tr_b16 v[82:83], v12 offset:29184
    v_mfma_f32_16x16x32_bf16 v[144:147], v[64:67], a[100:103], v[144:147]
    ds_read_b64_tr_b16 v[84:85], v13 offset:28672
    ds_read_b64_tr_b16 v[86:87], v13 offset:29184
    v_mfma_f32_16x16x32_bf16 v[160:163], v[64:67], a[104:107], v[160:163]
    ds_read_b64_tr_b16 v[88:89], v14 offset:28672
    ds_read_b64_tr_b16 v[90:91], v14 offset:29184
    v_mfma_f32_16x16x32_bf16 v[176:179], v[64:67], a[108:111], v[176:179]
    ds_read_b64_tr_b16 v[92:93], v15 offset:28672
    ds_read_b64_tr_b16 v[94:95], v15 offset:29184
    v_mfma_f32_16x16x32_bf16 v[132:135], v[68:71], a[96:99], v[132:135]
    v_mfma_f32_16x16x32_bf16 v[148:151], v[68:71], a[100:103], v[148:151]
    v_mfma_f32_16x16x32_bf16 v[164:167], v[68:71], a[104:107], v[164:167]
    v_mfma_f32_16x16x32_bf16 v[180:183], v[68:71], a[108:111], v[180:183]
    v_mfma_f32_16x16x32_bf16 v[136:139], v[72:75], a[96:99], v[136:139]
    buffer_load_dword v31, v19, s[60:63], s76 offen
    v_mfma_f32_16x16x32_bf16 v[152:155], v[72:75], a[100:103], v[152:155]
    v_mfma_f32_16x16x32_bf16 v[168:171], v[72:75], a[104:107], v[168:171]
    v_mfma_f32_16x16x32_bf16 v[184:187], v[72:75], a[108:111], v[184:187]
    v_mfma_f32_16x16x32_bf16 v[140:143], v[76:79], a[96:99], v[140:143]
    v_mfma_f32_16x16x32_bf16 v[156:159], v[76:79], a[100:103], v[156:159]
    v_mfma_f32_16x16x32_bf16 v[172:175], v[76:79], a[104:107], v[172:175]
    v_mfma_f32_16x16x32_bf16 v[188:191], v[76:79], a[108:111], v[188:191]
    s_waitcnt lgkmcnt(0)
    v_mfma_f32_16x16x32_bf16 v[128:131], v[80:83], a[112:115], v[128:131]
    s_waitcnt vmcnt(13)
    v_mfma_f32_16x16x32_bf16 v[144:147], v[80:83], a[116:119], v[144:147]
    s_barrier
    ds_read_b64_tr_b16 v[64:65], v12 offset:32768
    ds_read_b64_tr_b16 v[66:67], v12 offset:33280
    v_mfma_f32_16x16x32_bf16 v[160:163], v[80:83], a[120:123], v[160:163]
    s_add_u32 m0, s40, 16384
    ds_read_b64_tr_b16 v[68:69], v13 offset:32768
    ds_read_b64_tr_b16 v[70:71], v13 offset:33280
    v_mfma_f32_16x16x32_bf16 v[176:179], v[80:83], a[124:127], v[176:179]
    s_add_u32 s46, s41, 3145728
    ds_read_b64_tr_b16 v[72:73], v14 offset:32768
    ds_read_b64_tr_b16 v[74:75], v14 offset:33280
    v_mfma_f32_16x16x32_bf16 v[132:135], v[84:87], a[112:115], v[132:135]
    s_and_b32 s46, s46, 0x3fffff
    ds_read_b64_tr_b16 v[76:77], v15 offset:32768
    ds_read_b64_tr_b16 v[78:79], v15 offset:33280
    v_mfma_f32_16x16x32_bf16 v[148:151], v[84:87], a[116:119], v[148:151]
    buffer_load_dwordx4 v8, s[20:23], s46 offen offset:0 lds
    v_mfma_f32_16x16x32_bf16 v[164:167], v[84:87], a[120:123], v[164:167]
    v_mfma_f32_16x16x32_bf16 v[180:183], v[84:87], a[124:127], v[180:183]
    v_mfma_f32_16x16x32_bf16 v[136:139], v[88:91], a[112:115], v[136:139]
    buffer_load_dwordx4 v9, s[20:23], s46 offen offset:1024 lds
    v_mfma_f32_16x16x32_bf16 v[152:155], v[88:91], a[116:119], v[152:155]
    v_mfma_f32_16x16x32_bf16 v[168:171], v[88:91], a[120:123], v[168:171]
    v_mfma_f32_16x16x32_bf16 v[184:187], v[88:91], a[124:127], v[184:187]
    buffer_load_dwordx4 v10, s[20:23], s46 offen offset:2048 lds
    v_mfma_f32_16x16x32_bf16 v[140:143], v[92:95], a[112:115], v[140:143]
    v_mfma_f32_16x16x32_bf16 v[156:159], v[92:95], a[116:119], v[156:159]
    v_mfma_f32_16x16x32_bf16 v[172:175], v[92:95], a[120:123], v[172:175]
    buffer_load_dwordx4 v11, s[20:23], s46 offen offset:3072 lds
    v_mfma_f32_16x16x32_bf16 v[188:191], v[92:95], a[124:127], v[188:191]
    s_waitcnt lgkmcnt(0)
    v_mfma_f32_16x16x32_bf16 v[192:195], v[64:67], a[0:3], v[192:195]
    s_add_u32 s37, s45, 0
    ds_read_b64_tr_b16 v[80:81], v12 offset:36864
    ds_read_b64_tr_b16 v[82:83], v12 offset:37376
    v_mfma_f32_16x16x32_bf16 v[208:211], v[64:67], a[4:7], v[208:211]
    s_and_b32 s37, s37, 0x3ff
    ds_read_b64_tr_b16 v[84:85], v13 offset:36864
    ds_read_b64_tr_b16 v[86:87], v13 offset:37376
    v_mfma_f32_16x16x32_bf16 v[224:227], v[64:67], a[8:11], v[224:227]
    s_add_u32 m0, s36, 0
    ds_read_b64_tr_b16 v[88:89], v14 offset:36864
    ds_read_b64_tr_b16 v[90:91], v14 offset:37376
    v_mfma_f32_16x16x32_bf16 v[240:243], v[64:67], a[12:15], v[240:243]
    s_add_u32 s46, s34, s37
    ds_read_b64_tr_b16 v[92:93], v15 offset:36864
    ds_read_b64_tr_b16 v[94:95], v15 offset:37376
    v_mfma_f32_16x16x32_bf16 v[196:199], v[68:71], a[0:3], v[196:199]
    s_add_u32 s47, s42, 0
    buffer_load_dwordx4 v4, s[12:15], s46 offen offset:0 lds
    v_mfma_f32_16x16x32_bf16 v[212:215], v[68:71], a[4:7], v[212:215]
    s_lshl_b32 s70, s4, 7
    v_mul_f32 v128, s44, v128
    v_mul_f32 v129, s44, v129
    v_mfma_f32_16x16x32_bf16 v[228:231], v[68:71], a[8:11], v[228:231]
    s_lshl_b32 s71, s5, 2
    v_mul_f32 v130, s44, v130
    v_mul_f32 v131, s44, v131
    v_mfma_f32_16x16x32_bf16 v[244:247], v[68:71], a[12:15], v[244:247]
    s_add_u32 s70, s70, s71
    buffer_load_dwordx4 v5, s[12:15], s46 offen offset:1024 lds
    v_mfma_f32_16x16x32_bf16 v[200:203], v[72:75], a[0:3], v[200:203]
    s_add_u32 s70, s70, 0x3400000
    v_mul_f32 v132, s44, v132
    v_mul_f32 v133, s44, v133
    v_mfma_f32_16x16x32_bf16 v[216:219], v[72:75], a[4:7], v[216:219]
    s_lshr_b32 s78, s2, 6
    v_mul_f32 v134, s44, v134
    v_mul_f32 v135, s44, v135
    v_mfma_f32_16x16x32_bf16 v[232:235], v[72:75], a[8:11], v[232:235]
    s_lshl_b32 s78, s78, 3
    buffer_load_dwordx4 v6, s[12:15], s46 offen offset:2048 lds
    v_mfma_f32_16x16x32_bf16 v[248:251], v[72:75], a[12:15], v[248:251]
    s_and_b32 s79, s2, 7
    v_cvt_pk_bf16_f32 v128, v128, v129
    v_cvt_pk_bf16_f32 v129, v130, v131
    v_mfma_f32_16x16x32_bf16 v[204:207], v[76:79], a[0:3], v[204:207]
    s_add_u32 s78, s78, s79
    v_cvt_pk_bf16_f32 v130, v132, v133
    v_cvt_pk_bf16_f32 v131, v134, v135
    v_mfma_f32_16x16x32_bf16 v[220:223], v[76:79], a[4:7], v[220:223]
    s_lshl_b32 s78, s78, 3
    buffer_store_dwordx4 v[128:131], v2, s[28:31], s47 offen offset:0 sc1
    v_mfma_f32_16x16x32_bf16 v[236:239], v[76:79], a[8:11], v[236:239]
    s_bfe_u32 s79, s2, 0x30003
    v_mul_f32 v144, s44, v144
    v_mul_f32 v145, s44, v145
    v_mfma_f32_16x16x32_bf16 v[252:255], v[76:79], a[12:15], v[252:255]
    s_waitcnt lgkmcnt(0)
    v_mul_f32 v146, s44, v146
    v_mul_f32 v147, s44, v147
    v_mfma_f32_16x16x32_bf16 v[192:195], v[80:83], a[16:19], v[192:195]
    s_add_u32 s78, s78, s79
    ds_read_b64_tr_b16 v[64:65], v12 offset:40960
    ds_read_b64_tr_b16 v[66:67], v12 offset:41472
    v_mfma_f32_16x16x32_bf16 v[208:211], v[80:83], a[20:23], v[208:211]
    s_lshl_b32 s68, s78, 4
    ds_read_b64_tr_b16 v[68:69], v13 offset:40960
    ds_read_b64_tr_b16 v[70:71], v13 offset:41472
    v_mfma_f32_16x16x32_bf16 v[224:227], v[80:83], a[24:27], v[224:227]
    ds_read_b64_tr_b16 v[72:73], v14 offset:40960
    ds_read_b64_tr_b16 v[74:75], v14 offset:41472
    v_mfma_f32_16x16x32_bf16 v[240:243], v[80:83], a[28:31], v[240:243]
    ds_read_b64_tr_b16 v[76:77], v15 offset:40960
    ds_read_b64_tr_b16 v[78:79], v15 offset:41472
    v_mfma_f32_16x16x32_bf16 v[196:199], v[84:87], a[16:19], v[196:199]
    buffer_load_dwordx4 v7, s[12:15], s46 offen offset:3072 lds
    v_mfma_f32_16x16x32_bf16 v[212:215], v[84:87], a[20:23], v[212:215]
    s_add_u32 m0, s36, 4096
    v_mul_f32 v148, s44, v148
    v_mul_f32 v149, s44, v149
    v_mfma_f32_16x16x32_bf16 v[228:231], v[84:87], a[24:27], v[228:231]
    s_add_u32 s46, s35, s37
    v_mul_f32 v150, s44, v150
    v_mul_f32 v151, s44, v151
    v_mfma_f32_16x16x32_bf16 v[244:247], v[84:87], a[28:31], v[244:247]
    buffer_load_dwordx4 v4, s[12:15], s46 offen offset:0 lds
    v_mfma_f32_16x16x32_bf16 v[200:203], v[88:91], a[16:19], v[200:203]
    v_cvt_pk_bf16_f32 v144, v144, v145
    v_cvt_pk_bf16_f32 v145, v146, v147
    v_mfma_f32_16x16x32_bf16 v[216:219], v[88:91], a[20:23], v[216:219]
    v_cvt_pk_bf16_f32 v146, v148, v149
    v_cvt_pk_bf16_f32 v147, v150, v151
    v_mfma_f32_16x16x32_bf16 v[232:235], v[88:91], a[24:27], v[232:235]
    buffer_load_dwordx4 v5, s[12:15], s46 offen offset:1024 lds
    v_mfma_f32_16x16x32_bf16 v[248:251], v[88:91], a[28:31], v[248:251]
    v_mul_u32_u24 v21, 3584, v1
    v_mfma_f32_16x16x32_bf16 v[204:207], v[92:95], a[16:19], v[204:207]
    s_mul_i32 s78, s3, 458752
    v_mfma_f32_16x16x32_bf16 v[220:223], v[92:95], a[20:23], v[220:223]
    s_add_u32 s78, s78, s68
    buffer_load_dwordx4 v6, s[12:15], s46 offen offset:2048 lds
    v_mfma_f32_16x16x32_bf16 v[236:239], v[92:95], a[24:27], v[236:239]
    s_add_u32 s79, s78, 229376
    v_mfma_f32_16x16x32_bf16 v[252:255], v[92:95], a[28:31], v[252:255]
    s_waitcnt lgkmcnt(0)
    v_mfma_f32_16x16x32_bf16 v[192:195], v[64:67], a[32:35], v[192:195]
    ds_read_b64_tr_b16 v[80:81], v12 offset:45056
    ds_read_b64_tr_b16 v[82:83], v12 offset:45568
    v_mfma_f32_16x16x32_bf16 v[208:211], v[64:67], a[36:39], v[208:211]
    ds_read_b64_tr_b16 v[84:85], v13 offset:45056
    ds_read_b64_tr_b16 v[86:87], v13 offset:45568
    v_mfma_f32_16x16x32_bf16 v[224:227], v[64:67], a[40:43], v[224:227]
    ds_read_b64_tr_b16 v[88:89], v14 offset:45056
    ds_read_b64_tr_b16 v[90:91], v14 offset:45568
    v_mfma_f32_16x16x32_bf16 v[240:243], v[64:67], a[44:47], v[240:243]
    ds_read_b64_tr_b16 v[92:93], v15 offset:45056
    ds_read_b64_tr_b16 v[94:95], v15 offset:45568
    v_mfma_f32_16x16x32_bf16 v[196:199], v[68:71], a[32:35], v[196:199]
    buffer_store_dwordx4 v[144:147], v2, s[28:31], s47 offen offset:1024 sc1
    v_mfma_f32_16x16x32_bf16 v[212:215], v[68:71], a[36:39], v[212:215]
    v_mul_f32 v136, s44, v136
    v_mul_f32 v137, s44, v137
    v_mfma_f32_16x16x32_bf16 v[228:231], v[68:71], a[40:43], v[228:231]
    v_mul_f32 v138, s44, v138
    v_mul_f32 v139, s44, v139
    v_mfma_f32_16x16x32_bf16 v[244:247], v[68:71], a[44:47], v[244:247]
    buffer_load_dwordx4 v7, s[12:15], s46 offen offset:3072 lds
    v_mfma_f32_16x16x32_bf16 v[200:203], v[72:75], a[32:35], v[200:203]
    v_mul_f32 v140, s44, v140
    v_mul_f32 v141, s44, v141
    v_mfma_f32_16x16x32_bf16 v[216:219], v[72:75], a[36:39], v[216:219]
    v_mul_f32 v142, s44, v142
    v_mul_f32 v143, s44, v143
    v_mfma_f32_16x16x32_bf16 v[232:235], v[72:75], a[40:43], v[232:235]
    v_cvt_pk_bf16_f32 v136, v136, v137
    v_cvt_pk_bf16_f32 v137, v138, v139
    v_mfma_f32_16x16x32_bf16 v[248:251], v[72:75], a[44:47], v[248:251]
    v_cvt_pk_bf16_f32 v138, v140, v141
    v_cvt_pk_bf16_f32 v139, v142, v143
    v_mfma_f32_16x16x32_bf16 v[204:207], v[76:79], a[32:35], v[204:207]
    v_mfma_f32_16x16x32_bf16 v[220:223], v[76:79], a[36:39], v[220:223]
    v_mfma_f32_16x16x32_bf16 v[236:239], v[76:79], a[40:43], v[236:239]
    v_mfma_f32_16x16x32_bf16 v[252:255], v[76:79], a[44:47], v[252:255]
    s_waitcnt lgkmcnt(0)
    v_mfma_f32_16x16x32_bf16 v[192:195], v[80:83], a[48:51], v[192:195]
    s_waitcnt vmcnt(21)
    v_mfma_f32_16x16x32_bf16 v[208:211], v[80:83], a[52:55], v[208:211]
    s_barrier
    ds_read_b64_tr_b16 v[64:65], v12 offset:49152
    ds_read_b64_tr_b16 v[66:67], v12 offset:49664
    v_mfma_f32_16x16x32_bf16 v[224:227], v[80:83], a[56:59], v[224:227]
    s_add_u32 m0, s40, 32768
    ds_read_b64_tr_b16 v[68:69], v13 offset:49152
    ds_read_b64_tr_b16 v[70:71], v13 offset:49664
    v_mfma_f32_16x16x32_bf16 v[240:243], v[80:83], a[60:63], v[240:243]
    s_add_u32 s46, s41, 2097280
    ds_read_b64_tr_b16 v[72:73], v14 offset:49152
    ds_read_b64_tr_b16 v[74:75], v14 offset:49664
    v_mfma_f32_16x16x32_bf16 v[196:199], v[84:87], a[48:51], v[196:199]
    s_and_b32 s46, s46, 0x3fffff
    ds_read_b64_tr_b16 v[76:77], v15 offset:49152
    ds_read_b64_tr_b16 v[78:79], v15 offset:49664
    v_mfma_f32_16x16x32_bf16 v[212:215], v[84:87], a[52:55], v[212:215]
    buffer_load_dwordx4 v8, s[20:23], s46 offen offset:0 lds
    v_mfma_f32_16x16x32_bf16 v[228:231], v[84:87], a[56:59], v[228:231]
    v_mfma_f32_16x16x32_bf16 v[244:247], v[84:87], a[60:63], v[244:247]
    v_mfma_f32_16x16x32_bf16 v[200:203], v[88:91], a[48:51], v[200:203]
    buffer_store_dwordx4 v[136:139], v2, s[28:31], s47 offen offset:2048 sc1
    v_mfma_f32_16x16x32_bf16 v[216:219], v[88:91], a[52:55], v[216:219]
    v_mul_f32 v152, s44, v152
    v_mul_f32 v153, s44, v153
    v_mfma_f32_16x16x32_bf16 v[232:235], v[88:91], a[56:59], v[232:235]
    v_mul_f32 v154, s44, v154
    v_mul_f32 v155, s44, v155
    v_mfma_f32_16x16x32_bf16 v[248:251], v[88:91], a[60:63], v[248:251]
    buffer_load_dwordx4 v9, s[20:23], s46 offen offset:1024 lds
    v_mfma_f32_16x16x32_bf16 v[204:207], v[92:95], a[48:51], v[204:207]
    v_mul_f32 v156, s44, v156
    v_mul_f32 v157, s44, v157
    v_mfma_f32_16x16x32_bf16 v[220:223], v[92:95], a[52:55], v[220:223]
    v_mul_f32 v158, s44, v158
    v_mul_f32 v159, s44, v159
    v_mfma_f32_16x16x32_bf16 v[236:239], v[92:95], a[56:59], v[236:239]
    buffer_load_dwordx4 v10, s[20:23], s46 offen offset:2048 lds
    v_mfma_f32_16x16x32_bf16 v[252:255], v[92:95], a[60:63], v[252:255]
    s_waitcnt lgkmcnt(0)
    v_cvt_pk_bf16_f32 v152, v152, v153
    v_cvt_pk_bf16_f32 v153, v154, v155
    v_mfma_f32_16x16x32_bf16 v[192:195], v[64:67], a[64:67], v[192:195]
    ds_read_b64_tr_b16 v[80:81], v12 offset:53248
    ds_read_b64_tr_b16 v[82:83], v12 offset:53760
    v_mfma_f32_16x16x32_bf16 v[208:211], v[64:67], a[68:71], v[208:211]
    ds_read_b64_tr_b16 v[84:85], v13 offset:53248
    ds_read_b64_tr_b16 v[86:87], v13 offset:53760
    v_mfma_f32_16x16x32_bf16 v[224:227], v[64:67], a[72:75], v[224:227]
    ds_read_b64_tr_b16 v[88:89], v14 offset:53248
    ds_read_b64_tr_b16 v[90:91], v14 offset:53760
    v_mfma_f32_16x16x32_bf16 v[240:243], v[64:67], a[76:79], v[240:243]
    ds_read_b64_tr_b16 v[92:93], v15 offset:53248
    ds_read_b64_tr_b16 v[94:95], v15 offset:53760
    v_mfma_f32_16x16x32_bf16 v[196:199], v[68:71], a[64:67], v[196:199]
    buffer_load_dwordx4 v11, s[20:23], s46 offen offset:3072 lds
    v_mfma_f32_16x16x32_bf16 v[212:215], v[68:71], a[68:71], v[212:215]
    s_add_u32 s37, s45, 128
    v_cvt_pk_bf16_f32 v154, v156, v157
    v_cvt_pk_bf16_f32 v155, v158, v159
    v_mfma_f32_16x16x32_bf16 v[228:231], v[68:71], a[72:75], v[228:231]
    s_and_b32 s37, s37, 0x3ff
    v_mfma_f32_16x16x32_bf16 v[244:247], v[68:71], a[76:79], v[244:247]
    s_add_u32 m0, s36, 8192
    v_mfma_f32_16x16x32_bf16 v[200:203], v[72:75], a[64:67], v[200:203]
    s_add_u32 s46, s34, s37
    buffer_load_dwordx4 v4, s[12:15], s46 offen offset:0 lds
    v_mfma_f32_16x16x32_bf16 v[216:219], v[72:75], a[68:71], v[216:219]
    v_mfma_f32_16x16x32_bf16 v[232:235], v[72:75], a[72:75], v[232:235]
    v_mfma_f32_16x16x32_bf16 v[248:251], v[72:75], a[76:79], v[248:251]
    buffer_load_dwordx4 v5, s[12:15], s46 offen offset:1024 lds
    v_mfma_f32_16x16x32_bf16 v[204:207], v[76:79], a[64:67], v[204:207]
    v_mfma_f32_16x16x32_bf16 v[220:223], v[76:79], a[68:71], v[220:223]
    v_mfma_f32_16x16x32_bf16 v[236:239], v[76:79], a[72:75], v[236:239]
    buffer_store_dwordx4 v[152:155], v2, s[28:31], s47 offen offset:3072 sc1
    v_mfma_f32_16x16x32_bf16 v[252:255], v[76:79], a[76:79], v[252:255]
    s_waitcnt lgkmcnt(0)
    v_mfma_f32_16x16x32_bf16 v[192:195], v[80:83], a[80:83], v[192:195]
    ds_read_b64_tr_b16 v[64:65], v12 offset:57344
    ds_read_b64_tr_b16 v[66:67], v12 offset:57856
    v_mfma_f32_16x16x32_bf16 v[208:211], v[80:83], a[84:87], v[208:211]
    ds_read_b64_tr_b16 v[68:69], v13 offset:57344
    ds_read_b64_tr_b16 v[70:71], v13 offset:57856
    v_mfma_f32_16x16x32_bf16 v[224:227], v[80:83], a[88:91], v[224:227]
    ds_read_b64_tr_b16 v[72:73], v14 offset:57344
    ds_read_b64_tr_b16 v[74:75], v14 offset:57856
    v_mfma_f32_16x16x32_bf16 v[240:243], v[80:83], a[92:95], v[240:243]
    ds_read_b64_tr_b16 v[76:77], v15 offset:57344
    ds_read_b64_tr_b16 v[78:79], v15 offset:57856
    v_mfma_f32_16x16x32_bf16 v[196:199], v[84:87], a[80:83], v[196:199]
    s_add_u32 s47, s42, 16384
    buffer_load_dwordx4 v6, s[12:15], s46 offen offset:2048 lds
    v_mfma_f32_16x16x32_bf16 v[212:215], v[84:87], a[84:87], v[212:215]
    v_mul_f32 v160, s44, v160
    v_mul_f32 v161, s44, v161
    v_mfma_f32_16x16x32_bf16 v[228:231], v[84:87], a[88:91], v[228:231]
    v_mul_f32 v162, s44, v162
    v_mul_f32 v163, s44, v163
    v_mfma_f32_16x16x32_bf16 v[244:247], v[84:87], a[92:95], v[244:247]
    buffer_load_dwordx4 v7, s[12:15], s46 offen offset:3072 lds
    v_mfma_f32_16x16x32_bf16 v[200:203], v[88:91], a[80:83], v[200:203]
    s_add_u32 m0, s36, 12288
    v_mul_f32 v164, s44, v164
    v_mul_f32 v165, s44, v165
    v_mfma_f32_16x16x32_bf16 v[216:219], v[88:91], a[84:87], v[216:219]
    s_add_u32 s46, s35, s37
    v_mul_f32 v166, s44, v166
    v_mul_f32 v167, s44, v167
    v_mfma_f32_16x16x32_bf16 v[232:235], v[88:91], a[88:91], v[232:235]
    buffer_load_dwordx4 v4, s[12:15], s46 offen offset:0 lds
    v_mfma_f32_16x16x32_bf16 v[248:251], v[88:91], a[92:95], v[248:251]
    v_cvt_pk_bf16_f32 v160, v160, v161
    v_cvt_pk_bf16_f32 v161, v162, v163
    v_mfma_f32_16x16x32_bf16 v[204:207], v[92:95], a[80:83], v[204:207]
    v_cvt_pk_bf16_f32 v162, v164, v165
    v_cvt_pk_bf16_f32 v163, v166, v167
    v_mfma_f32_16x16x32_bf16 v[220:223], v[92:95], a[84:87], v[220:223]
    buffer_load_dwordx4 v5, s[12:15], s46 offen offset:1024 lds
    v_mfma_f32_16x16x32_bf16 v[236:239], v[92:95], a[88:91], v[236:239]
    v_mfma_f32_16x16x32_bf16 v[252:255], v[92:95], a[92:95], v[252:255]
    s_waitcnt lgkmcnt(0)
    v_mfma_f32_16x16x32_bf16 v[192:195], v[64:67], a[96:99], v[192:195]
    ds_read_b64_tr_b16 v[80:81], v12 offset:61440
    ds_read_b64_tr_b16 v[82:83], v12 offset:61952
    v_mfma_f32_16x16x32_bf16 v[208:211], v[64:67], a[100:103], v[208:211]
    ds_read_b64_tr_b16 v[84:85], v13 offset:61440
    ds_read_b64_tr_b16 v[86:87], v13 offset:61952
    v_mfma_f32_16x16x32_bf16 v[224:227], v[64:67], a[104:107], v[224:227]
    ds_read_b64_tr_b16 v[88:89], v14 offset:61440
    ds_read_b64_tr_b16 v[90:91], v14 offset:61952
    v_mfma_f32_16x16x32_bf16 v[240:243], v[64:67], a[108:111], v[240:243]
    ds_read_b64_tr_b16 v[92:93], v15 offset:61440
    ds_read_b64_tr_b16 v[94:95], v15 offset:61952
    v_mfma_f32_16x16x32_bf16 v[196:199], v[68:71], a[96:99], v[196:199]
    buffer_store_dwordx4 v[160:163], v2, s[28:31], s47 offen offset:0 sc1
    v_mfma_f32_16x16x32_bf16 v[212:215], v[68:71], a[100:103], v[212:215]
    v_mul_f32 v176, s44, v176
    v_mul_f32 v177, s44, v177
    v_mfma_f32_16x16x32_bf16 v[228:231], v[68:71], a[104:107], v[228:231]
    v_mul_f32 v178, s44, v178
    v_mul_f32 v179, s44, v179
    v_mfma_f32_16x16x32_bf16 v[244:247], v[68:71], a[108:111], v[244:247]
    buffer_load_dwordx4 v6, s[12:15], s46 offen offset:2048 lds
    v_mfma_f32_16x16x32_bf16 v[200:203], v[72:75], a[96:99], v[200:203]
    v_mul_f32 v180, s44, v180
    v_mul_f32 v181, s44, v181
    v_mfma_f32_16x16x32_bf16 v[216:219], v[72:75], a[100:103], v[216:219]
    v_mul_f32 v182, s44, v182
    v_mul_f32 v183, s44, v183
    v_mfma_f32_16x16x32_bf16 v[232:235], v[72:75], a[104:107], v[232:235]
    buffer_load_dwordx4 v7, s[12:15], s46 offen offset:3072 lds
    v_mfma_f32_16x16x32_bf16 v[248:251], v[72:75], a[108:111], v[248:251]
    s_mov_b32 s50, 0x3402000
    v_cvt_pk_bf16_f32 v176, v176, v177
    v_cvt_pk_bf16_f32 v177, v178, v179
    v_mfma_f32_16x16x32_bf16 v[204:207], v[76:79], a[96:99], v[204:207]
    v_cvt_pk_bf16_f32 v178, v180, v181
    v_cvt_pk_bf16_f32 v179, v182, v183
    v_mfma_f32_16x16x32_bf16 v[220:223], v[76:79], a[100:103], v[220:223]
    buffer_load_dwordx4 v[32:35], v2, s[28:31], s50 offen offset:0 sc1
    v_mfma_f32_16x16x32_bf16 v[236:239], v[76:79], a[104:107], v[236:239]
    v_mfma_f32_16x16x32_bf16 v[252:255], v[76:79], a[108:111], v[252:255]
    s_waitcnt lgkmcnt(0)
    v_mfma_f32_16x16x32_bf16 v[192:195], v[80:83], a[112:115], v[192:195]
    s_waitcnt vmcnt(33)
    v_mfma_f32_16x16x32_bf16 v[208:211], v[80:83], a[116:119], v[208:211]
    s_barrier
    ds_read_b64_tr_b16 v[64:65], v12 offset:0
    ds_read_b64_tr_b16 v[66:67], v12 offset:512
    v_mfma_f32_16x16x32_bf16 v[224:227], v[80:83], a[120:123], v[224:227]
    ds_read_b64_tr_b16 v[68:69], v13 offset:0
    ds_read_b64_tr_b16 v[70:71], v13 offset:512
    v_mfma_f32_16x16x32_bf16 v[240:243], v[80:83], a[124:127], v[240:243]
    ds_read_b64_tr_b16 v[72:73], v14 offset:0
    ds_read_b64_tr_b16 v[74:75], v14 offset:512
    v_mfma_f32_16x16x32_bf16 v[196:199], v[84:87], a[112:115], v[196:199]
    ds_read_b64_tr_b16 v[76:77], v15 offset:0
    ds_read_b64_tr_b16 v[78:79], v15 offset:512
    v_mfma_f32_16x16x32_bf16 v[212:215], v[84:87], a[116:119], v[212:215]
    buffer_load_dwordx4 v[36:39], v2, s[28:31], s50 offen offset:1024 sc1
    v_mfma_f32_16x16x32_bf16 v[228:231], v[84:87], a[120:123], v[228:231]
    v_mfma_f32_16x16x32_bf16 v[244:247], v[84:87], a[124:127], v[244:247]
    v_mfma_f32_16x16x32_bf16 v[200:203], v[88:91], a[112:115], v[200:203]
    buffer_store_dwordx4 v[176:179], v2, s[28:31], s47 offen offset:1024 sc1
    v_mfma_f32_16x16x32_bf16 v[216:219], v[88:91], a[116:119], v[216:219]
    v_mul_f32 v168, s44, v168
    v_mul_f32 v169, s44, v169
    v_mfma_f32_16x16x32_bf16 v[232:235], v[88:91], a[120:123], v[232:235]
    v_mul_f32 v170, s44, v170
    v_mul_f32 v171, s44, v171
    v_mfma_f32_16x16x32_bf16 v[248:251], v[88:91], a[124:127], v[248:251]
    buffer_load_dwordx4 v[40:43], v2, s[28:31], s50 offen offset:2048 sc1
    v_mfma_f32_16x16x32_bf16 v[204:207], v[92:95], a[112:115], v[204:207]
    v_mul_f32 v172, s44, v172
    v_mul_f32 v173, s44, v173
    v_mfma_f32_16x16x32_bf16 v[220:223], v[92:95], a[116:119], v[220:223]
    v_mul_f32 v174, s44, v174
    v_mul_f32 v175, s44, v175
    v_mfma_f32_16x16x32_bf16 v[236:239], v[92:95], a[120:123], v[236:239]
    buffer_load_dwordx4 v[44:47], v2, s[28:31], s50 offen offset:3072 sc1
    v_mfma_f32_16x16x32_bf16 v[252:255], v[92:95], a[124:127], v[252:255]
    s_waitcnt lgkmcnt(0)
    v_cvt_pk_bf16_f32 v168, v168, v169
    v_cvt_pk_bf16_f32 v169, v170, v171
    v_mfma_f32_16x16x32_bf16 a[128:131], a[0:3], v[64:67], a[128:131]
    s_mov_b32 s50, 0x3403000
    ds_read_b64_tr_b16 v[80:81], v12 offset:4096
    ds_read_b64_tr_b16 v[82:83], v12 offset:4608
    v_mfma_f32_16x16x32_bf16 a[132:135], a[4:7], v[64:67], a[132:135]
    ds_read_b64_tr_b16 v[84:85], v13 offset:4096
    ds_read_b64_tr_b16 v[86:87], v13 offset:4608
    v_mfma_f32_16x16x32_bf16 a[160:163], a[8:11], v[64:67], a[160:163]
    ds_read_b64_tr_b16 v[88:89], v14 offset:4096
    ds_read_b64_tr_b16 v[90:91], v14 offset:4608
    v_mfma_f32_16x16x32_bf16 a[164:167], a[12:15], v[64:67], a[164:167]
    ds_read_b64_tr_b16 v[92:93], v15 offset:4096
    ds_read_b64_tr_b16 v[94:95], v15 offset:4608
    v_mfma_f32_16x16x32_bf16 a[136:139], a[0:3], v[68:71], a[136:139]
    buffer_load_dwordx4 v[48:51], v2, s[28:31], s50 offen offset:0 sc1
    v_mfma_f32_16x16x32_bf16 a[140:143], a[4:7], v[68:71], a[140:143]
    v_cvt_pk_bf16_f32 v170, v172, v173
    v_cvt_pk_bf16_f32 v171, v174, v175
    v_mfma_f32_16x16x32_bf16 a[168:171], a[8:11], v[68:71], a[168:171]
    v_mfma_f32_16x16x32_bf16 a[172:175], a[12:15], v[68:71], a[172:175]
    buffer_load_dwordx4 v[52:55], v2, s[28:31], s50 offen offset:1024 sc1
    v_mfma_f32_16x16x32_bf16 a[144:147], a[0:3], v[72:75], a[144:147]
    v_mfma_f32_16x16x32_bf16 a[148:151], a[4:7], v[72:75], a[148:151]
    v_mfma_f32_16x16x32_bf16 a[176:179], a[8:11], v[72:75], a[176:179]
    buffer_load_dwordx4 v[56:59], v2, s[28:31], s50 offen offset:2048 sc1
    v_mfma_f32_16x16x32_bf16 a[180:183], a[12:15], v[72:75], a[180:183]
    v_mfma_f32_16x16x32_bf16 a[152:155], a[0:3], v[76:79], a[152:155]
    v_mfma_f32_16x16x32_bf16 a[156:159], a[4:7], v[76:79], a[156:159]
    buffer_store_dwordx4 v[168:171], v2, s[28:31], s47 offen offset:2048 sc1
    v_mfma_f32_16x16x32_bf16 a[184:187], a[8:11], v[76:79], a[184:187]
    v_mul_f32 v184, s44, v184
    v_mul_f32 v185, s44, v185
    v_mfma_f32_16x16x32_bf16 a[188:191], a[12:15], v[76:79], a[188:191]
    s_waitcnt lgkmcnt(0)
    v_mul_f32 v186, s44, v186
    v_mul_f32 v187, s44, v187
    v_mfma_f32_16x16x32_bf16 a[128:131], a[16:19], v[80:83], a[128:131]
    ds_read_b64_tr_b16 v[64:65], v12 offset:8192
    ds_read_b64_tr_b16 v[66:67], v12 offset:8704
    v_mfma_f32_16x16x32_bf16 a[132:135], a[20:23], v[80:83], a[132:135]
    ds_read_b64_tr_b16 v[68:69], v13 offset:8192
    ds_read_b64_tr_b16 v[70:71], v13 offset:8704
    v_mfma_f32_16x16x32_bf16 a[160:163], a[24:27], v[80:83], a[160:163]
    ds_read_b64_tr_b16 v[72:73], v14 offset:8192
    ds_read_b64_tr_b16 v[74:75], v14 offset:8704
    v_mfma_f32_16x16x32_bf16 a[164:167], a[28:31], v[80:83], a[164:167]
    ds_read_b64_tr_b16 v[76:77], v15 offset:8192
    ds_read_b64_tr_b16 v[78:79], v15 offset:8704
    v_mfma_f32_16x16x32_bf16 a[136:139], a[16:19], v[84:87], a[136:139]
    buffer_load_dwordx4 v[60:63], v2, s[28:31], s50 offen offset:3072 sc1
    v_mfma_f32_16x16x32_bf16 a[140:143], a[20:23], v[84:87], a[140:143]
    s_add_u32 m0, s40, 49152
    v_mul_f32 v188, s44, v188
    v_mul_f32 v189, s44, v189
    v_mfma_f32_16x16x32_bf16 a[168:171], a[24:27], v[84:87], a[168:171]
    s_add_u32 s46, s41, 3145856
    v_mul_f32 v190, s44, v190
    v_mul_f32 v191, s44, v191
    v_mfma_f32_16x16x32_bf16 a[172:175], a[28:31], v[84:87], a[172:175]
    s_and_b32 s46, s46, 0x3fffff
    buffer_load_dwordx4 v8, s[20:23], s46 offen offset:0 lds
    v_mfma_f32_16x16x32_bf16 a[144:147], a[16:19], v[88:91], a[144:147]
    v_cvt_pk_bf16_f32 v184, v184, v185
    v_cvt_pk_bf16_f32 v185, v186, v187
    v_mfma_f32_16x16x32_bf16 a[148:151], a[20:23], v[88:91], a[148:151]
    v_cvt_pk_bf16_f32 v186, v188, v189
    v_cvt_pk_bf16_f32 v187, v190, v191
    v_mfma_f32_16x16x32_bf16 a[176:179], a[24:27], v[88:91], a[176:179]
    buffer_load_dwordx4 v9, s[20:23], s46 offen offset:1024 lds
    v_mfma_f32_16x16x32_bf16 a[180:183], a[28:31], v[88:91], a[180:183]
    v_mfma_f32_16x16x32_bf16 a[152:155], a[16:19], v[92:95], a[152:155]
    v_mfma_f32_16x16x32_bf16 a[156:159], a[20:23], v[92:95], a[156:159]
    buffer_load_dwordx4 v10, s[20:23], s46 offen offset:2048 lds
    v_mfma_f32_16x16x32_bf16 a[184:187], a[24:27], v[92:95], a[184:187]
    v_mfma_f32_16x16x32_bf16 a[188:191], a[28:31], v[92:95], a[188:191]
    s_waitcnt lgkmcnt(0)
    v_mfma_f32_16x16x32_bf16 a[128:131], a[32:35], v[64:67], a[128:131]
    ds_read_b64_tr_b16 v[80:81], v12 offset:12288
    ds_read_b64_tr_b16 v[82:83], v12 offset:12800
    v_mfma_f32_16x16x32_bf16 a[132:135], a[36:39], v[64:67], a[132:135]
    ds_read_b64_tr_b16 v[84:85], v13 offset:12288
    ds_read_b64_tr_b16 v[86:87], v13 offset:12800
    v_mfma_f32_16x16x32_bf16 a[160:163], a[40:43], v[64:67], a[160:163]
    ds_read_b64_tr_b16 v[88:89], v14 offset:12288
    ds_read_b64_tr_b16 v[90:91], v14 offset:12800
    v_mfma_f32_16x16x32_bf16 a[164:167], a[44:47], v[64:67], a[164:167]
    ds_read_b64_tr_b16 v[92:93], v15 offset:12288
    ds_read_b64_tr_b16 v[94:95], v15 offset:12800
    v_mfma_f32_16x16x32_bf16 a[136:139], a[32:35], v[68:71], a[136:139]
    buffer_store_dwordx4 v[184:187], v2, s[28:31], s47 offen offset:3072 sc1
    v_mfma_f32_16x16x32_bf16 a[140:143], a[36:39], v[68:71], a[140:143]
    s_add_u32 s47, s42, 4096
    v_mul_f32 v192, s44, v192
    v_mul_f32 v193, s44, v193
    v_mfma_f32_16x16x32_bf16 a[168:171], a[40:43], v[68:71], a[168:171]
    v_mul_f32 v194, s44, v194
    v_mul_f32 v195, s44, v195
    v_mfma_f32_16x16x32_bf16 a[172:175], a[44:47], v[68:71], a[172:175]
    buffer_load_dwordx4 v11, s[20:23], s46 offen offset:3072 lds
    v_mfma_f32_16x16x32_bf16 a[144:147], a[32:35], v[72:75], a[144:147]
    s_add_u32 s37, s45, 256
    v_mul_f32 v196, s44, v196
    v_mul_f32 v197, s44, v197
    v_mfma_f32_16x16x32_bf16 a[148:151], a[36:39], v[72:75], a[148:151]
    s_and_b32 s37, s37, 0x3ff
    v_mul_f32 v198, s44, v198
    v_mul_f32 v199, s44, v199
    v_mfma_f32_16x16x32_bf16 a[176:179], a[40:43], v[72:75], a[176:179]
    s_add_u32 m0, s36, 16384
    v_cvt_pk_bf16_f32 v192, v192, v193
    v_cvt_pk_bf16_f32 v193, v194, v195
    v_mfma_f32_16x16x32_bf16 a[180:183], a[44:47], v[72:75], a[180:183]
    s_add_u32 s46, s34, s37
    buffer_load_dwordx4 v4, s[12:15], s46 offen offset:0 lds
    v_mfma_f32_16x16x32_bf16 a[152:155], a[32:35], v[76:79], a[152:155]
    v_cvt_pk_bf16_f32 v194, v196, v197
    v_cvt_pk_bf16_f32 v195, v198, v199
    v_mfma_f32_16x16x32_bf16 a[156:159], a[36:39], v[76:79], a[156:159]
    v_mfma_f32_16x16x32_bf16 a[184:187], a[40:43], v[76:79], a[184:187]
    buffer_load_dwordx4 v5, s[12:15], s46 offen offset:1024 lds
    v_mfma_f32_16x16x32_bf16 a[188:191], a[44:47], v[76:79], a[188:191]
    s_waitcnt lgkmcnt(0)
    v_mfma_f32_16x16x32_bf16 a[128:131], a[48:51], v[80:83], a[128:131]
    s_waitcnt vmcnt(42)
    v_mfma_f32_16x16x32_bf16 a[132:135], a[52:55], v[80:83], a[132:135]
    s_barrier
    ds_read_b64_tr_b16 v[64:65], v12 offset:16384
    ds_read_b64_tr_b16 v[66:67], v12 offset:16896
    v_mfma_f32_16x16x32_bf16 a[160:163], a[56:59], v[80:83], a[160:163]
    ds_read_b64_tr_b16 v[68:69], v13 offset:16384
    ds_read_b64_tr_b16 v[70:71], v13 offset:16896
    v_mfma_f32_16x16x32_bf16 a[164:167], a[60:63], v[80:83], a[164:167]
    ds_read_b64_tr_b16 v[72:73], v14 offset:16384
    ds_read_b64_tr_b16 v[74:75], v14 offset:16896
    v_mfma_f32_16x16x32_bf16 a[136:139], a[48:51], v[84:87], a[136:139]
    ds_read_b64_tr_b16 v[76:77], v15 offset:16384
    ds_read_b64_tr_b16 v[78:79], v15 offset:16896
    v_mfma_f32_16x16x32_bf16 a[140:143], a[52:55], v[84:87], a[140:143]
    buffer_load_dwordx4 v6, s[12:15], s46 offen offset:2048 lds
    v_mfma_f32_16x16x32_bf16 a[168:171], a[56:59], v[84:87], a[168:171]
    v_mfma_f32_16x16x32_bf16 a[172:175], a[60:63], v[84:87], a[172:175]
    v_mfma_f32_16x16x32_bf16 a[144:147], a[48:51], v[88:91], a[144:147]
    buffer_store_dwordx4 v[192:195], v2, s[28:31], s47 offen offset:0 sc1
    v_mfma_f32_16x16x32_bf16 a[148:151], a[52:55], v[88:91], a[148:151]
    v_mul_f32 v208, s44, v208
    v_mul_f32 v209, s44, v209
    v_mfma_f32_16x16x32_bf16 a[176:179], a[56:59], v[88:91], a[176:179]
    v_mul_f32 v210, s44, v210
    v_mul_f32 v211, s44, v211
    v_mfma_f32_16x16x32_bf16 a[180:183], a[60:63], v[88:91], a[180:183]
    buffer_load_dwordx4 v7, s[12:15], s46 offen offset:3072 lds
    v_mfma_f32_16x16x32_bf16 a[152:155], a[48:51], v[92:95], a[152:155]
    s_add_u32 m0, s36, 20480
    v_mul_f32 v212, s44, v212
    v_mul_f32 v213, s44, v213
    v_mfma_f32_16x16x32_bf16 a[156:159], a[52:55], v[92:95], a[156:159]
    s_add_u32 s46, s35, s37
    v_mul_f32 v214, s44, v214
    v_mul_f32 v215, s44, v215
    v_mfma_f32_16x16x32_bf16 a[184:187], a[56:59], v[92:95], a[184:187]
    buffer_load_dwordx4 v4, s[12:15], s46 offen offset:0 lds
    v_mfma_f32_16x16x32_bf16 a[188:191], a[60:63], v[92:95], a[188:191]
    s_waitcnt lgkmcnt(0)
    v_cvt_pk_bf16_f32 v208, v208, v209
    v_cvt_pk_bf16_f32 v209, v210, v211
    v_mfma_f32_16x16x32_bf16 a[128:131], a[64:67], v[64:67], a[128:131]
    ds_read_b64_tr_b16 v[80:81], v12 offset:20480
    ds_read_b64_tr_b16 v[82:83], v12 offset:20992
    v_mfma_f32_16x16x32_bf16 a[132:135], a[68:71], v[64:67], a[132:135]
    ds_read_b64_tr_b16 v[84:85], v13 offset:20480
    ds_read_b64_tr_b16 v[86:87], v13 offset:20992
    v_mfma_f32_16x16x32_bf16 a[160:163], a[72:75], v[64:67], a[160:163]
    ds_read_b64_tr_b16 v[88:89], v14 offset:20480
    ds_read_b64_tr_b16 v[90:91], v14 offset:20992
    v_mfma_f32_16x16x32_bf16 a[164:167], a[76:79], v[64:67], a[164:167]
    ds_read_b64_tr_b16 v[92:93], v15 offset:20480
    ds_read_b64_tr_b16 v[94:95], v15 offset:20992
    v_mfma_f32_16x16x32_bf16 a[136:139], a[64:67], v[68:71], a[136:139]
    buffer_load_dwordx4 v5, s[12:15], s46 offen offset:1024 lds
    v_mfma_f32_16x16x32_bf16 a[140:143], a[68:71], v[68:71], a[140:143]
    v_cvt_pk_bf16_f32 v210, v212, v213
    v_cvt_pk_bf16_f32 v211, v214, v215
    v_mfma_f32_16x16x32_bf16 a[168:171], a[72:75], v[68:71], a[168:171]
    v_mfma_f32_16x16x32_bf16 a[172:175], a[76:79], v[68:71], a[172:175]
    buffer_load_dwordx4 v6, s[12:15], s46 offen offset:2048 lds
    v_mfma_f32_16x16x32_bf16 a[144:147], a[64:67], v[72:75], a[144:147]
    v_mfma_f32_16x16x32_bf16 a[148:151], a[68:71], v[72:75], a[148:151]
    v_mfma_f32_16x16x32_bf16 a[176:179], a[72:75], v[72:75], a[176:179]
    buffer_load_dwordx4 v7, s[12:15], s46 offen offset:3072 lds
    v_mfma_f32_16x16x32_bf16 a[180:183], a[76:79], v[72:75], a[180:183]
    s_add_u32 m0, s40, 0
    v_mfma_f32_16x16x32_bf16 a[152:155], a[64:67], v[76:79], a[152:155]
    s_add_u32 s46, s41, 0
    v_mfma_f32_16x16x32_bf16 a[156:159], a[68:71], v[76:79], a[156:159]
    s_and_b32 s46, s46, 0x3fffff
    buffer_store_dwordx4 v[208:211], v2, s[28:31], s47 offen offset:1024 sc1
    v_mfma_f32_16x16x32_bf16 a[184:187], a[72:75], v[76:79], a[184:187]
    v_mul_f32 v200, s44, v200
    v_mul_f32 v201, s44, v201
    v_mfma_f32_16x16x32_bf16 a[188:191], a[76:79], v[76:79], a[188:191]
    s_waitcnt lgkmcnt(0)
    v_mul_f32 v202, s44, v202
    v_mul_f32 v203, s44, v203
    v_mfma_f32_16x16x32_bf16 a[128:131], a[80:83], v[80:83], a[128:131]
    ds_read_b64_tr_b16 v[64:65], v12 offset:24576
    ds_read_b64_tr_b16 v[66:67], v12 offset:25088
    v_mfma_f32_16x16x32_bf16 a[132:135], a[84:87], v[80:83], a[132:135]
    ds_read_b64_tr_b16 v[68:69], v13 offset:24576
    ds_read_b64_tr_b16 v[70:71], v13 offset:25088
    v_mfma_f32_16x16x32_bf16 a[160:163], a[88:91], v[80:83], a[160:163]
    ds_read_b64_tr_b16 v[72:73], v14 offset:24576
    ds_read_b64_tr_b16 v[74:75], v14 offset:25088
    v_mfma_f32_16x16x32_bf16 a[164:167], a[92:95], v[80:83], a[164:167]
    ds_read_b64_tr_b16 v[76:77], v15 offset:24576
    ds_read_b64_tr_b16 v[78:79], v15 offset:25088
    v_mfma_f32_16x16x32_bf16 a[136:139], a[80:83], v[84:87], a[136:139]
    buffer_load_dwordx4 v8, s[24:27], s46 offen offset:0 lds
    v_mfma_f32_16x16x32_bf16 a[140:143], a[84:87], v[84:87], a[140:143]
    v_mul_f32 v204, s44, v204
    v_mul_f32 v205, s44, v205
    v_mfma_f32_16x16x32_bf16 a[168:171], a[88:91], v[84:87], a[168:171]
    v_mul_f32 v206, s44, v206
    v_mul_f32 v207, s44, v207
    v_mfma_f32_16x16x32_bf16 a[172:175], a[92:95], v[84:87], a[172:175]
    buffer_load_dwordx4 v9, s[24:27], s46 offen offset:1024 lds
    v_mfma_f32_16x16x32_bf16 a[144:147], a[80:83], v[88:91], a[144:147]
    v_cvt_pk_bf16_f32 v200, v200, v201
    v_cvt_pk_bf16_f32 v201, v202, v203
    v_mfma_f32_16x16x32_bf16 a[148:151], a[84:87], v[88:91], a[148:151]
    v_cvt_pk_bf16_f32 v202, v204, v205
    v_cvt_pk_bf16_f32 v203, v206, v207
    v_mfma_f32_16x16x32_bf16 a[176:179], a[88:91], v[88:91], a[176:179]
    buffer_load_dwordx4 v10, s[24:27], s46 offen offset:2048 lds
    v_mfma_f32_16x16x32_bf16 a[180:183], a[92:95], v[88:91], a[180:183]
    v_mfma_f32_16x16x32_bf16 a[152:155], a[80:83], v[92:95], a[152:155]
    v_mfma_f32_16x16x32_bf16 a[156:159], a[84:87], v[92:95], a[156:159]
    buffer_load_dwordx4 v11, s[24:27], s46 offen offset:3072 lds
    v_mfma_f32_16x16x32_bf16 a[184:187], a[88:91], v[92:95], a[184:187]
    v_mfma_f32_16x16x32_bf16 a[188:191], a[92:95], v[92:95], a[188:191]
    s_waitcnt lgkmcnt(0)
    v_mfma_f32_16x16x32_bf16 a[128:131], a[96:99], v[64:67], a[128:131]
    ds_read_b64_tr_b16 v[80:81], v12 offset:28672
    ds_read_b64_tr_b16 v[82:83], v12 offset:29184
    v_mfma_f32_16x16x32_bf16 a[132:135], a[100:103], v[64:67], a[132:135]
    ds_read_b64_tr_b16 v[84:85], v13 offset:28672
    ds_read_b64_tr_b16 v[86:87], v13 offset:29184
    v_mfma_f32_16x16x32_bf16 a[160:163], a[104:107], v[64:67], a[160:163]
    ds_read_b64_tr_b16 v[88:89], v14 offset:28672
    ds_read_b64_tr_b16 v[90:91], v14 offset:29184
    v_mfma_f32_16x16x32_bf16 a[164:167], a[108:111], v[64:67], a[164:167]
    ds_read_b64_tr_b16 v[92:93], v15 offset:28672
    ds_read_b64_tr_b16 v[94:95], v15 offset:29184
    v_mfma_f32_16x16x32_bf16 a[136:139], a[96:99], v[68:71], a[136:139]
    buffer_store_dwordx4 v[200:203], v2, s[28:31], s47 offen offset:2048 sc1
    v_mfma_f32_16x16x32_bf16 a[140:143], a[100:103], v[68:71], a[140:143]
    v_mul_f32 v216, s44, v216
    v_mul_f32 v217, s44, v217
    v_mfma_f32_16x16x32_bf16 a[168:171], a[104:107], v[68:71], a[168:171]
    v_mul_f32 v218, s44, v218
    v_mul_f32 v219, s44, v219
    v_mfma_f32_16x16x32_bf16 a[172:175], a[108:111], v[68:71], a[172:175]
    v_mul_f32 v220, s44, v220
    v_mul_f32 v221, s44, v221
    v_mfma_f32_16x16x32_bf16 a[144:147], a[96:99], v[72:75], a[144:147]
    v_mul_f32 v222, s44, v222
    v_mul_f32 v223, s44, v223
    v_mfma_f32_16x16x32_bf16 a[148:151], a[100:103], v[72:75], a[148:151]
    v_cvt_pk_bf16_f32 v216, v216, v217
    v_cvt_pk_bf16_f32 v217, v218, v219
    v_mfma_f32_16x16x32_bf16 a[176:179], a[104:107], v[72:75], a[176:179]
    v_cvt_pk_bf16_f32 v218, v220, v221
    v_cvt_pk_bf16_f32 v219, v222, v223
    v_mfma_f32_16x16x32_bf16 a[180:183], a[108:111], v[72:75], a[180:183]
    v_mfma_f32_16x16x32_bf16 a[152:155], a[96:99], v[76:79], a[152:155]
    v_mfma_f32_16x16x32_bf16 a[156:159], a[100:103], v[76:79], a[156:159]
    v_mfma_f32_16x16x32_bf16 a[184:187], a[104:107], v[76:79], a[184:187]
    v_mfma_f32_16x16x32_bf16 a[188:191], a[108:111], v[76:79], a[188:191]
    s_waitcnt lgkmcnt(0)
    v_mfma_f32_16x16x32_bf16 a[128:131], a[112:115], v[80:83], a[128:131]
    s_waitcnt vmcnt(40)
    v_mfma_f32_16x16x32_bf16 a[132:135], a[116:119], v[80:83], a[132:135]
    s_barrier
    ds_read_b64_tr_b16 v[64:65], v12 offset:32768
    ds_read_b64_tr_b16 v[66:67], v12 offset:33280
    v_mfma_f32_16x16x32_bf16 a[160:163], a[120:123], v[80:83], a[160:163]
    s_add_u32 m0, s40, 16384
    ds_read_b64_tr_b16 v[68:69], v13 offset:32768
    ds_read_b64_tr_b16 v[70:71], v13 offset:33280
    v_mfma_f32_16x16x32_bf16 a[164:167], a[124:127], v[80:83], a[164:167]
    s_add_u32 s46, s41, 128
    ds_read_b64_tr_b16 v[72:73], v14 offset:32768
    ds_read_b64_tr_b16 v[74:75], v14 offset:33280
    v_mfma_f32_16x16x32_bf16 a[136:139], a[112:115], v[84:87], a[136:139]
    s_and_b32 s46, s46, 0x3fffff
    ds_read_b64_tr_b16 v[76:77], v15 offset:32768
    ds_read_b64_tr_b16 v[78:79], v15 offset:33280
    v_mfma_f32_16x16x32_bf16 a[140:143], a[116:119], v[84:87], a[140:143]
    buffer_load_dwordx4 v8, s[24:27], s46 offen offset:0 lds
    v_mfma_f32_16x16x32_bf16 a[168:171], a[120:123], v[84:87], a[168:171]
    v_mfma_f32_16x16x32_bf16 a[172:175], a[124:127], v[84:87], a[172:175]
    v_mfma_f32_16x16x32_bf16 a[144:147], a[112:115], v[88:91], a[144:147]
    buffer_store_dwordx4 v[216:219], v2, s[28:31], s47 offen offset:3072 sc1
    v_mfma_f32_16x16x32_bf16 a[148:151], a[116:119], v[88:91], a[148:151]
    s_add_u32 s47, s42, 20480
    v_mul_f32 v224, s44, v224
    v_mul_f32 v225, s44, v225
    v_mfma_f32_16x16x32_bf16 a[176:179], a[120:123], v[88:91], a[176:179]
    v_mul_f32 v226, s44, v226
    v_mul_f32 v227, s44, v227
    v_mfma_f32_16x16x32_bf16 a[180:183], a[124:127], v[88:91], a[180:183]
    buffer_load_dwordx4 v9, s[24:27], s46 offen offset:1024 lds
    v_mfma_f32_16x16x32_bf16 a[152:155], a[112:115], v[92:95], a[152:155]
    v_mul_f32 v228, s44, v228
    v_mul_f32 v229, s44, v229
    v_mfma_f32_16x16x32_bf16 a[156:159], a[116:119], v[92:95], a[156:159]
    v_mul_f32 v230, s44, v230
    v_mul_f32 v231, s44, v231
    v_mfma_f32_16x16x32_bf16 a[184:187], a[120:123], v[92:95], a[184:187]
    buffer_load_dwordx4 v10, s[24:27], s46 offen offset:2048 lds
    v_mfma_f32_16x16x32_bf16 a[188:191], a[124:127], v[92:95], a[188:191]
    s_waitcnt lgkmcnt(0)
    v_cvt_pk_bf16_f32 v224, v224, v225
    v_cvt_pk_bf16_f32 v225, v226, v227
    v_mfma_f32_16x16x32_bf16 a[192:195], a[0:3], v[64:67], a[192:195]
    ds_read_b64_tr_b16 v[80:81], v12 offset:36864
    ds_read_b64_tr_b16 v[82:83], v12 offset:37376
    v_mfma_f32_16x16x32_bf16 a[196:199], a[4:7], v[64:67], a[196:199]
    ds_read_b64_tr_b16 v[84:85], v13 offset:36864
    ds_read_b64_tr_b16 v[86:87], v13 offset:37376
    v_mfma_f32_16x16x32_bf16 a[224:227], a[8:11], v[64:67], a[224:227]
    ds_read_b64_tr_b16 v[88:89], v14 offset:36864
    ds_read_b64_tr_b16 v[90:91], v14 offset:37376
    v_mfma_f32_16x16x32_bf16 a[228:231], a[12:15], v[64:67], a[228:231]
    ds_read_b64_tr_b16 v[92:93], v15 offset:36864
    ds_read_b64_tr_b16 v[94:95], v15 offset:37376
    v_mfma_f32_16x16x32_bf16 a[200:203], a[0:3], v[68:71], a[200:203]
    buffer_load_dwordx4 v11, s[24:27], s46 offen offset:3072 lds
    v_mfma_f32_16x16x32_bf16 a[204:207], a[4:7], v[68:71], a[204:207]
    v_cvt_pk_bf16_f32 v226, v228, v229
    v_cvt_pk_bf16_f32 v227, v230, v231
    v_mfma_f32_16x16x32_bf16 a[232:235], a[8:11], v[68:71], a[232:235]
    v_mfma_f32_16x16x32_bf16 a[236:239], a[12:15], v[68:71], a[236:239]
    v_mfma_f32_16x16x32_bf16 a[208:211], a[0:3], v[72:75], a[208:211]
    v_mfma_f32_16x16x32_bf16 a[212:215], a[4:7], v[72:75], a[212:215]
    v_mfma_f32_16x16x32_bf16 a[240:243], a[8:11], v[72:75], a[240:243]
    v_mfma_f32_16x16x32_bf16 a[244:247], a[12:15], v[72:75], a[244:247]
    v_mfma_f32_16x16x32_bf16 a[216:219], a[0:3], v[76:79], a[216:219]
    buffer_store_dwordx4 v[224:227], v2, s[28:31], s47 offen offset:0 sc1
    v_mfma_f32_16x16x32_bf16 a[220:223], a[4:7], v[76:79], a[220:223]
    v_mul_f32 v240, s44, v240
    v_mul_f32 v241, s44, v241
    v_mfma_f32_16x16x32_bf16 a[248:251], a[8:11], v[76:79], a[248:251]
    v_mul_f32 v242, s44, v242
    v_mul_f32 v243, s44, v243
    v_mfma_f32_16x16x32_bf16 a[252:255], a[12:15], v[76:79], a[252:255]
    s_waitcnt lgkmcnt(0)
    v_mul_f32 v244, s44, v244
    v_mul_f32 v245, s44, v245
    v_mfma_f32_16x16x32_bf16 a[192:195], a[16:19], v[80:83], a[192:195]
    ds_read_b64_tr_b16 v[64:65], v12 offset:40960
    ds_read_b64_tr_b16 v[66:67], v12 offset:41472
    v_mfma_f32_16x16x32_bf16 a[196:199], a[20:23], v[80:83], a[196:199]
    ds_read_b64_tr_b16 v[68:69], v13 offset:40960
    ds_read_b64_tr_b16 v[70:71], v13 offset:41472
    v_mfma_f32_16x16x32_bf16 a[224:227], a[24:27], v[80:83], a[224:227]
    ds_read_b64_tr_b16 v[72:73], v14 offset:40960
    ds_read_b64_tr_b16 v[74:75], v14 offset:41472
    v_mfma_f32_16x16x32_bf16 a[228:231], a[28:31], v[80:83], a[228:231]
    ds_read_b64_tr_b16 v[76:77], v15 offset:40960
    ds_read_b64_tr_b16 v[78:79], v15 offset:41472
    v_mfma_f32_16x16x32_bf16 a[200:203], a[16:19], v[84:87], a[200:203]
    v_mul_f32 v246, s44, v246
    v_mul_f32 v247, s44, v247
    v_mfma_f32_16x16x32_bf16 a[204:207], a[20:23], v[84:87], a[204:207]
    v_cvt_pk_bf16_f32 v240, v240, v241
    v_cvt_pk_bf16_f32 v241, v242, v243
    v_mfma_f32_16x16x32_bf16 a[232:235], a[24:27], v[84:87], a[232:235]
    v_cvt_pk_bf16_f32 v242, v244, v245
    v_cvt_pk_bf16_f32 v243, v246, v247
    v_mfma_f32_16x16x32_bf16 a[236:239], a[28:31], v[84:87], a[236:239]
    v_mfma_f32_16x16x32_bf16 a[208:211], a[16:19], v[88:91], a[208:211]
    v_mfma_f32_16x16x32_bf16 a[212:215], a[20:23], v[88:91], a[212:215]
    v_mfma_f32_16x16x32_bf16 a[240:243], a[24:27], v[88:91], a[240:243]
    v_mfma_f32_16x16x32_bf16 a[244:247], a[28:31], v[88:91], a[244:247]
    v_mfma_f32_16x16x32_bf16 a[216:219], a[16:19], v[92:95], a[216:219]
    v_mfma_f32_16x16x32_bf16 a[220:223], a[20:23], v[92:95], a[220:223]
    v_mfma_f32_16x16x32_bf16 a[248:251], a[24:27], v[92:95], a[248:251]
    v_mfma_f32_16x16x32_bf16 a[252:255], a[28:31], v[92:95], a[252:255]
    s_waitcnt lgkmcnt(0)
    v_mfma_f32_16x16x32_bf16 a[192:195], a[32:35], v[64:67], a[192:195]
    s_waitcnt vmcnt(51)
    ds_read_b64_tr_b16 v[80:81], v12 offset:45056
    ds_read_b64_tr_b16 v[82:83], v12 offset:45568
    v_mfma_f32_16x16x32_bf16 a[196:199], a[36:39], v[64:67], a[196:199]
    ds_read_b64_tr_b16 v[84:85], v13 offset:45056
    ds_read_b64_tr_b16 v[86:87], v13 offset:45568
    v_mfma_f32_16x16x32_bf16 a[224:227], a[40:43], v[64:67], a[224:227]
    ds_read_b64_tr_b16 v[88:89], v14 offset:45056
    ds_read_b64_tr_b16 v[90:91], v14 offset:45568
    v_mfma_f32_16x16x32_bf16 a[228:231], a[44:47], v[64:67], a[228:231]
    ds_read_b64_tr_b16 v[92:93], v15 offset:45056
    ds_read_b64_tr_b16 v[94:95], v15 offset:45568
    v_mfma_f32_16x16x32_bf16 a[200:203], a[32:35], v[68:71], a[200:203]
    ds_read_b128 a[0:3], v16 offset:0
    ds_read_b128 a[4:7], v16 offset:2048
    v_mfma_f32_16x16x32_bf16 a[204:207], a[36:39], v[68:71], a[204:207]
    ds_read_b128 a[8:11], v16 offset:4096
    ds_read_b128 a[12:15], v16 offset:6144
    v_mfma_f32_16x16x32_bf16 a[232:235], a[40:43], v[68:71], a[232:235]
    ds_read_b128 a[16:19], v17 offset:0
    ds_read_b128 a[20:23], v17 offset:2048
    v_mfma_f32_16x16x32_bf16 a[236:239], a[44:47], v[68:71], a[236:239]
    ds_read_b128 a[24:27], v17 offset:4096
    ds_read_b128 a[28:31], v17 offset:6144
    v_mfma_f32_16x16x32_bf16 a[208:211], a[32:35], v[72:75], a[208:211]
    buffer_store_dwordx4 v[240:243], v2, s[28:31], s47 offen offset:1024 sc1
    v_mfma_f32_16x16x32_bf16 a[212:215], a[36:39], v[72:75], a[212:215]
    v_mul_f32 v232, s44, v232
    v_mul_f32 v233, s44, v233
    v_mfma_f32_16x16x32_bf16 a[240:243], a[40:43], v[72:75], a[240:243]
    v_mul_f32 v234, s44, v234
    v_mul_f32 v235, s44, v235
    v_mfma_f32_16x16x32_bf16 a[244:247], a[44:47], v[72:75], a[244:247]
    v_mul_f32 v236, s44, v236
    v_mul_f32 v237, s44, v237
    v_mfma_f32_16x16x32_bf16 a[216:219], a[32:35], v[76:79], a[216:219]
    v_mul_f32 v238, s44, v238
    v_mul_f32 v239, s44, v239
    v_mfma_f32_16x16x32_bf16 a[220:223], a[36:39], v[76:79], a[220:223]
    v_cvt_pk_bf16_f32 v232, v232, v233
    v_cvt_pk_bf16_f32 v233, v234, v235
    v_mfma_f32_16x16x32_bf16 a[248:251], a[40:43], v[76:79], a[248:251]
    v_cvt_pk_bf16_f32 v234, v236, v237
    v_cvt_pk_bf16_f32 v235, v238, v239
    v_mfma_f32_16x16x32_bf16 a[252:255], a[44:47], v[76:79], a[252:255]
    s_waitcnt lgkmcnt(0)
    v_mfma_f32_16x16x32_bf16 a[192:195], a[48:51], v[80:83], a[192:195]
    s_waitcnt vmcnt(22)
    v_mfma_f32_16x16x32_bf16 a[196:199], a[52:55], v[80:83], a[196:199]
    s_barrier
    ds_read_b64_tr_b16 v[64:65], v12 offset:49152
    ds_read_b64_tr_b16 v[66:67], v12 offset:49664
    v_mfma_f32_16x16x32_bf16 a[224:227], a[56:59], v[80:83], a[224:227]
    s_add_u32 m0, s40, 32768
    ds_read_b64_tr_b16 v[68:69], v13 offset:49152
    ds_read_b64_tr_b16 v[70:71], v13 offset:49664
    v_mfma_f32_16x16x32_bf16 a[228:231], a[60:63], v[80:83], a[228:231]
    s_add_u32 s46, s43, 1048576
    ds_read_b64_tr_b16 v[72:73], v14 offset:49152
    ds_read_b64_tr_b16 v[74:75], v14 offset:49664
    v_mfma_f32_16x16x32_bf16 a[200:203], a[48:51], v[84:87], a[200:203]
    s_and_b32 s46, s46, 0x3fffff
    ds_read_b64_tr_b16 v[76:77], v15 offset:49152
    ds_read_b64_tr_b16 v[78:79], v15 offset:49664
    v_mfma_f32_16x16x32_bf16 a[204:207], a[52:55], v[84:87], a[204:207]
    s_waitcnt vmcnt(27)
    buffer_load_dwordx4 v8, s[24:27], s46 offen offset:0 lds
    v_mfma_f32_16x16x32_bf16 a[232:235], a[56:59], v[84:87], a[232:235]
    v_min3_u32 v20, v32, v33, v34
    v_min3_u32 v20, v20, v35, v36
    v_mfma_f32_16x16x32_bf16 a[236:239], a[60:63], v[84:87], a[236:239]
    v_min3_u32 v20, v20, v37, v38
    v_min3_u32 v20, v20, v39, v40
    v_mfma_f32_16x16x32_bf16 a[208:211], a[48:51], v[88:91], a[208:211]
    buffer_load_dwordx4 v9, s[24:27], s46 offen offset:1024 lds
    v_mfma_f32_16x16x32_bf16 a[212:215], a[52:55], v[88:91], a[212:215]
    v_min3_u32 v20, v20, v41, v42
    v_min3_u32 v20, v20, v43, v44
    v_mfma_f32_16x16x32_bf16 a[240:243], a[56:59], v[88:91], a[240:243]
    v_min3_u32 v20, v20, v45, v46
    v_min3_u32 v20, v20, v47, v48
    v_mfma_f32_16x16x32_bf16 a[244:247], a[60:63], v[88:91], a[244:247]
    buffer_load_dwordx4 v10, s[24:27], s46 offen offset:2048 lds
    v_mfma_f32_16x16x32_bf16 a[216:219], a[48:51], v[92:95], a[216:219]
    v_min3_u32 v20, v20, v49, v50
    v_min3_u32 v20, v20, v51, v52
    v_mfma_f32_16x16x32_bf16 a[220:223], a[52:55], v[92:95], a[220:223]
    v_min3_u32 v20, v20, v53, v54
    v_min3_u32 v20, v20, v55, v56
    v_mfma_f32_16x16x32_bf16 a[248:251], a[56:59], v[92:95], a[248:251]
    buffer_store_dwordx4 v[232:235], v2, s[28:31], s47 offen offset:2048 sc1
    v_mfma_f32_16x16x32_bf16 a[252:255], a[60:63], v[92:95], a[252:255]
    s_waitcnt lgkmcnt(0)
    v_mul_f32 v248, s44, v248
    v_mul_f32 v249, s44, v249
    v_mfma_f32_16x16x32_bf16 a[192:195], a[64:67], v[64:67], a[192:195]
    s_waitcnt vmcnt(41)
    ds_read_b64_tr_b16 v[80:81], v12 offset:53248
    ds_read_b64_tr_b16 v[82:83], v12 offset:53760
    v_mfma_f32_16x16x32_bf16 a[196:199], a[68:71], v[64:67], a[196:199]
    ds_read_b64_tr_b16 v[84:85], v13 offset:53248
    ds_read_b64_tr_b16 v[86:87], v13 offset:53760
    v_mfma_f32_16x16x32_bf16 a[224:227], a[72:75], v[64:67], a[224:227]
    ds_read_b64_tr_b16 v[88:89], v14 offset:53248
    ds_read_b64_tr_b16 v[90:91], v14 offset:53760
    v_mfma_f32_16x16x32_bf16 a[228:231], a[76:79], v[64:67], a[228:231]
    ds_read_b64_tr_b16 v[92:93], v15 offset:53248
    ds_read_b64_tr_b16 v[94:95], v15 offset:53760
    v_mfma_f32_16x16x32_bf16 a[200:203], a[64:67], v[68:71], a[200:203]
    ds_read_b128 a[32:35], v16 offset:8192
    ds_read_b128 a[36:39], v16 offset:10240
    v_mfma_f32_16x16x32_bf16 a[204:207], a[68:71], v[68:71], a[204:207]
    ds_read_b128 a[40:43], v16 offset:12288
    ds_read_b128 a[44:47], v16 offset:14336
    v_mfma_f32_16x16x32_bf16 a[232:235], a[72:75], v[68:71], a[232:235]
    ds_read_b128 a[48:51], v17 offset:8192
    ds_read_b128 a[52:55], v17 offset:10240
    v_mfma_f32_16x16x32_bf16 a[236:239], a[76:79], v[68:71], a[236:239]
    ds_read_b128 a[56:59], v17 offset:12288
    ds_read_b128 a[60:63], v17 offset:14336
    v_mfma_f32_16x16x32_bf16 a[208:211], a[64:67], v[72:75], a[208:211]
    buffer_load_dwordx4 v11, s[24:27], s46 offen offset:3072 lds
    v_mfma_f32_16x16x32_bf16 a[212:215], a[68:71], v[72:75], a[212:215]
    s_add_u32 s37, s45, 384
    v_mul_f32 v250, s44, v250
    v_mul_f32 v251, s44, v251
    v_mfma_f32_16x16x32_bf16 a[240:243], a[72:75], v[72:75], a[240:243]
    s_and_b32 s37, s37, 0x3ff
    v_mul_f32 v252, s44, v252
    v_mul_f32 v253, s44, v253
    v_mfma_f32_16x16x32_bf16 a[244:247], a[76:79], v[72:75], a[244:247]
    s_add_u32 m0, s36, 0
    v_mul_f32 v254, s44, v254
    v_mul_f32 v255, s44, v255
    v_mfma_f32_16x16x32_bf16 a[216:219], a[64:67], v[76:79], a[216:219]
    s_add_u32 s46, s34, s37
    buffer_load_dwordx4 v4, s[12:15], s46 offen offset:0 lds
    v_mfma_f32_16x16x32_bf16 a[220:223], a[68:71], v[76:79], a[220:223]
    v_cvt_pk_bf16_f32 v248, v248, v249
    v_cvt_pk_bf16_f32 v249, v250, v251
    v_mfma_f32_16x16x32_bf16 a[248:251], a[72:75], v[76:79], a[248:251]
    v_cvt_pk_bf16_f32 v250, v252, v253
    v_cvt_pk_bf16_f32 v251, v254, v255
    v_mfma_f32_16x16x32_bf16 a[252:255], a[76:79], v[76:79], a[252:255]
    s_waitcnt lgkmcnt(0)
    buffer_load_dwordx4 v5, s[12:15], s46 offen offset:1024 lds
    v_mfma_f32_16x16x32_bf16 a[192:195], a[80:83], v[80:83], a[192:195]
    ds_read_b64_tr_b16 v[64:65], v12 offset:57344
    ds_read_b64_tr_b16 v[66:67], v12 offset:57856
    v_mfma_f32_16x16x32_bf16 a[196:199], a[84:87], v[80:83], a[196:199]
    ds_read_b64_tr_b16 v[68:69], v13 offset:57344
    ds_read_b64_tr_b16 v[70:71], v13 offset:57856
    v_mfma_f32_16x16x32_bf16 a[224:227], a[88:91], v[80:83], a[224:227]
    ds_read_b64_tr_b16 v[72:73], v14 offset:57344
    ds_read_b64_tr_b16 v[74:75], v14 offset:57856
    v_mfma_f32_16x16x32_bf16 a[228:231], a[92:95], v[80:83], a[228:231]
    ds_read_b64_tr_b16 v[76:77], v15 offset:57344
    ds_read_b64_tr_b16 v[78:79], v15 offset:57856
    v_mfma_f32_16x16x32_bf16 a[200:203], a[80:83], v[84:87], a[200:203]
    buffer_store_dwordx4 v[248:251], v2, s[28:31], s47 offen offset:3072 sc1
    v_mfma_f32_16x16x32_bf16 a[204:207], a[84:87], v[84:87], a[204:207]
    s_add_u32 s47, s42, 8192
    v_accvgpr_read_b32 v112, a128
    v_accvgpr_read_b32 v113, a129
    v_mfma_f32_16x16x32_bf16 a[232:235], a[88:91], v[84:87], a[232:235]
    v_accvgpr_read_b32 v114, a130
    v_accvgpr_read_b32 v115, a131
    v_mfma_f32_16x16x32_bf16 a[236:239], a[92:95], v[84:87], a[236:239]
    buffer_load_dwordx4 v6, s[12:15], s46 offen offset:2048 lds
    v_mfma_f32_16x16x32_bf16 a[208:211], a[80:83], v[88:91], a[208:211]
    v_accvgpr_read_b32 v116, a132
    v_accvgpr_read_b32 v117, a133
    v_mfma_f32_16x16x32_bf16 a[212:215], a[84:87], v[88:91], a[212:215]
    v_accvgpr_read_b32 v118, a134
    v_accvgpr_read_b32 v119, a135
    v_mfma_f32_16x16x32_bf16 a[240:243], a[88:91], v[88:91], a[240:243]
    buffer_load_dwordx4 v7, s[12:15], s46 offen offset:3072 lds
    v_mfma_f32_16x16x32_bf16 a[244:247], a[92:95], v[88:91], a[244:247]
    s_add_u32 m0, s36, 4096
    v_cvt_pk_bf16_f32 v112, v112, v113
    v_cvt_pk_bf16_f32 v113, v114, v115
    v_mfma_f32_16x16x32_bf16 a[216:219], a[80:83], v[92:95], a[216:219]
    s_add_u32 s46, s35, s37
    v_cvt_pk_bf16_f32 v114, v116, v117
    v_cvt_pk_bf16_f32 v115, v118, v119
    v_mfma_f32_16x16x32_bf16 a[220:223], a[84:87], v[92:95], a[220:223]
    buffer_load_dwordx4 v4, s[12:15], s46 offen offset:0 lds
    v_mfma_f32_16x16x32_bf16 a[248:251], a[88:91], v[92:95], a[248:251]
    v_min3_u32 v20, v20, v57, v58
    v_min3_u32 v20, v20, v59, v60
    v_mfma_f32_16x16x32_bf16 a[252:255], a[92:95], v[92:95], a[252:255]
    s_waitcnt lgkmcnt(0)
    v_min3_u32 v20, v20, v61, v62
    v_min_u32 v20, v20, v63
    v_mfma_f32_16x16x32_bf16 a[192:195], a[96:99], v[64:67], a[192:195]
    s_waitcnt vmcnt(24)
    ds_read_b64_tr_b16 v[80:81], v12 offset:61440
    ds_read_b64_tr_b16 v[82:83], v12 offset:61952
    v_mfma_f32_16x16x32_bf16 a[196:199], a[100:103], v[64:67], a[196:199]
    ds_read_b64_tr_b16 v[84:85], v13 offset:61440
    ds_read_b64_tr_b16 v[86:87], v13 offset:61952
    v_mfma_f32_16x16x32_bf16 a[224:227], a[104:107], v[64:67], a[224:227]
    ds_read_b64_tr_b16 v[88:89], v14 offset:61440
    ds_read_b64_tr_b16 v[90:91], v14 offset:61952
    v_mfma_f32_16x16x32_bf16 a[228:231], a[108:111], v[64:67], a[228:231]
    ds_read_b64_tr_b16 v[92:93], v15 offset:61440
    ds_read_b64_tr_b16 v[94:95], v15 offset:61952
    v_mfma_f32_16x16x32_bf16 a[200:203], a[96:99], v[68:71], a[200:203]
    ds_read_b128 a[64:67], v16 offset:16384
    ds_read_b128 a[68:71], v16 offset:18432
    v_mfma_f32_16x16x32_bf16 a[204:207], a[100:103], v[68:71], a[204:207]
    ds_read_b128 a[72:75], v16 offset:20480
    ds_read_b128 a[76:79], v16 offset:22528
    v_mfma_f32_16x16x32_bf16 a[232:235], a[104:107], v[68:71], a[232:235]
    ds_read_b128 a[80:83], v17 offset:16384
    ds_read_b128 a[84:87], v17 offset:18432
    v_mfma_f32_16x16x32_bf16 a[236:239], a[108:111], v[68:71], a[236:239]
    ds_read_b128 a[88:91], v17 offset:20480
    ds_read_b128 a[92:95], v17 offset:22528
    v_mfma_f32_16x16x32_bf16 a[208:211], a[96:99], v[72:75], a[208:211]
    buffer_store_dwordx4 v[112:115], v2, s[28:31], s47 offen offset:0 sc1
    v_mfma_f32_16x16x32_bf16 a[212:215], a[100:103], v[72:75], a[212:215]
    v_accvgpr_read_b32 v120, a136
    v_accvgpr_read_b32 v121, a137
    v_mfma_f32_16x16x32_bf16 a[240:243], a[104:107], v[72:75], a[240:243]
    v_accvgpr_read_b32 v122, a138
    v_accvgpr_read_b32 v123, a139
    v_mfma_f32_16x16x32_bf16 a[244:247], a[108:111], v[72:75], a[244:247]
    buffer_load_dwordx4 v5, s[12:15], s46 offen offset:1024 lds
    v_mfma_f32_16x16x32_bf16 a[216:219], a[96:99], v[76:79], a[216:219]
    v_accvgpr_read_b32 v124, a140
    v_accvgpr_read_b32 v125, a141
    v_mfma_f32_16x16x32_bf16 a[220:223], a[100:103], v[76:79], a[220:223]
    v_accvgpr_read_b32 v126, a142
    v_accvgpr_read_b32 v127, a143
    v_mfma_f32_16x16x32_bf16 a[248:251], a[104:107], v[76:79], a[248:251]
    buffer_load_dwordx4 v6, s[12:15], s46 offen offset:2048 lds
    v_mfma_f32_16x16x32_bf16 a[252:255], a[108:111], v[76:79], a[252:255]
    s_waitcnt lgkmcnt(0)
    v_cvt_pk_bf16_f32 v120, v120, v121
    v_cvt_pk_bf16_f32 v121, v122, v123
    v_mfma_f32_16x16x32_bf16 a[192:195], a[112:115], v[80:83], a[192:195]
    s_waitcnt vmcnt(22)
    v_cmp_eq_u32 vcc, 0, v20
    v_mfma_f32_16x16x32_bf16 a[196:199], a[116:119], v[80:83], a[196:199]
    s_barrier
    ds_read_b64_tr_b16 v[64:65], v12 offset:0
    ds_read_b64_tr_b16 v[66:67], v12 offset:512
    v_mfma_f32_16x16x32_bf16 a[224:227], a[120:123], v[80:83], a[224:227]
    ds_read_b64_tr_b16 v[68:69], v13 offset:0
    ds_read_b64_tr_b16 v[70:71], v13 offset:512
    v_mfma_f32_16x16x32_bf16 a[228:231], a[124:127], v[80:83], a[228:231]
    ds_read_b64_tr_b16 v[72:73], v14 offset:0
    ds_read_b64_tr_b16 v[74:75], v14 offset:512
    v_mfma_f32_16x16x32_bf16 a[200:203], a[112:115], v[84:87], a[200:203]
    ds_read_b64_tr_b16 v[76:77], v15 offset:0
    ds_read_b64_tr_b16 v[78:79], v15 offset:512
    v_mfma_f32_16x16x32_bf16 a[204:207], a[116:119], v[84:87], a[204:207]
    buffer_load_dwordx4 v7, s[12:15], s46 offen offset:3072 lds
    v_mfma_f32_16x16x32_bf16 a[232:235], a[120:123], v[84:87], a[232:235]
    s_add_u32 s37, s45, 512
    v_cvt_pk_bf16_f32 v122, v124, v125
    v_cvt_pk_bf16_f32 v123, v126, v127
    v_mfma_f32_16x16x32_bf16 a[236:239], a[124:127], v[84:87], a[236:239]
    s_and_b32 s37, s37, 0x3ff
    s_cbranch_vccnz key_spin
    key_spin_ok:
    v_mfma_f32_16x16x32_bf16 a[208:211], a[112:115], v[88:91], a[208:211]
    s_add_u32 m0, s36, 8192
    v_max_u32 v18, v32, v33
    v_min_u32 v19, v32, v33
    v_mfma_f32_16x16x32_bf16 a[212:215], a[116:119], v[88:91], a[212:215]
    s_add_u32 s46, s34, s37
    buffer_load_dwordx4 v4, s[12:15], s46 offen offset:0 lds
    v_mfma_f32_16x16x32_bf16 a[240:243], a[120:123], v[88:91], a[240:243]
    v_med3_u32 v19, v18, v19, v34
    v_max_u32 v18, v18, v34
    v_mfma_f32_16x16x32_bf16 a[244:247], a[124:127], v[88:91], a[244:247]
    v_med3_u32 v19, v18, v19, v35
    v_max_u32 v18, v18, v35
    v_mfma_f32_16x16x32_bf16 a[216:219], a[112:115], v[92:95], a[216:219]
    buffer_store_dwordx4 v[120:123], v2, s[28:31], s47 offen offset:1024 sc1
    v_mfma_f32_16x16x32_bf16 a[220:223], a[116:119], v[92:95], a[220:223]
    v_accvgpr_read_b32 v112, a144
    v_accvgpr_read_b32 v113, a145
    v_mfma_f32_16x16x32_bf16 a[248:251], a[120:123], v[92:95], a[248:251]
    v_accvgpr_read_b32 v114, a146
    v_accvgpr_read_b32 v115, a147
    v_mfma_f32_16x16x32_bf16 a[252:255], a[124:127], v[92:95], a[252:255]
    s_waitcnt lgkmcnt(0)
    buffer_load_dwordx4 v5, s[12:15], s46 offen offset:1024 lds
    v_mfma_f32_16x16x32_bf16 v[128:131], v[64:67], a[0:3], 0
    ds_read_b64_tr_b16 v[80:81], v12 offset:4096
    ds_read_b64_tr_b16 v[82:83], v12 offset:4608
    v_mfma_f32_16x16x32_bf16 v[144:147], v[64:67], a[4:7], 0
    ds_read_b64_tr_b16 v[84:85], v13 offset:4096
    ds_read_b64_tr_b16 v[86:87], v13 offset:4608
    v_mfma_f32_16x16x32_bf16 v[160:163], v[64:67], a[8:11], 0
    ds_read_b64_tr_b16 v[88:89], v14 offset:4096
    ds_read_b64_tr_b16 v[90:91], v14 offset:4608
    v_mfma_f32_16x16x32_bf16 v[176:179], v[64:67], a[12:15], 0
    ds_read_b64_tr_b16 v[92:93], v15 offset:4096
    ds_read_b64_tr_b16 v[94:95], v15 offset:4608
    v_mfma_f32_16x16x32_bf16 v[132:135], v[68:71], a[0:3], 0
    buffer_load_dwordx4 v6, s[12:15], s46 offen offset:2048 lds
    v_mfma_f32_16x16x32_bf16 v[148:151], v[68:71], a[4:7], 0
    v_accvgpr_read_b32 v116, a148
    v_accvgpr_read_b32 v117, a149
    v_mfma_f32_16x16x32_bf16 v[164:167], v[68:71], a[8:11], 0
    v_accvgpr_read_b32 v118, a150
    v_accvgpr_read_b32 v119, a151
    v_mfma_f32_16x16x32_bf16 v[180:183], v[68:71], a[12:15], 0
    buffer_load_dwordx4 v7, s[12:15], s46 offen offset:3072 lds
    v_mfma_f32_16x16x32_bf16 v[136:139], v[72:75], a[0:3], 0
    s_add_u32 m0, s36, 12288
    v_cvt_pk_bf16_f32 v112, v112, v113
    v_cvt_pk_bf16_f32 v113, v114, v115
    v_mfma_f32_16x16x32_bf16 v[152:155], v[72:75], a[4:7], 0
    s_add_u32 s46, s35, s37
    v_cvt_pk_bf16_f32 v114, v116, v117
    v_cvt_pk_bf16_f32 v115, v118, v119
    v_mfma_f32_16x16x32_bf16 v[168:171], v[72:75], a[8:11], 0
    buffer_load_dwordx4 v4, s[12:15], s46 offen offset:0 lds
    v_mfma_f32_16x16x32_bf16 v[184:187], v[72:75], a[12:15], 0
    v_med3_u32 v19, v18, v19, v36
    v_max_u32 v18, v18, v36
    v_mfma_f32_16x16x32_bf16 v[140:143], v[76:79], a[0:3], 0
    v_med3_u32 v19, v18, v19, v37
    v_max_u32 v18, v18, v37
    v_mfma_f32_16x16x32_bf16 v[156:159], v[76:79], a[4:7], 0
    buffer_load_dwordx4 v5, s[12:15], s46 offen offset:1024 lds
    v_mfma_f32_16x16x32_bf16 v[172:175], v[76:79], a[8:11], 0
    v_med3_u32 v19, v18, v19, v38
    v_max_u32 v18, v18, v38
    v_mfma_f32_16x16x32_bf16 v[188:191], v[76:79], a[12:15], 0
    s_waitcnt lgkmcnt(0)
    v_med3_u32 v19, v18, v19, v39
    v_max_u32 v18, v18, v39
    v_mfma_f32_16x16x32_bf16 v[128:131], v[80:83], a[16:19], v[128:131]
    ds_read_b64_tr_b16 v[64:65], v12 offset:8192
    ds_read_b64_tr_b16 v[66:67], v12 offset:8704
    v_mfma_f32_16x16x32_bf16 v[144:147], v[80:83], a[20:23], v[144:147]
    ds_read_b64_tr_b16 v[68:69], v13 offset:8192
    ds_read_b64_tr_b16 v[70:71], v13 offset:8704
    v_mfma_f32_16x16x32_bf16 v[160:163], v[80:83], a[24:27], v[160:163]
    ds_read_b64_tr_b16 v[72:73], v14 offset:8192
    ds_read_b64_tr_b16 v[74:75], v14 offset:8704
    v_mfma_f32_16x16x32_bf16 v[176:179], v[80:83], a[28:31], v[176:179]
    ds_read_b64_tr_b16 v[76:77], v15 offset:8192
    ds_read_b64_tr_b16 v[78:79], v15 offset:8704
    v_mfma_f32_16x16x32_bf16 v[132:135], v[84:87], a[16:19], v[132:135]
    buffer_store_dwordx4 v[112:115], v2, s[28:31], s47 offen offset:2048 sc1
    v_mfma_f32_16x16x32_bf16 v[148:151], v[84:87], a[20:23], v[148:151]
    v_accvgpr_read_b32 v120, a152
    v_accvgpr_read_b32 v121, a153
    v_mfma_f32_16x16x32_bf16 v[164:167], v[84:87], a[24:27], v[164:167]
    v_accvgpr_read_b32 v122, a154
    v_accvgpr_read_b32 v123, a155
    v_mfma_f32_16x16x32_bf16 v[180:183], v[84:87], a[28:31], v[180:183]
    buffer_load_dwordx4 v6, s[12:15], s46 offen offset:2048 lds
    v_mfma_f32_16x16x32_bf16 v[136:139], v[88:91], a[16:19], v[136:139]
    v_accvgpr_read_b32 v124, a156
    v_accvgpr_read_b32 v125, a157
    v_mfma_f32_16x16x32_bf16 v[152:155], v[88:91], a[20:23], v[152:155]
    v_accvgpr_read_b32 v126, a158
    v_accvgpr_read_b32 v127, a159
    v_mfma_f32_16x16x32_bf16 v[168:171], v[88:91], a[24:27], v[168:171]
    buffer_load_dwordx4 v7, s[12:15], s46 offen offset:3072 lds
    v_mfma_f32_16x16x32_bf16 v[184:187], v[88:91], a[28:31], v[184:187]
    s_add_u32 m0, s40, 49152
    v_cvt_pk_bf16_f32 v120, v120, v121
    v_cvt_pk_bf16_f32 v121, v122, v123
    v_mfma_f32_16x16x32_bf16 v[140:143], v[92:95], a[16:19], v[140:143]
    s_add_u32 s46, s43, 1572864
    v_cvt_pk_bf16_f32 v122, v124, v125
    v_cvt_pk_bf16_f32 v123, v126, v127
    v_mfma_f32_16x16x32_bf16 v[156:159], v[92:95], a[20:23], v[156:159]
    s_and_b32 s46, s46, 0x3fffff
    buffer_load_dwordx4 v8, s[24:27], s46 offen offset:0 lds
    v_mfma_f32_16x16x32_bf16 v[172:175], v[92:95], a[24:27], v[172:175]
    v_med3_u32 v19, v18, v19, v40
    v_max_u32 v18, v18, v40
    v_mfma_f32_16x16x32_bf16 v[188:191], v[92:95], a[28:31], v[188:191]
    s_waitcnt lgkmcnt(0)
    v_med3_u32 v19, v18, v19, v41
    v_max_u32 v18, v18, v41
    v_mfma_f32_16x16x32_bf16 v[128:131], v[64:67], a[32:35], v[128:131]
    ds_read_b64_tr_b16 v[80:81], v12 offset:12288
    ds_read_b64_tr_b16 v[82:83], v12 offset:12800
    v_mfma_f32_16x16x32_bf16 v[144:147], v[64:67], a[36:39], v[144:147]
    ds_read_b64_tr_b16 v[84:85], v13 offset:12288
    ds_read_b64_tr_b16 v[86:87], v13 offset:12800
    v_mfma_f32_16x16x32_bf16 v[160:163], v[64:67], a[40:43], v[160:163]
    ds_read_b64_tr_b16 v[88:89], v14 offset:12288
    ds_read_b64_tr_b16 v[90:91], v14 offset:12800
    v_mfma_f32_16x16x32_bf16 v[176:179], v[64:67], a[44:47], v[176:179]
    ds_read_b64_tr_b16 v[92:93], v15 offset:12288
    ds_read_b64_tr_b16 v[94:95], v15 offset:12800
    v_mfma_f32_16x16x32_bf16 v[132:135], v[68:71], a[32:35], v[132:135]
    buffer_load_dwordx4 v9, s[24:27], s46 offen offset:1024 lds
    v_mfma_f32_16x16x32_bf16 v[148:151], v[68:71], a[36:39], v[148:151]
    v_med3_u32 v19, v18, v19, v42
    v_max_u32 v18, v18, v42
    v_mfma_f32_16x16x32_bf16 v[164:167], v[68:71], a[40:43], v[164:167]
    v_med3_u32 v19, v18, v19, v43
    v_max_u32 v18, v18, v43
    v_mfma_f32_16x16x32_bf16 v[180:183], v[68:71], a[44:47], v[180:183]
    buffer_load_dwordx4 v10, s[24:27], s46 offen offset:2048 lds
    v_mfma_f32_16x16x32_bf16 v[136:139], v[72:75], a[32:35], v[136:139]
    v_med3_u32 v19, v18, v19, v44
    v_max_u32 v18, v18, v44
    v_mfma_f32_16x16x32_bf16 v[152:155], v[72:75], a[36:39], v[152:155]
    v_med3_u32 v19, v18, v19, v45
    v_max_u32 v18, v18, v45
    v_mfma_f32_16x16x32_bf16 v[168:171], v[72:75], a[40:43], v[168:171]
    buffer_store_dwordx4 v[120:123], v2, s[28:31], s47 offen offset:3072 sc1
    v_mfma_f32_16x16x32_bf16 v[184:187], v[72:75], a[44:47], v[184:187]
    s_add_u32 s47, s42, 24576
    v_accvgpr_read_b32 v112, a160
    v_accvgpr_read_b32 v113, a161
    v_mfma_f32_16x16x32_bf16 v[140:143], v[76:79], a[32:35], v[140:143]
    v_accvgpr_read_b32 v114, a162
    v_accvgpr_read_b32 v115, a163
    v_mfma_f32_16x16x32_bf16 v[156:159], v[76:79], a[36:39], v[156:159]
    buffer_load_dwordx4 v11, s[24:27], s46 offen offset:3072 lds
    v_mfma_f32_16x16x32_bf16 v[172:175], v[76:79], a[40:43], v[172:175]
    s_add_u32 s37, s45, 640
    v_accvgpr_read_b32 v116, a164
    v_accvgpr_read_b32 v117, a165
    v_mfma_f32_16x16x32_bf16 v[188:191], v[76:79], a[44:47], v[188:191]
    s_waitcnt lgkmcnt(0)
    v_accvgpr_read_b32 v118, a166
    v_accvgpr_read_b32 v119, a167
    v_mfma_f32_16x16x32_bf16 v[128:131], v[80:83], a[48:51], v[128:131]
    s_waitcnt vmcnt(32)
    v_med3_u32 v19, v18, v19, v46
    v_max_u32 v18, v18, v46
    v_mfma_f32_16x16x32_bf16 v[144:147], v[80:83], a[52:55], v[144:147]
    s_barrier
    ds_read_b64_tr_b16 v[64:65], v12 offset:16384
    ds_read_b64_tr_b16 v[66:67], v12 offset:16896
    v_mfma_f32_16x16x32_bf16 v[160:163], v[80:83], a[56:59], v[160:163]
    s_and_b32 s37, s37, 0x3ff
    ds_read_b64_tr_b16 v[68:69], v13 offset:16384
    ds_read_b64_tr_b16 v[70:71], v13 offset:16896
    v_mfma_f32_16x16x32_bf16 v[176:179], v[80:83], a[60:63], v[176:179]
    s_add_u32 m0, s36, 16384
    ds_read_b64_tr_b16 v[72:73], v14 offset:16384
    ds_read_b64_tr_b16 v[74:75], v14 offset:16896
    v_mfma_f32_16x16x32_bf16 v[132:135], v[84:87], a[48:51], v[132:135]
    s_add_u32 s46, s34, s37
    ds_read_b64_tr_b16 v[76:77], v15 offset:16384
    ds_read_b64_tr_b16 v[78:79], v15 offset:16896
    v_mfma_f32_16x16x32_bf16 v[148:151], v[84:87], a[52:55], v[148:151]
    buffer_load_dwordx4 v4, s[12:15], s46 offen offset:0 lds
    v_mfma_f32_16x16x32_bf16 v[164:167], v[84:87], a[56:59], v[164:167]
    v_cvt_pk_bf16_f32 v112, v112, v113
    v_cvt_pk_bf16_f32 v113, v114, v115
    v_mfma_f32_16x16x32_bf16 v[180:183], v[84:87], a[60:63], v[180:183]
    v_cvt_pk_bf16_f32 v114, v116, v117
    v_cvt_pk_bf16_f32 v115, v118, v119
    v_mfma_f32_16x16x32_bf16 v[136:139], v[88:91], a[48:51], v[136:139]
    buffer_load_dwordx4 v5, s[12:15], s46 offen offset:1024 lds
    v_mfma_f32_16x16x32_bf16 v[152:155], v[88:91], a[52:55], v[152:155]
    v_med3_u32 v19, v18, v19, v47
    v_max_u32 v18, v18, v47
    v_mfma_f32_16x16x32_bf16 v[168:171], v[88:91], a[56:59], v[168:171]
    v_med3_u32 v19, v18, v19, v48
    v_max_u32 v18, v18, v48
    v_mfma_f32_16x16x32_bf16 v[184:187], v[88:91], a[60:63], v[184:187]
    buffer_load_dwordx4 v6, s[12:15], s46 offen offset:2048 lds
    v_mfma_f32_16x16x32_bf16 v[140:143], v[92:95], a[48:51], v[140:143]
    v_med3_u32 v19, v18, v19, v49
    v_max_u32 v18, v18, v49
    v_mfma_f32_16x16x32_bf16 v[156:159], v[92:95], a[52:55], v[156:159]
    v_med3_u32 v19, v18, v19, v50
    v_max_u32 v18, v18, v50
    v_mfma_f32_16x16x32_bf16 v[172:175], v[92:95], a[56:59], v[172:175]
    buffer_store_dwordx4 v[112:115], v2, s[28:31], s47 offen offset:0 sc1
    v_mfma_f32_16x16x32_bf16 v[188:191], v[92:95], a[60:63], v[188:191]
    s_waitcnt lgkmcnt(0)
    v_accvgpr_read_b32 v120, a168
    v_accvgpr_read_b32 v121, a169
    v_mfma_f32_16x16x32_bf16 v[192:195], v[64:67], a[0:3], 0
    ds_read_b64_tr_b16 v[80:81], v12 offset:20480
    ds_read_b64_tr_b16 v[82:83], v12 offset:20992
    v_mfma_f32_16x16x32_bf16 v[208:211], v[64:67], a[4:7], 0
    ds_read_b64_tr_b16 v[84:85], v13 offset:20480
    ds_read_b64_tr_b16 v[86:87], v13 offset:20992
    v_mfma_f32_16x16x32_bf16 v[224:227], v[64:67], a[8:11], 0
    ds_read_b64_tr_b16 v[88:89], v14 offset:20480
    ds_read_b64_tr_b16 v[90:91], v14 offset:20992
    v_mfma_f32_16x16x32_bf16 v[240:243], v[64:67], a[12:15], 0
    ds_read_b64_tr_b16 v[92:93], v15 offset:20480
    ds_read_b64_tr_b16 v[94:95], v15 offset:20992
    v_mfma_f32_16x16x32_bf16 v[196:199], v[68:71], a[0:3], 0
    buffer_load_dwordx4 v7, s[12:15], s46 offen offset:3072 lds
    v_mfma_f32_16x16x32_bf16 v[212:215], v[68:71], a[4:7], 0
    s_add_u32 m0, s36, 20480
    v_accvgpr_read_b32 v122, a170
    v_accvgpr_read_b32 v123, a171
    v_mfma_f32_16x16x32_bf16 v[228:231], v[68:71], a[8:11], 0
    s_add_u32 s46, s35, s37
    v_accvgpr_read_b32 v124, a172
    v_accvgpr_read_b32 v125, a173
    v_mfma_f32_16x16x32_bf16 v[244:247], v[68:71], a[12:15], 0
    buffer_load_dwordx4 v4, s[12:15], s46 offen offset:0 lds
    v_mfma_f32_16x16x32_bf16 v[200:203], v[72:75], a[0:3], 0
    v_accvgpr_read_b32 v126, a174
    v_accvgpr_read_b32 v127, a175
    v_mfma_f32_16x16x32_bf16 v[216:219], v[72:75], a[4:7], 0
    v_cvt_pk_bf16_f32 v120, v120, v121
    v_cvt_pk_bf16_f32 v121, v122, v123
    v_mfma_f32_16x16x32_bf16 v[232:235], v[72:75], a[8:11], 0
    buffer_load_dwordx4 v5, s[12:15], s46 offen offset:1024 lds
    v_mfma_f32_16x16x32_bf16 v[248:251], v[72:75], a[12:15], 0
    v_cvt_pk_bf16_f32 v122, v124, v125
    v_cvt_pk_bf16_f32 v123, v126, v127
    v_mfma_f32_16x16x32_bf16 v[204:207], v[76:79], a[0:3], 0
    v_med3_u32 v19, v18, v19, v51
    v_max_u32 v18, v18, v51
    v_mfma_f32_16x16x32_bf16 v[220:223], v[76:79], a[4:7], 0
    buffer_load_dwordx4 v6, s[12:15], s46 offen offset:2048 lds
    v_mfma_f32_16x16x32_bf16 v[236:239], v[76:79], a[8:11], 0
    v_med3_u32 v19, v18, v19, v52
    v_max_u32 v18, v18, v52
    v_mfma_f32_16x16x32_bf16 v[252:255], v[76:79], a[12:15], 0
    s_waitcnt lgkmcnt(0)
    v_med3_u32 v19, v18, v19, v53
    v_max_u32 v18, v18, v53
    v_mfma_f32_16x16x32_bf16 v[192:195], v[80:83], a[16:19], v[192:195]
    s_waitcnt vmcnt(23)
    ds_read_b64_tr_b16 v[64:65], v12 offset:24576
    ds_read_b64_tr_b16 v[66:67], v12 offset:25088
    v_mfma_f32_16x16x32_bf16 v[208:211], v[80:83], a[20:23], v[208:211]
    ds_read_b64_tr_b16 v[68:69], v13 offset:24576
    ds_read_b64_tr_b16 v[70:71], v13 offset:25088
    v_mfma_f32_16x16x32_bf16 v[224:227], v[80:83], a[24:27], v[224:227]
    ds_read_b64_tr_b16 v[72:73], v14 offset:24576
    ds_read_b64_tr_b16 v[74:75], v14 offset:25088
    v_mfma_f32_16x16x32_bf16 v[240:243], v[80:83], a[28:31], v[240:243]
    ds_read_b64_tr_b16 v[76:77], v15 offset:24576
    ds_read_b64_tr_b16 v[78:79], v15 offset:25088
    v_mfma_f32_16x16x32_bf16 v[196:199], v[84:87], a[16:19], v[196:199]
    ds_read_b128 a[96:99], v16 offset:0
    ds_read_b128 a[100:103], v16 offset:2048
    v_mfma_f32_16x16x32_bf16 v[212:215], v[84:87], a[20:23], v[212:215]
    ds_read_b128 a[104:107], v16 offset:4096
    ds_read_b128 a[108:111], v16 offset:6144
    v_mfma_f32_16x16x32_bf16 v[228:231], v[84:87], a[24:27], v[228:231]
    ds_read_b128 a[112:115], v17 offset:0
    ds_read_b128 a[116:119], v17 offset:2048
    v_mfma_f32_16x16x32_bf16 v[244:247], v[84:87], a[28:31], v[244:247]
    ds_read_b128 a[120:123], v17 offset:4096
    ds_read_b128 a[124:127], v17 offset:6144
    v_mfma_f32_16x16x32_bf16 v[200:203], v[88:91], a[16:19], v[200:203]
    buffer_store_dwordx4 v[120:123], v2, s[28:31], s47 offen offset:1024 sc1
    v_mfma_f32_16x16x32_bf16 v[216:219], v[88:91], a[20:23], v[216:219]
    v_accvgpr_read_b32 v112, a176
    v_accvgpr_read_b32 v113, a177
    v_mfma_f32_16x16x32_bf16 v[232:235], v[88:91], a[24:27], v[232:235]
    v_accvgpr_read_b32 v114, a178
    v_accvgpr_read_b32 v115, a179
    v_mfma_f32_16x16x32_bf16 v[248:251], v[88:91], a[28:31], v[248:251]
    buffer_load_dwordx4 v7, s[12:15], s46 offen offset:3072 lds
    v_mfma_f32_16x16x32_bf16 v[204:207], v[92:95], a[16:19], v[204:207]
    s_add_u32 m0, s40, 0
    v_accvgpr_read_b32 v116, a180
    v_accvgpr_read_b32 v117, a181
    v_mfma_f32_16x16x32_bf16 v[220:223], v[92:95], a[20:23], v[220:223]
    s_add_u32 s46, s43, 2097152
    v_accvgpr_read_b32 v118, a182
    v_accvgpr_read_b32 v119, a183
    v_mfma_f32_16x16x32_bf16 v[236:239], v[92:95], a[24:27], v[236:239]
    s_and_b32 s46, s46, 0x3fffff
    buffer_load_dwordx4 v8, s[24:27], s46 offen offset:0 lds
    v_mfma_f32_16x16x32_bf16 v[252:255], v[92:95], a[28:31], v[252:255]
    s_waitcnt lgkmcnt(0)
    v_cvt_pk_bf16_f32 v112, v112, v113
    v_cvt_pk_bf16_f32 v113, v114, v115
    v_mfma_f32_16x16x32_bf16 v[192:195], v[64:67], a[32:35], v[192:195]
    ds_read_b64_tr_b16 v[80:81], v12 offset:28672
    ds_read_b64_tr_b16 v[82:83], v12 offset:29184
    v_mfma_f32_16x16x32_bf16 v[208:211], v[64:67], a[36:39], v[208:211]
    ds_read_b64_tr_b16 v[84:85], v13 offset:28672
    ds_read_b64_tr_b16 v[86:87], v13 offset:29184
    v_mfma_f32_16x16x32_bf16 v[224:227], v[64:67], a[40:43], v[224:227]
    ds_read_b64_tr_b16 v[88:89], v14 offset:28672
    ds_read_b64_tr_b16 v[90:91], v14 offset:29184
    v_mfma_f32_16x16x32_bf16 v[240:243], v[64:67], a[44:47], v[240:243]
    ds_read_b64_tr_b16 v[92:93], v15 offset:28672
    ds_read_b64_tr_b16 v[94:95], v15 offset:29184
    v_mfma_f32_16x16x32_bf16 v[196:199], v[68:71], a[32:35], v[196:199]
    buffer_load_dwordx4 v9, s[24:27], s46 offen offset:1024 lds
    v_mfma_f32_16x16x32_bf16 v[212:215], v[68:71], a[36:39], v[212:215]
    v_cvt_pk_bf16_f32 v114, v116, v117
    v_cvt_pk_bf16_f32 v115, v118, v119
    v_mfma_f32_16x16x32_bf16 v[228:231], v[68:71], a[40:43], v[228:231]
    v_med3_u32 v19, v18, v19, v54
    v_max_u32 v18, v18, v54
    v_mfma_f32_16x16x32_bf16 v[244:247], v[68:71], a[44:47], v[244:247]
    buffer_load_dwordx4 v10, s[24:27], s46 offen offset:2048 lds
    v_mfma_f32_16x16x32_bf16 v[200:203], v[72:75], a[32:35], v[200:203]
    v_med3_u32 v19, v18, v19, v55
    v_max_u32 v18, v18, v55
    v_mfma_f32_16x16x32_bf16 v[216:219], v[72:75], a[36:39], v[216:219]
    v_med3_u32 v19, v18, v19, v56
    v_max_u32 v18, v18, v56
    v_mfma_f32_16x16x32_bf16 v[232:235], v[72:75], a[40:43], v[232:235]
    buffer_load_dwordx4 v11, s[24:27], s46 offen offset:3072 lds
    v_mfma_f32_16x16x32_bf16 v[248:251], v[72:75], a[44:47], v[248:251]
    s_add_u32 s37, s45, 768
    v_med3_u32 v19, v18, v19, v57
    v_max_u32 v18, v18, v57
    v_mfma_f32_16x16x32_bf16 v[204:207], v[76:79], a[32:35], v[204:207]
    s_and_b32 s37, s37, 0x3ff
    v_med3_u32 v19, v18, v19, v58
    v_max_u32 v18, v18, v58
    v_mfma_f32_16x16x32_bf16 v[220:223], v[76:79], a[36:39], v[220:223]
    s_add_u32 m0, s36, 0
    v_med3_u32 v19, v18, v19, v59
    v_max_u32 v18, v18, v59
    v_mfma_f32_16x16x32_bf16 v[236:239], v[76:79], a[40:43], v[236:239]
    s_add_u32 s46, s34, s37
    buffer_store_dwordx4 v[112:115], v2, s[28:31], s47 offen offset:2048 sc1
    v_mfma_f32_16x16x32_bf16 v[252:255], v[76:79], a[44:47], v[252:255]
    s_waitcnt lgkmcnt(0)
    v_accvgpr_read_b32 v120, a184
    v_accvgpr_read_b32 v121, a185
    v_mfma_f32_16x16x32_bf16 v[192:195], v[80:83], a[48:51], v[192:195]
    s_waitcnt vmcnt(40)
    v_med3_u32 v19, v18, v19, v60
    v_max_u32 v18, v18, v60
    v_mfma_f32_16x16x32_bf16 v[208:211], v[80:83], a[52:55], v[208:211]
    s_barrier
    ds_read_b64_tr_b16 v[64:65], v12 offset:32768
    ds_read_b64_tr_b16 v[66:67], v12 offset:33280
    v_mfma_f32_16x16x32_bf16 v[224:227], v[80:83], a[56:59], v[224:227]
    ds_read_b64_tr_b16 v[68:69], v13 offset:32768
    ds_read_b64_tr_b16 v[70:71], v13 offset:33280
    v_mfma_f32_16x16x32_bf16 v[240:243], v[80:83], a[60:63], v[240:243]
    ds_read_b64_tr_b16 v[72:73], v14 offset:32768
    ds_read_b64_tr_b16 v[74:75], v14 offset:33280
    v_mfma_f32_16x16x32_bf16 v[196:199], v[84:87], a[48:51], v[196:199]
    ds_read_b64_tr_b16 v[76:77], v15 offset:32768
    ds_read_b64_tr_b16 v[78:79], v15 offset:33280
    v_mfma_f32_16x16x32_bf16 v[212:215], v[84:87], a[52:55], v[212:215]
    buffer_load_dwordx4 v4, s[12:15], s46 offen offset:0 lds
    v_mfma_f32_16x16x32_bf16 v[228:231], v[84:87], a[56:59], v[228:231]
    v_accvgpr_read_b32 v122, a186
    v_accvgpr_read_b32 v123, a187
    v_mfma_f32_16x16x32_bf16 v[244:247], v[84:87], a[60:63], v[244:247]
    v_accvgpr_read_b32 v124, a188
    v_accvgpr_read_b32 v125, a189
    v_mfma_f32_16x16x32_bf16 v[200:203], v[88:91], a[48:51], v[200:203]
    buffer_load_dwordx4 v5, s[12:15], s46 offen offset:1024 lds
    v_mfma_f32_16x16x32_bf16 v[216:219], v[88:91], a[52:55], v[216:219]
    v_accvgpr_read_b32 v126, a190
    v_accvgpr_read_b32 v127, a191
    v_mfma_f32_16x16x32_bf16 v[232:235], v[88:91], a[56:59], v[232:235]
    v_cvt_pk_bf16_f32 v120, v120, v121
    v_cvt_pk_bf16_f32 v121, v122, v123
    v_mfma_f32_16x16x32_bf16 v[248:251], v[88:91], a[60:63], v[248:251]
    buffer_load_dwordx4 v6, s[12:15], s46 offen offset:2048 lds
    v_mfma_f32_16x16x32_bf16 v[204:207], v[92:95], a[48:51], v[204:207]
    v_cvt_pk_bf16_f32 v122, v124, v125
    v_cvt_pk_bf16_f32 v123, v126, v127
    v_mfma_f32_16x16x32_bf16 v[220:223], v[92:95], a[52:55], v[220:223]
    v_med3_u32 v19, v18, v19, v61
    v_max_u32 v18, v18, v61
    v_mfma_f32_16x16x32_bf16 v[236:239], v[92:95], a[56:59], v[236:239]
    buffer_load_dwordx4 v7, s[12:15], s46 offen offset:3072 lds
    v_mfma_f32_16x16x32_bf16 v[252:255], v[92:95], a[60:63], v[252:255]
    s_waitcnt lgkmcnt(0)
    v_med3_u32 v19, v18, v19, v62
    v_max_u32 v18, v18, v62
    v_mfma_f32_16x16x32_bf16 v[128:131], v[64:67], a[64:67], v[128:131]
    s_add_u32 m0, s36, 4096
    ds_read_b64_tr_b16 v[80:81], v12 offset:36864
    ds_read_b64_tr_b16 v[82:83], v12 offset:37376
    v_mfma_f32_16x16x32_bf16 v[144:147], v[64:67], a[68:71], v[144:147]
    s_add_u32 s46, s35, s37
    ds_read_b64_tr_b16 v[84:85], v13 offset:36864
    ds_read_b64_tr_b16 v[86:87], v13 offset:37376
    v_mfma_f32_16x16x32_bf16 v[160:163], v[64:67], a[72:75], v[160:163]
    ds_read_b64_tr_b16 v[88:89], v14 offset:36864
    ds_read_b64_tr_b16 v[90:91], v14 offset:37376
    v_mfma_f32_16x16x32_bf16 v[176:179], v[64:67], a[76:79], v[176:179]
    ds_read_b64_tr_b16 v[92:93], v15 offset:36864
    ds_read_b64_tr_b16 v[94:95], v15 offset:37376
    v_mfma_f32_16x16x32_bf16 v[132:135], v[68:71], a[64:67], v[132:135]
    buffer_store_dwordx4 v[120:123], v2, s[28:31], s47 offen offset:3072 sc1
    v_mfma_f32_16x16x32_bf16 v[148:151], v[68:71], a[68:71], v[148:151]
    s_add_u32 s47, s42, 12288
    v_accvgpr_read_b32 v112, a192
    v_accvgpr_read_b32 v113, a193
    v_mfma_f32_16x16x32_bf16 v[164:167], v[68:71], a[72:75], v[164:167]
    v_accvgpr_read_b32 v114, a194
    v_accvgpr_read_b32 v115, a195
    v_mfma_f32_16x16x32_bf16 v[180:183], v[68:71], a[76:79], v[180:183]
    buffer_load_dwordx4 v4, s[12:15], s46 offen offset:0 lds
    v_mfma_f32_16x16x32_bf16 v[136:139], v[72:75], a[64:67], v[136:139]
    v_accvgpr_read_b32 v116, a196
    v_accvgpr_read_b32 v117, a197
    v_mfma_f32_16x16x32_bf16 v[152:155], v[72:75], a[68:71], v[152:155]
    v_accvgpr_read_b32 v118, a198
    v_accvgpr_read_b32 v119, a199
    v_mfma_f32_16x16x32_bf16 v[168:171], v[72:75], a[72:75], v[168:171]
    buffer_load_dwordx4 v5, s[12:15], s46 offen offset:1024 lds
    v_mfma_f32_16x16x32_bf16 v[184:187], v[72:75], a[76:79], v[184:187]
    v_cvt_pk_bf16_f32 v112, v112, v113
    v_cvt_pk_bf16_f32 v113, v114, v115
    v_mfma_f32_16x16x32_bf16 v[140:143], v[76:79], a[64:67], v[140:143]
    v_cvt_pk_bf16_f32 v114, v116, v117
    v_cvt_pk_bf16_f32 v115, v118, v119
    v_mfma_f32_16x16x32_bf16 v[156:159], v[76:79], a[68:71], v[156:159]
    buffer_load_dwordx4 v6, s[12:15], s46 offen offset:2048 lds
    v_mfma_f32_16x16x32_bf16 v[172:175], v[76:79], a[72:75], v[172:175]
    v_med3_u32 v19, v18, v19, v63
    v_max_u32 v18, v18, v63
    v_mfma_f32_16x16x32_bf16 v[188:191], v[76:79], a[76:79], v[188:191]
    s_waitcnt lgkmcnt(0)
    v_mov_b32 v20, v18
    v_mfma_f32_16x16x32_bf16 v[192:195], v[80:83], a[64:67], v[192:195]
    s_waitcnt vmcnt(28)
    ds_read_b64_tr_b16 v[64:65], v12 offset:40960
    ds_read_b64_tr_b16 v[66:67], v12 offset:41472
    v_mfma_f32_16x16x32_bf16 v[208:211], v[80:83], a[68:71], v[208:211]
    s_nop 1
    ds_read_b64_tr_b16 v[68:69], v13 offset:40960
    ds_read_b64_tr_b16 v[70:71], v13 offset:41472
    v_mfma_f32_16x16x32_bf16 v[224:227], v[80:83], a[72:75], v[224:227]
    ds_read_b64_tr_b16 v[72:73], v14 offset:40960
    ds_read_b64_tr_b16 v[74:75], v14 offset:41472
    v_mfma_f32_16x16x32_bf16 v[240:243], v[80:83], a[76:79], v[240:243]
    ds_read_b64_tr_b16 v[76:77], v15 offset:40960
    ds_read_b64_tr_b16 v[78:79], v15 offset:41472
    v_mfma_f32_16x16x32_bf16 v[196:199], v[84:87], a[64:67], v[196:199]
    ds_read_b128 a[0:3], v16 offset:8192
    ds_read_b128 a[4:7], v16 offset:10240
    v_mfma_f32_16x16x32_bf16 v[212:215], v[84:87], a[68:71], v[212:215]
    ds_read_b128 a[8:11], v16 offset:12288
    ds_read_b128 a[12:15], v16 offset:14336
    v_mfma_f32_16x16x32_bf16 v[228:231], v[84:87], a[72:75], v[228:231]
    ds_read_b128 a[16:19], v17 offset:8192
    ds_read_b128 a[20:23], v17 offset:10240
    v_mfma_f32_16x16x32_bf16 v[244:247], v[84:87], a[76:79], v[244:247]
    ds_read_b128 a[24:27], v17 offset:12288
    ds_read_b128 a[28:31], v17 offset:14336
    v_mfma_f32_16x16x32_bf16 v[200:203], v[88:91], a[64:67], v[200:203]
    buffer_store_dwordx4 v[112:115], v2, s[28:31], s47 offen offset:0 sc1
    v_mfma_f32_16x16x32_bf16 v[216:219], v[88:91], a[68:71], v[216:219]
    v_accvgpr_read_b32 v120, a200
    v_accvgpr_read_b32 v121, a201
    v_mfma_f32_16x16x32_bf16 v[232:235], v[88:91], a[72:75], v[232:235]
    v_accvgpr_read_b32 v122, a202
    v_accvgpr_read_b32 v123, a203
    v_mfma_f32_16x16x32_bf16 v[248:251], v[88:91], a[76:79], v[248:251]
    buffer_load_dwordx4 v7, s[12:15], s46 offen offset:3072 lds
    v_mfma_f32_16x16x32_bf16 v[204:207], v[92:95], a[64:67], v[204:207]
    s_add_u32 m0, s40, 16384
    v_accvgpr_read_b32 v124, a204
    v_accvgpr_read_b32 v125, a205
    v_mfma_f32_16x16x32_bf16 v[220:223], v[92:95], a[68:71], v[220:223]
    s_add_u32 s46, s43, 2621440
    v_accvgpr_read_b32 v126, a206
    v_accvgpr_read_b32 v127, a207
    v_mfma_f32_16x16x32_bf16 v[236:239], v[92:95], a[72:75], v[236:239]
    s_and_b32 s46, s46, 0x3fffff
    buffer_load_dwordx4 v8, s[24:27], s46 offen offset:0 lds
    v_mfma_f32_16x16x32_bf16 v[252:255], v[92:95], a[76:79], v[252:255]
    s_waitcnt lgkmcnt(0)
    v_cvt_pk_bf16_f32 v120, v120, v121
    v_cvt_pk_bf16_f32 v121, v122, v123
    v_mfma_f32_16x16x32_bf16 v[128:131], v[64:67], a[80:83], v[128:131]
    ds_read_b64_tr_b16 v[80:81], v12 offset:45056
    ds_read_b64_tr_b16 v[82:83], v12 offset:45568
    v_mfma_f32_16x16x32_bf16 v[144:147], v[64:67], a[84:87], v[144:147]
    ds_read_b64_tr_b16 v[84:85], v13 offset:45056
    ds_read_b64_tr_b16 v[86:87], v13 offset:45568
    v_mfma_f32_16x16x32_bf16 v[160:163], v[64:67], a[88:91], v[160:163]
    ds_read_b64_tr_b16 v[88:89], v14 offset:45056
    ds_read_b64_tr_b16 v[90:91], v14 offset:45568
    v_mfma_f32_16x16x32_bf16 v[176:179], v[64:67], a[92:95], v[176:179]
    ds_read_b64_tr_b16 v[92:93], v15 offset:45056
    ds_read_b64_tr_b16 v[94:95], v15 offset:45568
    v_mfma_f32_16x16x32_bf16 v[132:135], v[68:71], a[80:83], v[132:135]
    buffer_load_dwordx4 v9, s[24:27], s46 offen offset:1024 lds
    v_mfma_f32_16x16x32_bf16 v[148:151], v[68:71], a[84:87], v[148:151]
    v_cvt_pk_bf16_f32 v122, v124, v125
    v_cvt_pk_bf16_f32 v123, v126, v127
    v_mfma_f32_16x16x32_bf16 v[164:167], v[68:71], a[88:91], v[164:167]
    v_max_u32_dpp v20, v20, v20 row_shr:1 row_mask:0xf bank_mask:0xf bound_ctrl:0
    v_mfma_f32_16x16x32_bf16 v[180:183], v[68:71], a[92:95], v[180:183]
    s_nop 1
    buffer_load_dwordx4 v10, s[24:27], s46 offen offset:2048 lds
    v_mfma_f32_16x16x32_bf16 v[136:139], v[72:75], a[80:83], v[136:139]
    v_max_u32_dpp v20, v20, v20 row_shr:2 row_mask:0xf bank_mask:0xf bound_ctrl:0
    v_mfma_f32_16x16x32_bf16 v[152:155], v[72:75], a[84:87], v[152:155]
    s_nop 1
    v_max_u32_dpp v20, v20, v20 row_shr:4 row_mask:0xf bank_mask:0xf bound_ctrl:0
    v_mfma_f32_16x16x32_bf16 v[168:171], v[72:75], a[88:91], v[168:171]
    s_nop 1
    buffer_load_dwordx4 v11, s[24:27], s46 offen offset:3072 lds
    v_mfma_f32_16x16x32_bf16 v[184:187], v[72:75], a[92:95], v[184:187]
    s_add_u32 s37, s45, 896
    v_max_u32_dpp v20, v20, v20 row_shr:8 row_mask:0xf bank_mask:0xf bound_ctrl:0
    v_mfma_f32_16x16x32_bf16 v[140:143], v[76:79], a[80:83], v[140:143]
    s_and_b32 s37, s37, 0x3ff
    v_mfma_f32_16x16x32_bf16 v[156:159], v[76:79], a[84:87], v[156:159]
    s_add_u32 m0, s36, 8192
    v_mfma_f32_16x16x32_bf16 v[172:175], v[76:79], a[88:91], v[172:175]
    s_add_u32 s46, s34, s37
    buffer_store_dwordx4 v[120:123], v2, s[28:31], s47 offen offset:1024 sc1
    v_mfma_f32_16x16x32_bf16 v[188:191], v[76:79], a[92:95], v[188:191]
    s_waitcnt lgkmcnt(0)
    v_accvgpr_read_b32 v112, a208
    v_accvgpr_read_b32 v113, a209
    v_mfma_f32_16x16x32_bf16 v[192:195], v[80:83], a[80:83], v[192:195]
    s_waitcnt vmcnt(30)
    v_mfma_f32_16x16x32_bf16 v[208:211], v[80:83], a[84:87], v[208:211]
    s_barrier
    ds_read_b64_tr_b16 v[64:65], v12 offset:49152
    ds_read_b64_tr_b16 v[66:67], v12 offset:49664
    v_mfma_f32_16x16x32_bf16 v[224:227], v[80:83], a[88:91], v[224:227]
    s_nop 1
    ds_read_b64_tr_b16 v[68:69], v13 offset:49152
    ds_read_b64_tr_b16 v[70:71], v13 offset:49664
    v_mfma_f32_16x16x32_bf16 v[240:243], v[80:83], a[92:95], v[240:243]
    ds_read_b64_tr_b16 v[72:73], v14 offset:49152
    ds_read_b64_tr_b16 v[74:75], v14 offset:49664
    v_mfma_f32_16x16x32_bf16 v[196:199], v[84:87], a[80:83], v[196:199]
    ds_read_b64_tr_b16 v[76:77], v15 offset:49152
    ds_read_b64_tr_b16 v[78:79], v15 offset:49664
    v_mfma_f32_16x16x32_bf16 v[212:215], v[84:87], a[84:87], v[212:215]
    buffer_load_dwordx4 v4, s[12:15], s46 offen offset:0 lds
    v_mfma_f32_16x16x32_bf16 v[228:231], v[84:87], a[88:91], v[228:231]
    v_accvgpr_read_b32 v114, a210
    v_accvgpr_read_b32 v115, a211
    v_mfma_f32_16x16x32_bf16 v[244:247], v[84:87], a[92:95], v[244:247]
    v_accvgpr_read_b32 v116, a212
    v_accvgpr_read_b32 v117, a213
    v_mfma_f32_16x16x32_bf16 v[200:203], v[88:91], a[80:83], v[200:203]
    buffer_load_dwordx4 v5, s[12:15], s46 offen offset:1024 lds
    v_mfma_f32_16x16x32_bf16 v[216:219], v[88:91], a[84:87], v[216:219]
    v_accvgpr_read_b32 v118, a214
    v_accvgpr_read_b32 v119, a215
    v_mfma_f32_16x16x32_bf16 v[232:235], v[88:91], a[88:91], v[232:235]
    v_cvt_pk_bf16_f32 v112, v112, v113
    v_cvt_pk_bf16_f32 v113, v114, v115
    v_mfma_f32_16x16x32_bf16 v[248:251], v[88:91], a[92:95], v[248:251]
    buffer_load_dwordx4 v6, s[12:15], s46 offen offset:2048 lds
    v_mfma_f32_16x16x32_bf16 v[204:207], v[92:95], a[80:83], v[204:207]
    v_cvt_pk_bf16_f32 v114, v116, v117
    v_cvt_pk_bf16_f32 v115, v118, v119
    v_mfma_f32_16x16x32_bf16 v[220:223], v[92:95], a[84:87], v[220:223]
    v_max_u32_dpp v20, v20, v20 row_bcast:15 row_mask:0xa bank_mask:0xf
    v_mfma_f32_16x16x32_bf16 v[236:239], v[92:95], a[88:91], v[236:239]
    s_nop 1
    buffer_load_dwordx4 v7, s[12:15], s46 offen offset:3072 lds
    v_mfma_f32_16x16x32_bf16 v[252:255], v[92:95], a[92:95], v[252:255]
    s_waitcnt lgkmcnt(0)
    v_max_u32_dpp v20, v20, v20 row_bcast:31 row_mask:0xc bank_mask:0xf
    v_mfma_f32_16x16x32_bf16 v[128:131], v[64:67], a[96:99], v[128:131]
    s_add_u32 m0, s36, 12288
    ds_read_b64_tr_b16 v[80:81], v12 offset:53248
    ds_read_b64_tr_b16 v[82:83], v12 offset:53760
    v_mfma_f32_16x16x32_bf16 v[144:147], v[64:67], a[100:103], v[144:147]
    s_add_u32 s46, s35, s37
    ds_read_b64_tr_b16 v[84:85], v13 offset:53248
    ds_read_b64_tr_b16 v[86:87], v13 offset:53760
    v_mfma_f32_16x16x32_bf16 v[160:163], v[64:67], a[104:107], v[160:163]
    s_nop 0
    ds_read_b64_tr_b16 v[88:89], v14 offset:53248
    ds_read_b64_tr_b16 v[90:91], v14 offset:53760
    v_mfma_f32_16x16x32_bf16 v[176:179], v[64:67], a[108:111], v[176:179]
    ds_read_b64_tr_b16 v[92:93], v15 offset:53248
    ds_read_b64_tr_b16 v[94:95], v15 offset:53760
    v_mfma_f32_16x16x32_bf16 v[132:135], v[68:71], a[96:99], v[132:135]
    buffer_store_dwordx4 v[112:115], v2, s[28:31], s47 offen offset:2048 sc1
    v_mfma_f32_16x16x32_bf16 v[148:151], v[68:71], a[100:103], v[148:151]
    v_accvgpr_read_b32 v120, a216
    v_accvgpr_read_b32 v121, a217
    v_mfma_f32_16x16x32_bf16 v[164:167], v[68:71], a[104:107], v[164:167]
    v_accvgpr_read_b32 v122, a218
    v_accvgpr_read_b32 v123, a219
    v_mfma_f32_16x16x32_bf16 v[180:183], v[68:71], a[108:111], v[180:183]
    buffer_load_dwordx4 v4, s[12:15], s46 offen offset:0 lds
    v_mfma_f32_16x16x32_bf16 v[136:139], v[72:75], a[96:99], v[136:139]
    v_accvgpr_read_b32 v124, a220
    v_accvgpr_read_b32 v125, a221
    v_mfma_f32_16x16x32_bf16 v[152:155], v[72:75], a[100:103], v[152:155]
    v_accvgpr_read_b32 v126, a222
    v_accvgpr_read_b32 v127, a223
    v_mfma_f32_16x16x32_bf16 v[168:171], v[72:75], a[104:107], v[168:171]
    buffer_load_dwordx4 v5, s[12:15], s46 offen offset:1024 lds
    v_mfma_f32_16x16x32_bf16 v[184:187], v[72:75], a[108:111], v[184:187]
    v_cvt_pk_bf16_f32 v120, v120, v121
    v_cvt_pk_bf16_f32 v121, v122, v123
    v_mfma_f32_16x16x32_bf16 v[140:143], v[76:79], a[96:99], v[140:143]
    v_cvt_pk_bf16_f32 v122, v124, v125
    v_cvt_pk_bf16_f32 v123, v126, v127
    v_mfma_f32_16x16x32_bf16 v[156:159], v[76:79], a[100:103], v[156:159]
    buffer_load_dwordx4 v6, s[12:15], s46 offen offset:2048 lds
    v_mfma_f32_16x16x32_bf16 v[172:175], v[76:79], a[104:107], v[172:175]
    v_readlane_b32 s50, v20, 63
    v_mfma_f32_16x16x32_bf16 v[188:191], v[76:79], a[108:111], v[188:191]
    s_waitcnt lgkmcnt(0)
    v_mfma_f32_16x16x32_bf16 v[192:195], v[80:83], a[96:99], v[192:195]
    s_waitcnt vmcnt(28)
    ds_read_b64_tr_b16 v[64:65], v12 offset:57344
    ds_read_b64_tr_b16 v[66:67], v12 offset:57856
    v_mfma_f32_16x16x32_bf16 v[208:211], v[80:83], a[100:103], v[208:211]
    s_nop 1
    ds_read_b64_tr_b16 v[68:69], v13 offset:57344
    ds_read_b64_tr_b16 v[70:71], v13 offset:57856
    v_mfma_f32_16x16x32_bf16 v[224:227], v[80:83], a[104:107], v[224:227]
    ds_read_b64_tr_b16 v[72:73], v14 offset:57344
    ds_read_b64_tr_b16 v[74:75], v14 offset:57856
    v_mfma_f32_16x16x32_bf16 v[240:243], v[80:83], a[108:111], v[240:243]
    ds_read_b64_tr_b16 v[76:77], v15 offset:57344
    ds_read_b64_tr_b16 v[78:79], v15 offset:57856
    v_mfma_f32_16x16x32_bf16 v[196:199], v[84:87], a[96:99], v[196:199]
    ds_read_b128 a[32:35], v16 offset:16384
    ds_read_b128 a[36:39], v16 offset:18432
    v_mfma_f32_16x16x32_bf16 v[212:215], v[84:87], a[100:103], v[212:215]
    ds_read_b128 a[40:43], v16 offset:20480
    ds_read_b128 a[44:47], v16 offset:22528
    v_mfma_f32_16x16x32_bf16 v[228:231], v[84:87], a[104:107], v[228:231]
    ds_read_b128 a[48:51], v17 offset:16384
    ds_read_b128 a[52:55], v17 offset:18432
    v_mfma_f32_16x16x32_bf16 v[244:247], v[84:87], a[108:111], v[244:247]
    ds_read_b128 a[56:59], v17 offset:20480
    ds_read_b128 a[60:63], v17 offset:22528
    v_mfma_f32_16x16x32_bf16 v[200:203], v[88:91], a[96:99], v[200:203]
    buffer_store_dwordx4 v[120:123], v2, s[28:31], s47 offen offset:3072 sc1
    v_mfma_f32_16x16x32_bf16 v[216:219], v[88:91], a[100:103], v[216:219]
    s_add_u32 s47, s42, 28672
    v_accvgpr_read_b32 v112, a224
    v_accvgpr_read_b32 v113, a225
    v_mfma_f32_16x16x32_bf16 v[232:235], v[88:91], a[104:107], v[232:235]
    v_accvgpr_read_b32 v114, a226
    v_accvgpr_read_b32 v115, a227
    v_mfma_f32_16x16x32_bf16 v[248:251], v[88:91], a[108:111], v[248:251]
    buffer_load_dwordx4 v7, s[12:15], s46 offen offset:3072 lds
    v_mfma_f32_16x16x32_bf16 v[204:207], v[92:95], a[96:99], v[204:207]
    s_add_u32 m0, s40, 32768
    v_accvgpr_read_b32 v116, a228
    v_accvgpr_read_b32 v117, a229
    v_mfma_f32_16x16x32_bf16 v[220:223], v[92:95], a[100:103], v[220:223]
    s_add_u32 s46, s41, 3145728
    v_accvgpr_read_b32 v118, a230
    v_accvgpr_read_b32 v119, a231
    v_mfma_f32_16x16x32_bf16 v[236:239], v[92:95], a[104:107], v[236:239]
    s_and_b32 s46, s46, 0x3fffff
    buffer_load_dwordx4 v8, s[24:27], s46 offen offset:0 lds
    v_mfma_f32_16x16x32_bf16 v[252:255], v[92:95], a[108:111], v[252:255]
    s_waitcnt lgkmcnt(0)
    v_cvt_pk_bf16_f32 v112, v112, v113
    v_cvt_pk_bf16_f32 v113, v114, v115
    v_mfma_f32_16x16x32_bf16 v[128:131], v[64:67], a[112:115], v[128:131]
    ds_read_b64_tr_b16 v[80:81], v12 offset:61440
    ds_read_b64_tr_b16 v[82:83], v12 offset:61952
    v_mfma_f32_16x16x32_bf16 v[144:147], v[64:67], a[116:119], v[144:147]
    ds_read_b64_tr_b16 v[84:85], v13 offset:61440
    ds_read_b64_tr_b16 v[86:87], v13 offset:61952
    v_mfma_f32_16x16x32_bf16 v[160:163], v[64:67], a[120:123], v[160:163]
    ds_read_b64_tr_b16 v[88:89], v14 offset:61440
    ds_read_b64_tr_b16 v[90:91], v14 offset:61952
    v_mfma_f32_16x16x32_bf16 v[176:179], v[64:67], a[124:127], v[176:179]
    ds_read_b64_tr_b16 v[92:93], v15 offset:61440
    ds_read_b64_tr_b16 v[94:95], v15 offset:61952
    v_mfma_f32_16x16x32_bf16 v[132:135], v[68:71], a[112:115], v[132:135]
    buffer_load_dwordx4 v9, s[24:27], s46 offen offset:1024 lds
    v_mfma_f32_16x16x32_bf16 v[148:151], v[68:71], a[116:119], v[148:151]
    v_cvt_pk_bf16_f32 v114, v116, v117
    v_cvt_pk_bf16_f32 v115, v118, v119
    v_mfma_f32_16x16x32_bf16 v[164:167], v[68:71], a[120:123], v[164:167]
    v_cmp_eq_u32 vcc, s50, v18
    v_mfma_f32_16x16x32_bf16 v[180:183], v[68:71], a[124:127], v[180:183]
    s_nop 1
    buffer_load_dwordx4 v10, s[24:27], s46 offen offset:2048 lds
    v_mfma_f32_16x16x32_bf16 v[136:139], v[72:75], a[112:115], v[136:139]
    v_cndmask_b32 v20, v18, v19, vcc
    v_mfma_f32_16x16x32_bf16 v[152:155], v[72:75], a[116:119], v[152:155]
    s_nop 1
    v_max_u32_dpp v20, v20, v20 row_shr:1 row_mask:0xf bank_mask:0xf bound_ctrl:0
    v_mfma_f32_16x16x32_bf16 v[168:171], v[72:75], a[120:123], v[168:171]
    s_nop 1
    buffer_load_dwordx4 v11, s[24:27], s46 offen offset:3072 lds
    v_mfma_f32_16x16x32_bf16 v[184:187], v[72:75], a[124:127], v[184:187]
    v_max_u32_dpp v20, v20, v20 row_shr:2 row_mask:0xf bank_mask:0xf bound_ctrl:0
    v_mfma_f32_16x16x32_bf16 v[140:143], v[76:79], a[112:115], v[140:143]
    s_nop 1
    v_max_u32_dpp v20, v20, v20 row_shr:4 row_mask:0xf bank_mask:0xf bound_ctrl:0
    v_mfma_f32_16x16x32_bf16 v[156:159], v[76:79], a[116:119], v[156:159]
    s_nop 1
    buffer_store_dwordx4 v[112:115], v2, s[28:31], s47 offen offset:0 sc1
    v_mfma_f32_16x16x32_bf16 v[172:175], v[76:79], a[120:123], v[172:175]
    v_accvgpr_read_b32 v120, a232
    v_accvgpr_read_b32 v121, a233
    v_mfma_f32_16x16x32_bf16 v[188:191], v[76:79], a[124:127], v[188:191]
    s_waitcnt lgkmcnt(0)
    v_accvgpr_read_b32 v122, a234
    v_accvgpr_read_b32 v123, a235
    v_mfma_f32_16x16x32_bf16 v[192:195], v[80:83], a[112:115], v[192:195]
    s_waitcnt vmcnt(31)
    v_max_u32_dpp v20, v20, v20 row_shr:8 row_mask:0xf bank_mask:0xf bound_ctrl:0
    v_mfma_f32_16x16x32_bf16 v[208:211], v[80:83], a[116:119], v[208:211]
    s_barrier
    ds_read_b64_tr_b16 v[64:65], v12 offset:0
    ds_read_b64_tr_b16 v[66:67], v12 offset:512
    v_mfma_f32_16x16x32_bf16 v[224:227], v[80:83], a[120:123], v[224:227]
    s_add_u32 m0, s40, 49152
    ds_read_b64_tr_b16 v[68:69], v13 offset:0
    ds_read_b64_tr_b16 v[70:71], v13 offset:512
    v_mfma_f32_16x16x32_bf16 v[240:243], v[80:83], a[124:127], v[240:243]
    s_add_u32 s46, s41, 3145856
    ds_read_b64_tr_b16 v[72:73], v14 offset:0
    ds_read_b64_tr_b16 v[74:75], v14 offset:512
    v_mfma_f32_16x16x32_bf16 v[196:199], v[84:87], a[112:115], v[196:199]
    s_and_b32 s46, s46, 0x3fffff
    ds_read_b64_tr_b16 v[76:77], v15 offset:0
    ds_read_b64_tr_b16 v[78:79], v15 offset:512
    v_mfma_f32_16x16x32_bf16 v[212:215], v[84:87], a[116:119], v[212:215]
    s_nop 1
    buffer_load_dwordx4 v8, s[24:27], s46 offen offset:0 lds
    v_mfma_f32_16x16x32_bf16 v[228:231], v[84:87], a[120:123], v[228:231]
    v_accvgpr_read_b32 v124, a236
    v_accvgpr_read_b32 v125, a237
    v_mfma_f32_16x16x32_bf16 v[244:247], v[84:87], a[124:127], v[244:247]
    v_accvgpr_read_b32 v126, a238
    v_accvgpr_read_b32 v127, a239
    v_mfma_f32_16x16x32_bf16 v[200:203], v[88:91], a[112:115], v[200:203]
    buffer_load_dwordx4 v9, s[24:27], s46 offen offset:1024 lds
    v_mfma_f32_16x16x32_bf16 v[216:219], v[88:91], a[116:119], v[216:219]
    v_cvt_pk_bf16_f32 v120, v120, v121
    v_cvt_pk_bf16_f32 v121, v122, v123
    v_mfma_f32_16x16x32_bf16 v[232:235], v[88:91], a[120:123], v[232:235]
    v_cvt_pk_bf16_f32 v122, v124, v125
    v_cvt_pk_bf16_f32 v123, v126, v127
    v_mfma_f32_16x16x32_bf16 v[248:251], v[88:91], a[124:127], v[248:251]
    buffer_load_dwordx4 v10, s[24:27], s46 offen offset:2048 lds
    v_mfma_f32_16x16x32_bf16 v[204:207], v[92:95], a[112:115], v[204:207]
    v_max_u32_dpp v20, v20, v20 row_bcast:15 row_mask:0xa bank_mask:0xf
    v_mfma_f32_16x16x32_bf16 v[220:223], v[92:95], a[116:119], v[220:223]
    s_nop 1
    v_max_u32_dpp v20, v20, v20 row_bcast:31 row_mask:0xc bank_mask:0xf
    v_mfma_f32_16x16x32_bf16 v[236:239], v[92:95], a[120:123], v[236:239]
    s_nop 0
    buffer_load_dwordx4 v11, s[24:27], s46 offen offset:3072 lds
    v_mfma_f32_16x16x32_bf16 v[252:255], v[92:95], a[124:127], v[252:255]
    s_waitcnt lgkmcnt(0)
    v_readlane_b32 s51, v20, 63
    v_mfma_f32_16x16x32_bf16 v[128:131], v[64:67], a[0:3], v[128:131]
    s_nop 0
    ds_read_b64_tr_b16 v[80:81], v12 offset:4096
    ds_read_b64_tr_b16 v[82:83], v12 offset:4608
    v_mfma_f32_16x16x32_bf16 v[144:147], v[64:67], a[4:7], v[144:147]
    ds_read_b64_tr_b16 v[84:85], v13 offset:4096
    ds_read_b64_tr_b16 v[86:87], v13 offset:4608
    v_mfma_f32_16x16x32_bf16 v[160:163], v[64:67], a[8:11], v[160:163]
    ds_read_b64_tr_b16 v[88:89], v14 offset:4096
    ds_read_b64_tr_b16 v[90:91], v14 offset:4608
    v_mfma_f32_16x16x32_bf16 v[176:179], v[64:67], a[12:15], v[176:179]
    ds_read_b64_tr_b16 v[92:93], v15 offset:4096
    ds_read_b64_tr_b16 v[94:95], v15 offset:4608
    v_mfma_f32_16x16x32_bf16 v[132:135], v[68:71], a[0:3], v[132:135]
    buffer_store_dwordx4 v[120:123], v2, s[28:31], s47 offen offset:1024 sc1
    v_mfma_f32_16x16x32_bf16 v[148:151], v[68:71], a[4:7], v[148:151]
    v_accvgpr_read_b32 v112, a240
    v_accvgpr_read_b32 v113, a241
    v_mfma_f32_16x16x32_bf16 v[164:167], v[68:71], a[8:11], v[164:167]
    v_accvgpr_read_b32 v114, a242
    v_accvgpr_read_b32 v115, a243
    v_mfma_f32_16x16x32_bf16 v[180:183], v[68:71], a[12:15], v[180:183]
    v_accvgpr_read_b32 v116, a244
    v_accvgpr_read_b32 v117, a245
    v_mfma_f32_16x16x32_bf16 v[136:139], v[72:75], a[0:3], v[136:139]
    v_accvgpr_read_b32 v118, a246
    v_accvgpr_read_b32 v119, a247
    v_mfma_f32_16x16x32_bf16 v[152:155], v[72:75], a[4:7], v[152:155]
    v_cvt_pk_bf16_f32 v112, v112, v113
    v_cvt_pk_bf16_f32 v113, v114, v115
    v_mfma_f32_16x16x32_bf16 v[168:171], v[72:75], a[8:11], v[168:171]
    v_cvt_pk_bf16_f32 v114, v116, v117
    v_cvt_pk_bf16_f32 v115, v118, v119
    v_mfma_f32_16x16x32_bf16 v[184:187], v[72:75], a[12:15], v[184:187]
    v_mfma_f32_16x16x32_bf16 v[140:143], v[76:79], a[0:3], v[140:143]
    v_mfma_f32_16x16x32_bf16 v[156:159], v[76:79], a[4:7], v[156:159]
    v_mfma_f32_16x16x32_bf16 v[172:175], v[76:79], a[8:11], v[172:175]
    v_mfma_f32_16x16x32_bf16 v[188:191], v[76:79], a[12:15], v[188:191]
    s_waitcnt lgkmcnt(0)
    v_mfma_f32_16x16x32_bf16 v[192:195], v[80:83], a[0:3], v[192:195]
    s_andn2_b32 s49, 0x7ff, s50
    ds_read_b64_tr_b16 v[64:65], v12 offset:8192
    ds_read_b64_tr_b16 v[66:67], v12 offset:8704
    v_mfma_f32_16x16x32_bf16 v[208:211], v[80:83], a[4:7], v[208:211]
    s_lshl_b32 s49, s49, 10
    ds_read_b64_tr_b16 v[68:69], v13 offset:8192
    ds_read_b64_tr_b16 v[70:71], v13 offset:8704
    v_mfma_f32_16x16x32_bf16 v[224:227], v[80:83], a[8:11], v[224:227]
    s_add_u32 m0, s36, 20480
    ds_read_b64_tr_b16 v[72:73], v14 offset:8192
    ds_read_b64_tr_b16 v[74:75], v14 offset:8704
    v_mfma_f32_16x16x32_bf16 v[240:243], v[80:83], a[12:15], v[240:243]
    ds_read_b64_tr_b16 v[76:77], v15 offset:8192
    ds_read_b64_tr_b16 v[78:79], v15 offset:8704
    v_mfma_f32_16x16x32_bf16 v[196:199], v[84:87], a[0:3], v[196:199]
    buffer_load_dwordx4 v2, s[12:15], s49 offen lds
    v_mfma_f32_16x16x32_bf16 v[212:215], v[84:87], a[4:7], v[212:215]
    s_andn2_b32 s49, 0x7ff, s51
    v_mfma_f32_16x16x32_bf16 v[228:231], v[84:87], a[8:11], v[228:231]
    s_lshl_b32 s49, s49, 10
    v_mfma_f32_16x16x32_bf16 v[244:247], v[84:87], a[12:15], v[244:247]
    s_add_u32 m0, s36, 21504
    v_mfma_f32_16x16x32_bf16 v[200:203], v[88:91], a[0:3], v[200:203]
    buffer_store_dwordx4 v[112:115], v2, s[28:31], s47 offen offset:2048 sc1
    v_mfma_f32_16x16x32_bf16 v[216:219], v[88:91], a[4:7], v[216:219]
    v_accvgpr_read_b32 v120, a248
    v_accvgpr_read_b32 v121, a249
    v_mfma_f32_16x16x32_bf16 v[232:235], v[88:91], a[8:11], v[232:235]
    v_accvgpr_read_b32 v122, a250
    v_accvgpr_read_b32 v123, a251
    v_mfma_f32_16x16x32_bf16 v[248:251], v[88:91], a[12:15], v[248:251]
    buffer_load_dwordx4 v2, s[12:15], s49 offen lds
    v_mfma_f32_16x16x32_bf16 v[204:207], v[92:95], a[0:3], v[204:207]
    v_accvgpr_read_b32 v124, a252
    v_accvgpr_read_b32 v125, a253
    v_mfma_f32_16x16x32_bf16 v[220:223], v[92:95], a[4:7], v[220:223]
    v_accvgpr_read_b32 v126, a254
    v_accvgpr_read_b32 v127, a255
    v_mfma_f32_16x16x32_bf16 v[236:239], v[92:95], a[8:11], v[236:239]
    v_cvt_pk_bf16_f32 v120, v120, v121
    v_cvt_pk_bf16_f32 v121, v122, v123
    v_mfma_f32_16x16x32_bf16 v[252:255], v[92:95], a[12:15], v[252:255]
    s_waitcnt lgkmcnt(0)
    v_cvt_pk_bf16_f32 v122, v124, v125
    v_cvt_pk_bf16_f32 v123, v126, v127
    v_mfma_f32_16x16x32_bf16 v[128:131], v[64:67], a[16:19], v[128:131]
    ds_read_b64_tr_b16 v[80:81], v12 offset:12288
    ds_read_b64_tr_b16 v[82:83], v12 offset:12800
    v_mfma_f32_16x16x32_bf16 v[144:147], v[64:67], a[20:23], v[144:147]
    ds_read_b64_tr_b16 v[84:85], v13 offset:12288
    ds_read_b64_tr_b16 v[86:87], v13 offset:12800
    v_mfma_f32_16x16x32_bf16 v[160:163], v[64:67], a[24:27], v[160:163]
    ds_read_b64_tr_b16 v[88:89], v14 offset:12288
    ds_read_b64_tr_b16 v[90:91], v14 offset:12800
    v_mfma_f32_16x16x32_bf16 v[176:179], v[64:67], a[28:31], v[176:179]
    ds_read_b64_tr_b16 v[92:93], v15 offset:12288
    ds_read_b64_tr_b16 v[94:95], v15 offset:12800
    v_mfma_f32_16x16x32_bf16 v[132:135], v[68:71], a[16:19], v[132:135]
    buffer_load_dwordx4 v[96:99], v21, s[80:83], s78 offen
    v_mfma_f32_16x16x32_bf16 v[148:151], v[68:71], a[20:23], v[148:151]
    v_mfma_f32_16x16x32_bf16 v[164:167], v[68:71], a[24:27], v[164:167]
    v_mfma_f32_16x16x32_bf16 v[180:183], v[68:71], a[28:31], v[180:183]
    v_mfma_f32_16x16x32_bf16 v[136:139], v[72:75], a[16:19], v[136:139]
    v_mfma_f32_16x16x32_bf16 v[152:155], v[72:75], a[20:23], v[152:155]
    v_mfma_f32_16x16x32_bf16 v[168:171], v[72:75], a[24:27], v[168:171]
    v_mfma_f32_16x16x32_bf16 v[184:187], v[72:75], a[28:31], v[184:187]
    v_mfma_f32_16x16x32_bf16 v[140:143], v[76:79], a[16:19], v[140:143]
    buffer_store_dwordx4 v[120:123], v2, s[28:31], s47 offen offset:3072 sc1
    v_mfma_f32_16x16x32_bf16 v[156:159], v[76:79], a[20:23], v[156:159]
    v_mfma_f32_16x16x32_bf16 v[172:175], v[76:79], a[24:27], v[172:175]
    v_mfma_f32_16x16x32_bf16 v[188:191], v[76:79], a[28:31], v[188:191]
    s_waitcnt lgkmcnt(0)
    v_mfma_f32_16x16x32_bf16 v[192:195], v[80:83], a[16:19], v[192:195]
    s_waitcnt vmcnt(26)
    v_mov_b32 v6, 0xff800000
    v_xor_b32 v7, 0x10000, v2
    v_mfma_f32_16x16x32_bf16 v[208:211], v[80:83], a[20:23], v[208:211]
    s_barrier
    ds_read_b64_tr_b16 v[64:65], v12 offset:16384
    ds_read_b64_tr_b16 v[66:67], v12 offset:16896
    v_mfma_f32_16x16x32_bf16 v[224:227], v[80:83], a[24:27], v[224:227]
    ds_read_b64_tr_b16 v[68:69], v13 offset:16384
    ds_read_b64_tr_b16 v[70:71], v13 offset:16896
    v_mfma_f32_16x16x32_bf16 v[240:243], v[80:83], a[28:31], v[240:243]
    ds_read_b64_tr_b16 v[72:73], v14 offset:16384
    ds_read_b64_tr_b16 v[74:75], v14 offset:16896
    v_mfma_f32_16x16x32_bf16 v[196:199], v[84:87], a[16:19], v[196:199]
    ds_read_b64_tr_b16 v[76:77], v15 offset:16384
    ds_read_b64_tr_b16 v[78:79], v15 offset:16896
    v_mfma_f32_16x16x32_bf16 v[212:215], v[84:87], a[20:23], v[212:215]
    buffer_load_dwordx4 v[100:103], v21, s[80:83], s79 offen
    v_mfma_f32_16x16x32_bf16 v[228:231], v[84:87], a[24:27], v[228:231]
    v_mov_b32 v8, 0xff800000
    v_mov_b32 v9, 0xff800000
    v_mfma_f32_16x16x32_bf16 v[244:247], v[84:87], a[28:31], v[244:247]
    v_mov_b32 v10, 0xff800000
    v_mov_b32 v11, 0xff800000
    v_mfma_f32_16x16x32_bf16 v[200:203], v[88:91], a[16:19], v[200:203]
    v_mov_b32 v124, 0x3f803f80
    v_accvgpr_write_b32 a144, v124
    v_mfma_f32_16x16x32_bf16 v[216:219], v[88:91], a[20:23], v[216:219]
    v_accvgpr_write_b32 a148, 0
    v_accvgpr_write_b32 a145, v124
    v_mfma_f32_16x16x32_bf16 v[232:235], v[88:91], a[24:27], v[232:235]
    v_accvgpr_write_b32 a149, 0
    v_accvgpr_write_b32 a146, v124
    v_mfma_f32_16x16x32_bf16 v[248:251], v[88:91], a[28:31], v[248:251]
    v_accvgpr_write_b32 a150, 0
    v_accvgpr_write_b32 a147, v124
    v_mfma_f32_16x16x32_bf16 v[204:207], v[92:95], a[16:19], v[204:207]
    v_accvgpr_write_b32 a151, 0
    v_lshrrev_b32 v124, 5, v1
    v_mfma_f32_16x16x32_bf16 v[220:223], v[92:95], a[20:23], v[220:223]
    v_lshlrev_b32 v124, 14, v124
    v_bfe_u32 v125, v1, 3, 2
    v_mfma_f32_16x16x32_bf16 v[236:239], v[92:95], a[24:27], v[236:239]
    v_lshl_add_u32 v124, v125, 10, v124
    v_and_b32 v125, 1, v1
    v_mfma_f32_16x16x32_bf16 v[252:255], v[92:95], a[28:31], v[252:255]
    s_waitcnt lgkmcnt(0)
    v_lshl_add_u32 v124, v125, 6, v124
    v_bfe_u32 v125, v1, 1, 2
    v_mfma_f32_16x16x32_bf16 v[128:131], v[64:67], a[32:35], v[128:131]
    s_waitcnt vmcnt(31)
    ds_read_b64_tr_b16 v[80:81], v12 offset:20480
    ds_read_b64_tr_b16 v[82:83], v12 offset:20992
    v_mfma_f32_16x16x32_bf16 v[144:147], v[64:67], a[36:39], v[144:147]
    ds_read_b64_tr_b16 v[84:85], v13 offset:20480
    ds_read_b64_tr_b16 v[86:87], v13 offset:20992
    v_mfma_f32_16x16x32_bf16 v[160:163], v[64:67], a[40:43], v[160:163]
    ds_read_b64_tr_b16 v[88:89], v14 offset:20480
    ds_read_b64_tr_b16 v[90:91], v14 offset:20992
    v_mfma_f32_16x16x32_bf16 v[176:179], v[64:67], a[44:47], v[176:179]
    ds_read_b64_tr_b16 v[92:93], v15 offset:20480
    ds_read_b64_tr_b16 v[94:95], v15 offset:20992
    v_mfma_f32_16x16x32_bf16 v[132:135], v[68:71], a[32:35], v[132:135]
    ds_read_b128 a[64:67], v16 offset:0
    ds_read_b128 a[68:71], v16 offset:2048
    v_mfma_f32_16x16x32_bf16 v[148:151], v[68:71], a[36:39], v[148:151]
    ds_read_b128 a[72:75], v16 offset:4096
    ds_read_b128 a[76:79], v16 offset:6144
    v_mfma_f32_16x16x32_bf16 v[164:167], v[68:71], a[40:43], v[164:167]
    ds_read_b128 a[80:83], v17 offset:0
    ds_read_b128 a[84:87], v17 offset:2048
    v_mfma_f32_16x16x32_bf16 v[180:183], v[68:71], a[44:47], v[180:183]
    ds_read_b128 a[88:91], v17 offset:4096
    ds_read_b128 a[92:95], v17 offset:6144
    v_mfma_f32_16x16x32_bf16 v[136:139], v[72:75], a[32:35], v[136:139]
    buffer_load_dwordx4 v[104:107], v21, s[72:75], s78 offen
    v_mfma_f32_16x16x32_bf16 v[152:155], v[72:75], a[36:39], v[152:155]
    v_bfe_u32 v126, v1, 4, 1
    v_xor_b32 v125, v125, v126
    v_mfma_f32_16x16x32_bf16 v[168:171], v[72:75], a[40:43], v[168:171]
    v_lshl_add_u32 v124, v125, 4, v124
    v_xor_b32 v125, 32, v124
    v_mfma_f32_16x16x32_bf16 v[184:187], v[72:75], a[44:47], v[184:187]
    v_add_u32 v125, 3072, v125
    v_accvgpr_write_b32 a152, v124
    v_mfma_f32_16x16x32_bf16 v[140:143], v[76:79], a[32:35], v[140:143]
    v_accvgpr_write_b32 a153, v125
    v_mfma_f32_16x16x32_bf16 v[156:159], v[76:79], a[36:39], v[156:159]
    v_mfma_f32_16x16x32_bf16 v[172:175], v[76:79], a[40:43], v[172:175]
    v_mfma_f32_16x16x32_bf16 v[188:191], v[76:79], a[44:47], v[188:191]
    s_waitcnt lgkmcnt(0)
    v_mfma_f32_16x16x32_bf16 v[192:195], v[80:83], a[32:35], v[192:195]
    ds_read_b64_tr_b16 v[64:65], v12 offset:24576
    ds_read_b64_tr_b16 v[66:67], v12 offset:25088
    v_mfma_f32_16x16x32_bf16 v[208:211], v[80:83], a[36:39], v[208:211]
    ds_read_b64_tr_b16 v[68:69], v13 offset:24576
    ds_read_b64_tr_b16 v[70:71], v13 offset:25088
    v_mfma_f32_16x16x32_bf16 v[224:227], v[80:83], a[40:43], v[224:227]
    ds_read_b64_tr_b16 v[72:73], v14 offset:24576
    ds_read_b64_tr_b16 v[74:75], v14 offset:25088
    v_mfma_f32_16x16x32_bf16 v[240:243], v[80:83], a[44:47], v[240:243]
    ds_read_b64_tr_b16 v[76:77], v15 offset:24576
    ds_read_b64_tr_b16 v[78:79], v15 offset:25088
    v_mfma_f32_16x16x32_bf16 v[196:199], v[84:87], a[32:35], v[196:199]
    v_mfma_f32_16x16x32_bf16 v[212:215], v[84:87], a[36:39], v[212:215]
    v_mfma_f32_16x16x32_bf16 v[228:231], v[84:87], a[40:43], v[228:231]
    buffer_load_dwordx4 v[108:111], v21, s[72:75], s79 offen
    v_mfma_f32_16x16x32_bf16 v[244:247], v[84:87], a[44:47], v[244:247]
    v_mfma_f32_16x16x32_bf16 v[200:203], v[88:91], a[32:35], v[200:203]
    v_mfma_f32_16x16x32_bf16 v[216:219], v[88:91], a[36:39], v[216:219]
    v_mfma_f32_16x16x32_bf16 v[232:235], v[88:91], a[40:43], v[232:235]
    v_mfma_f32_16x16x32_bf16 v[248:251], v[88:91], a[44:47], v[248:251]
    v_mfma_f32_16x16x32_bf16 v[204:207], v[92:95], a[32:35], v[204:207]
    v_mfma_f32_16x16x32_bf16 v[220:223], v[92:95], a[36:39], v[220:223]
    v_mfma_f32_16x16x32_bf16 v[236:239], v[92:95], a[40:43], v[236:239]
    v_mfma_f32_16x16x32_bf16 v[252:255], v[92:95], a[44:47], v[252:255]
    s_waitcnt lgkmcnt(0)
    v_mfma_f32_16x16x32_bf16 v[128:131], v[64:67], a[48:51], v[128:131]
    s_waitcnt vmcnt(18)
    ds_read_b64_tr_b16 v[80:81], v12 offset:28672
    ds_read_b64_tr_b16 v[82:83], v12 offset:29184
    v_mfma_f32_16x16x32_bf16 v[144:147], v[64:67], a[52:55], v[144:147]
    s_lshl_b32 s55, s3, 13
    ds_read_b64_tr_b16 v[84:85], v13 offset:28672
    ds_read_b64_tr_b16 v[86:87], v13 offset:29184
    v_mfma_f32_16x16x32_bf16 v[160:163], v[64:67], a[56:59], v[160:163]
    s_lshr_b32 s82, s3, 1
    ds_read_b64_tr_b16 v[88:89], v14 offset:28672
    ds_read_b64_tr_b16 v[90:91], v14 offset:29184
    v_mfma_f32_16x16x32_bf16 v[176:179], v[64:67], a[60:63], v[176:179]
    ds_read_b64_tr_b16 v[92:93], v15 offset:28672
    ds_read_b64_tr_b16 v[94:95], v15 offset:29184
    v_mfma_f32_16x16x32_bf16 v[132:135], v[68:71], a[48:51], v[132:135]
    ds_read_b128 a[96:99], v16 offset:8192
    ds_read_b128 a[100:103], v16 offset:10240
    v_mfma_f32_16x16x32_bf16 v[148:151], v[68:71], a[52:55], v[148:151]
    ds_read_b128 a[104:107], v16 offset:12288
    ds_read_b128 a[108:111], v16 offset:14336
    v_mfma_f32_16x16x32_bf16 v[164:167], v[68:71], a[56:59], v[164:167]
    ds_read_b128 a[112:115], v17 offset:8192
    ds_read_b128 a[116:119], v17 offset:10240
    v_mfma_f32_16x16x32_bf16 v[180:183], v[68:71], a[60:63], v[180:183]
    ds_read_b128 a[120:123], v17 offset:12288
    ds_read_b128 a[124:127], v17 offset:14336
    v_mfma_f32_16x16x32_bf16 v[136:139], v[72:75], a[48:51], v[136:139]
    v_subrev_u32 v124, s82, v1
    v_mfma_f32_16x16x32_bf16 v[152:155], v[72:75], a[52:55], v[152:155]
    s_lshl_b32 s83, s5, 2
    v_mfma_f32_16x16x32_bf16 v[168:171], v[72:75], a[56:59], v[168:171]
    s_add_u32 s83, s83, 4
    v_lshlrev_b32 v125, 1, v124
    v_subrev_u32 v125, s83, v125
    v_mfma_f32_16x16x32_bf16 v[184:187], v[72:75], a[60:63], v[184:187]
    v_max_i32 v125, v125, v124
    v_add_u32 v126, 1, v125
    v_mfma_f32_16x16x32_bf16 v[140:143], v[76:79], a[48:51], v[140:143]
    v_sub_u32 v127, 64, v124
    v_cmp_gt_i32 vcc, s83, v124
    v_mfma_f32_16x16x32_bf16 v[156:159], v[76:79], a[52:55], v[156:159]
    s_and_b32 s81, s3, 1
    v_mfma_f32_16x16x32_bf16 v[172:175], v[76:79], a[56:59], v[172:175]
    s_nop 0
    v_cndmask_b32 v126, v126, v127, vcc
    v_mfma_f32_16x16x32_bf16 v[188:191], v[76:79], a[60:63], v[188:191]
    s_waitcnt lgkmcnt(0)
    s_cmp_eq_u32 s81, 1
    s_cselect_b64 vcc, -1, 0
    v_mfma_f32_16x16x32_bf16 v[192:195], v[80:83], a[48:51], v[192:195]
    s_waitcnt vmcnt(3)
    v_mfma_f32_16x16x32_bf16 v[208:211], v[80:83], a[52:55], v[208:211]
    s_barrier
    ds_read_b64_tr_b16 v[64:65], v12 offset:32768
    ds_read_b64_tr_b16 v[66:67], v12 offset:33280
    v_mfma_f32_16x16x32_bf16 v[224:227], v[80:83], a[56:59], v[224:227]
    s_cmp_lg_u32 s3, 0
    s_cbranch_scc1 kvf_skip
    v_mov_b32 v18, 1
    s_mov_b64 exec, 1
    buffer_store_dword v18, off, s[28:31], s70 sc1
    s_mov_b64 exec, -1
    kvf_skip:
    v_mfma_f32_16x16x32_bf16 v[240:243], v[80:83], a[60:63], v[240:243]
    s_sub_u32 s83, s83, 3
    ds_read_b64_tr_b16 v[68:69], v13 offset:32768
    ds_read_b64_tr_b16 v[70:71], v13 offset:33280
    v_mfma_f32_16x16x32_bf16 v[196:199], v[84:87], a[48:51], v[196:199]
    ds_read_b64_tr_b16 v[72:73], v14 offset:32768
    ds_read_b64_tr_b16 v[74:75], v14 offset:33280
    v_mfma_f32_16x16x32_bf16 v[212:215], v[84:87], a[52:55], v[212:215]
    ds_read_b64_tr_b16 v[76:77], v15 offset:32768
    ds_read_b64_tr_b16 v[78:79], v15 offset:33280
    v_mfma_f32_16x16x32_bf16 v[228:231], v[84:87], a[56:59], v[228:231]
    v_cndmask_b32 v125, v125, v126, vcc
    v_mfma_f32_16x16x32_bf16 v[244:247], v[84:87], a[60:63], v[244:247]
    s_cmp_eq_u32 s81, 1
    s_cselect_b32 s83, s83, 0
    v_mfma_f32_16x16x32_bf16 v[200:203], v[88:91], a[48:51], v[200:203]
    s_sub_u32 s81, 32, s81
    v_mfma_f32_16x16x32_bf16 v[216:219], v[88:91], a[52:55], v[216:219]
    s_lshl_b32 s82, s82, 13
    v_mfma_f32_16x16x32_bf16 v[232:235], v[88:91], a[56:59], v[232:235]
    s_lshl_b32 s53, s4, 20
    v_mfma_f32_16x16x32_bf16 v[248:251], v[88:91], a[60:63], v[248:251]
    s_add_u32 s82, s82, s53
    v_lshlrev_b32 v125, 14, v125
    v_add_u32 v125, s82, v125
    v_mfma_f32_16x16x32_bf16 v[204:207], v[92:95], a[48:51], v[204:207]
    v_mov_b32 v126, 0x40000000
    v_cmp_gt_i32 vcc, s83, v124
    v_mfma_f32_16x16x32_bf16 v[220:223], v[92:95], a[52:55], v[220:223]
    s_nop 1
    v_cndmask_b32 v125, v125, v126, vcc
    v_cmp_lt_i32 vcc, s81, v124
    v_mfma_f32_16x16x32_bf16 v[236:239], v[92:95], a[56:59], v[236:239]
    s_nop 1
    v_cndmask_b32 v5, v125, v126, vcc
    v_bfe_u32 v20, v1, 3, 2
    v_mfma_f32_16x16x32_bf16 v[252:255], v[92:95], a[60:63], v[252:255]
    s_waitcnt lgkmcnt(0)
    v_lshlrev_b32 v20, 17, v20
    v_bfe_u32 v19, v1, 1, 2
    v_mfma_f32_16x16x32_bf16 v[128:131], v[64:67], a[64:67], v[128:131]
    ds_read_b64_tr_b16 v[80:81], v12 offset:36864
    ds_read_b64_tr_b16 v[82:83], v12 offset:37376
    v_mfma_f32_16x16x32_bf16 v[144:147], v[64:67], a[68:71], v[144:147]
    ds_read_b64_tr_b16 v[84:85], v13 offset:36864
    ds_read_b64_tr_b16 v[86:87], v13 offset:37376
    v_mfma_f32_16x16x32_bf16 v[160:163], v[64:67], a[72:75], v[160:163]
    ds_read_b64_tr_b16 v[88:89], v14 offset:36864
    ds_read_b64_tr_b16 v[90:91], v14 offset:37376
    v_mfma_f32_16x16x32_bf16 v[176:179], v[64:67], a[76:79], v[176:179]
    ds_read_b64_tr_b16 v[92:93], v15 offset:36864
    ds_read_b64_tr_b16 v[94:95], v15 offset:37376
    v_mfma_f32_16x16x32_bf16 v[132:135], v[68:71], a[64:67], v[132:135]
    v_lshl_add_u32 v20, v19, 10, v20
    v_and_b32 v19, 1, v1
    v_mfma_f32_16x16x32_bf16 v[148:151], v[68:71], a[68:71], v[148:151]
    v_lshl_add_u32 v20, v19, 7, v20
    v_mfma_f32_16x16x32_bf16 v[164:167], v[68:71], a[72:75], v[164:167]
    s_lshr_b32 s76, s4, 2
    v_mfma_f32_16x16x32_bf16 v[180:183], v[68:71], a[76:79], v[180:183]
    s_lshl_b32 s76, s76, 19
    v_mfma_f32_16x16x32_bf16 v[136:139], v[72:75], a[64:67], v[136:139]
    s_lshl_b32 s77, s6, 12
    v_mfma_f32_16x16x32_bf16 v[152:155], v[72:75], a[68:71], v[152:155]
    s_add_u32 s76, s76, s77
    v_mfma_f32_16x16x32_bf16 v[168:171], v[72:75], a[72:75], v[168:171]
    s_and_b32 s77, s4, 3
    v_mfma_f32_16x16x32_bf16 v[184:187], v[72:75], a[76:79], v[184:187]
    s_lshl_b32 s77, s77, 8
    v_mfma_f32_16x16x32_bf16 v[140:143], v[76:79], a[64:67], v[140:143]
    s_add_u32 s76, s76, s77
    buffer_load_dword v31, v20, s[8:11], s76 offen
    v_mfma_f32_16x16x32_bf16 v[156:159], v[76:79], a[68:71], v[156:159]
    s_add_u32 s48, s36, 16384
    v_add_u32 v121, s48, v2
    v_mfma_f32_16x16x32_bf16 v[172:175], v[76:79], a[72:75], v[172:175]
    s_waitcnt vmcnt(1)
    ds_write_b128 v121, v[96:99] offset:0
    ds_write_b128 v121, v[100:103] offset:1024
    v_mfma_f32_16x16x32_bf16 v[188:191], v[76:79], a[76:79], v[188:191]
    s_waitcnt lgkmcnt(0)
    ds_write_b128 v121, v[104:107] offset:2048
    ds_write_b128 v121, v[108:111] offset:3072
    v_mfma_f32_16x16x32_bf16 v[128:131], v[80:83], a[80:83], v[128:131]
    s_mov_b64 s[72:73], 0
    ds_read_b64_tr_b16 v[64:65], v12 offset:40960
    ds_read_b64_tr_b16 v[66:67], v12 offset:41472
    v_mfma_f32_16x16x32_bf16 v[144:147], v[80:83], a[84:87], v[144:147]
    s_mov_b32 s78, 0
    ds_read_b64_tr_b16 v[68:69], v13 offset:40960
    ds_read_b64_tr_b16 v[70:71], v13 offset:41472
    v_mfma_f32_16x16x32_bf16 v[160:163], v[80:83], a[88:91], v[160:163]
    s_mov_b32 s52, -1
    ds_read_b64_tr_b16 v[72:73], v14 offset:40960
    ds_read_b64_tr_b16 v[74:75], v14 offset:41472
    v_mfma_f32_16x16x32_bf16 v[176:179], v[80:83], a[92:95], v[176:179]
    s_mov_b32 s54, 0x8000
    ds_read_b64_tr_b16 v[76:77], v15 offset:40960
    ds_read_b64_tr_b16 v[78:79], v15 offset:41472
    v_mfma_f32_16x16x32_bf16 v[132:135], v[84:87], a[80:83], v[132:135]
    s_movk_i32 s76, 0x1000
    v_lshrrev_b32 v116, 4, v1
    v_bfe_u32 v117, v1, 2, 2
    v_mfma_f32_16x16x32_bf16 v[148:151], v[84:87], a[84:87], v[148:151]
    s_mov_b32 s77, 0
    v_lshl_add_u32 v117, v116, 3, v117
    v_lshlrev_b32 v117, 4, v117
    v_mfma_f32_16x16x32_bf16 v[164:167], v[84:87], a[88:91], v[164:167]
    s_mov_b32 s45, 0x4e800000
    v_and_b32 v118, 1, v1
    v_lshl_add_u32 v117, v118, 3, v117
    v_mfma_f32_16x16x32_bf16 v[180:183], v[84:87], a[92:95], v[180:183]
    s_lshl_b32 s82, s6, 5
    v_bfe_u32 v119, v1, 1, 1
    v_lshl_add_u32 v117, v119, 11, v117
    v_mfma_f32_16x16x32_bf16 v[136:139], v[88:91], a[80:83], v[136:139]
    s_add_u32 s83, s82, s4
    v_add_u32 v117, s48, v117
    v_lshlrev_b32 v119, 4, v116
    v_mfma_f32_16x16x32_bf16 v[152:155], v[88:91], a[84:87], v[152:155]
    s_lshl_b32 s27, s82, 2
    v_lshl_add_u32 v119, v118, 10, v119
    v_mfma_f32_16x16x32_bf16 v[168:171], v[88:91], a[88:91], v[168:171]
    s_lshl_b32 s49, s3, 8
    v_mfma_f32_16x16x32_bf16 v[184:187], v[88:91], a[92:95], v[184:187]
    s_add_u32 s48, s48, s49
    v_add_u32 v119, s48, v119
    v_lshlrev_b32 v120, 5, v116
    v_mfma_f32_16x16x32_bf16 v[140:143], v[92:95], a[80:83], v[140:143]
    s_add_u32 s27, s27, 0x3401000
    v_lshl_add_u32 v120, v118, 4, v120
    v_mfma_f32_16x16x32_bf16 v[156:159], v[92:95], a[84:87], v[156:159]
    s_lshr_b32 s49, s49, 1
    v_mfma_f32_16x16x32_bf16 v[172:175], v[92:95], a[88:91], v[172:175]
    s_add_u32 s49, s49, 0x21c00
    v_add_u32 v120, s49, v120
    v_and_b32 v20, 7, v1
    v_mfma_f32_16x16x32_bf16 v[188:191], v[92:95], a[92:95], v[188:191]
    s_waitcnt lgkmcnt(0)
    v_lshlrev_b32 v20, 2, v20
    v_mfma_f32_16x16x32_bf16 v[128:131], v[64:67], a[96:99], v[128:131]
    s_lshl_b32 s44, s4, 7
    ds_read_b64_tr_b16 v[80:81], v12 offset:45056
    ds_read_b64_tr_b16 v[82:83], v12 offset:45568
    v_mfma_f32_16x16x32_bf16 v[144:147], v[64:67], a[100:103], v[144:147]
    s_add_u32 s44, s44, 0x3400000
    ds_read_b64_tr_b16 v[84:85], v13 offset:45056
    ds_read_b64_tr_b16 v[86:87], v13 offset:45568
    v_mfma_f32_16x16x32_bf16 v[160:163], v[64:67], a[104:107], v[160:163]
    s_load_dwordx2 s[16:17], s[0:1], 96
    ds_read_b64_tr_b16 v[88:89], v14 offset:45056
    ds_read_b64_tr_b16 v[90:91], v14 offset:45568
    v_mfma_f32_16x16x32_bf16 v[176:179], v[64:67], a[108:111], v[176:179]
    s_mov_b32 s43, s68
    ds_read_b64_tr_b16 v[92:93], v15 offset:45056
    ds_read_b64_tr_b16 v[94:95], v15 offset:45568
    v_mfma_f32_16x16x32_bf16 v[132:135], v[68:71], a[96:99], v[132:135]
    s_lshl_b32 s26, s83, 2
    ds_read_b64_tr_b16 v[32:33], v117 offset:0
    ds_read_b64_tr_b16 v[34:35], v117 offset:64
    v_mfma_f32_16x16x32_bf16 v[148:151], v[68:71], a[100:103], v[148:151]
    s_add_u32 s26, s26, 0x3401000
    ds_read_b64_tr_b16 v[36:37], v117 offset:512
    ds_read_b64_tr_b16 v[38:39], v117 offset:576
    v_mfma_f32_16x16x32_bf16 v[164:167], v[68:71], a[104:107], v[164:167]
    s_lshl_b32 s83, s83, 16
    ds_read_b64_tr_b16 v[40:41], v117 offset:1024
    ds_read_b64_tr_b16 v[42:43], v117 offset:1088
    v_mfma_f32_16x16x32_bf16 v[180:183], v[68:71], a[108:111], v[180:183]
    s_add_u32 s79, s83, 0x6000000
    ds_read_b64_tr_b16 v[44:45], v117 offset:1536
    ds_read_b64_tr_b16 v[46:47], v117 offset:1600
    v_mfma_f32_16x16x32_bf16 v[136:139], v[72:75], a[96:99], v[136:139]
    s_waitcnt vmcnt(6)
    ds_read_b128 v[48:51], v119 offset:4096
    ds_read_b128 v[52:55], v119 offset:4160
    v_mfma_f32_16x16x32_bf16 v[152:155], v[72:75], a[100:103], v[152:155]
    s_add_u32 s80, s79, 0x2000
    ds_read_b128 v[56:59], v119 offset:4224
    ds_read_b128 v[60:63], v119 offset:4288
    v_mfma_f32_16x16x32_bf16 v[168:171], v[72:75], a[104:107], v[168:171]
    s_xor_b32 s20, s79, 0x10000
    v_mfma_f32_16x16x32_bf16 v[184:187], v[72:75], a[108:111], v[184:187]
    s_xor_b32 s23, s80, 0x10000
    v_mfma_f32_16x16x32_bf16 v[140:143], v[76:79], a[96:99], v[140:143]
    s_xor_b32 s21, s79, 0x20000
    v_mfma_f32_16x16x32_bf16 v[156:159], v[76:79], a[100:103], v[156:159]
    s_xor_b32 s24, s80, 0x20000
    v_mfma_f32_16x16x32_bf16 v[172:175], v[76:79], a[104:107], v[172:175]
    s_xor_b32 s22, s79, 0x30000
    v_mfma_f32_16x16x32_bf16 v[188:191], v[76:79], a[108:111], v[188:191]
    s_waitcnt lgkmcnt(0)
    v_mfma_f32_16x16x32_bf16 v[128:131], v[80:83], a[112:115], v[128:131]
    s_waitcnt vmcnt(10)
    v_mfma_f32_16x16x32_bf16 v[144:147], v[80:83], a[116:119], v[144:147]
    s_barrier
    ds_read_b64_tr_b16 v[64:65], v12 offset:49152
    ds_read_b64_tr_b16 v[66:67], v12 offset:49664
    v_mfma_f32_16x16x32_bf16 v[160:163], v[80:83], a[120:123], v[160:163]
    s_xor_b32 s25, s80, 0x30000
    ds_read_b64_tr_b16 v[68:69], v13 offset:49152
    ds_read_b64_tr_b16 v[70:71], v13 offset:49664
    v_mfma_f32_16x16x32_bf16 v[176:179], v[80:83], a[124:127], v[176:179]
    s_andn2_b32 s82, s4, 3
    ds_read_b64_tr_b16 v[72:73], v14 offset:49152
    ds_read_b64_tr_b16 v[74:75], v14 offset:49664
    v_mfma_f32_16x16x32_bf16 v[132:135], v[84:87], a[112:115], v[132:135]
    s_lshl_b32 s35, 15, s82
    ds_read_b64_tr_b16 v[76:77], v15 offset:49152
    ds_read_b64_tr_b16 v[78:79], v15 offset:49664
    v_mfma_f32_16x16x32_bf16 v[148:151], v[84:87], a[116:119], v[148:151]
    s_lshl_b32 s82, s4, 17
    v_mfma_f32_16x16x32_bf16 v[164:167], v[84:87], a[120:123], v[164:167]
    s_lshl_b32 s83, s3, 15
    v_mfma_f32_16x16x32_bf16 v[180:183], v[84:87], a[124:127], v[180:183]
    s_add_u32 s82, s82, s83
    v_mfma_f32_16x16x32_bf16 v[136:139], v[88:91], a[112:115], v[136:139]
    s_and_b32 s83, s4, 3
    v_mfma_f32_16x16x32_bf16 v[152:155], v[88:91], a[116:119], v[152:155]
    s_lshl_b32 s83, s83, 8
    v_mfma_f32_16x16x32_bf16 v[168:171], v[88:91], a[120:123], v[168:171]
    s_add_u32 s41, s82, s83
    v_mfma_f32_16x16x32_bf16 v[184:187], v[88:91], a[124:127], v[184:187]
    s_add_u32 s32, s79, 0x4000
    v_mfma_f32_16x16x32_bf16 v[140:143], v[92:95], a[112:115], v[140:143]
    s_andn2_b32 s33, s32, 0x1c0000
    v_mfma_f32_16x16x32_bf16 v[156:159], v[92:95], a[116:119], v[156:159]
    s_and_b32 s82, s2, 7
    v_mfma_f32_16x16x32_bf16 v[172:175], v[92:95], a[120:123], v[172:175]
    s_lshl_b32 s83, s82, 11
    v_mfma_f32_16x16x32_bf16 v[188:191], v[92:95], a[124:127], v[188:191]
    s_waitcnt lgkmcnt(0)
    v_mfma_f32_16x16x32_bf16 v[192:195], v[64:67], a[64:67], v[192:195]
    s_add_u32 s33, s33, s83
    ds_read_b64_tr_b16 v[80:81], v12 offset:53248
    ds_read_b64_tr_b16 v[82:83], v12 offset:53760
    v_mfma_f32_16x16x32_bf16 v[208:211], v[64:67], a[68:71], v[208:211]
    ds_read_b64_tr_b16 v[84:85], v13 offset:53248
    ds_read_b64_tr_b16 v[86:87], v13 offset:53760
    v_mfma_f32_16x16x32_bf16 v[224:227], v[64:67], a[72:75], v[224:227]
    ds_read_b64_tr_b16 v[88:89], v14 offset:53248
    ds_read_b64_tr_b16 v[90:91], v14 offset:53760
    v_mfma_f32_16x16x32_bf16 v[240:243], v[64:67], a[76:79], v[240:243]
    ds_read_b64_tr_b16 v[92:93], v15 offset:53248
    ds_read_b64_tr_b16 v[94:95], v15 offset:53760
    v_mfma_f32_16x16x32_bf16 v[196:199], v[68:71], a[64:67], v[196:199]
    v_mfma_f32_16x16x32_bf16 v[112:115], v[32:35], v[48:51], 0
    s_nop 0
    v_mfma_f32_16x16x32_bf16 v[212:215], v[68:71], a[68:71], v[212:215]
    v_mfma_f32_16x16x32_bf16 v[112:115], v[36:39], v[52:55], v[112:115]
    s_nop 0
    v_mfma_f32_16x16x32_bf16 v[228:231], v[68:71], a[72:75], v[228:231]
    v_mfma_f32_16x16x32_bf16 v[112:115], v[40:43], v[56:59], v[112:115]
    s_nop 0
    v_mfma_f32_16x16x32_bf16 v[244:247], v[68:71], a[76:79], v[244:247]
    v_mfma_f32_16x16x32_bf16 v[112:115], v[44:47], v[60:63], v[112:115]
    s_nop 0
    v_mfma_f32_16x16x32_bf16 v[200:203], v[72:75], a[64:67], v[200:203]
    s_cmp_ge_u32 s82, 4
    s_cselect_b32 s40, s7, s6
    v_mfma_f32_16x16x32_bf16 v[216:219], v[72:75], a[68:71], v[216:219]
    s_lshl_b32 s40, s40, 1
    v_cvt_pk_bf16_f32 v128, v128, v129
    v_cvt_pk_bf16_f32 v129, v130, v131
    v_mfma_f32_16x16x32_bf16 v[232:235], v[72:75], a[72:75], v[232:235]
    s_bfe_u32 s83, s2, 0x10001
    v_cvt_pk_bf16_f32 v130, v132, v133
    v_cvt_pk_bf16_f32 v131, v134, v135
    v_mfma_f32_16x16x32_bf16 v[248:251], v[72:75], a[76:79], v[248:251]
    s_add_u32 s40, s40, s83
    v_accvgpr_write_b32 a0, v128
    v_accvgpr_write_b32 a1, v129
    v_mfma_f32_16x16x32_bf16 v[204:207], v[76:79], a[64:67], v[204:207]
    s_lshl_b32 s40, s40, 4
    v_accvgpr_write_b32 a2, v130
    v_accvgpr_write_b32 a3, v131
    v_mfma_f32_16x16x32_bf16 v[220:223], v[76:79], a[68:71], v[220:223]
    s_and_b32 s83, s4, 3
    v_cvt_pk_bf16_f32 v136, v136, v137
    v_cvt_pk_bf16_f32 v137, v138, v139
    v_mfma_f32_16x16x32_bf16 v[236:239], v[76:79], a[72:75], v[236:239]
    s_lshl_b32 s83, s83, 1
    v_cvt_pk_bf16_f32 v138, v140, v141
    v_cvt_pk_bf16_f32 v139, v142, v143
    v_mfma_f32_16x16x32_bf16 v[252:255], v[76:79], a[76:79], v[252:255]
    s_waitcnt lgkmcnt(0)
    v_accvgpr_write_b32 a4, v136
    v_accvgpr_write_b32 a5, v137
    v_mfma_f32_16x16x32_bf16 v[192:195], v[80:83], a[80:83], v[192:195]
    s_and_b32 s82, s2, 1
    ds_read_b64_tr_b16 v[64:65], v12 offset:57344
    ds_read_b64_tr_b16 v[66:67], v12 offset:57856
    v_mfma_f32_16x16x32_bf16 v[208:211], v[80:83], a[84:87], v[208:211]
    s_add_u32 s83, s83, s82
    ds_read_b64_tr_b16 v[68:69], v13 offset:57344
    ds_read_b64_tr_b16 v[70:71], v13 offset:57856
    v_mfma_f32_16x16x32_bf16 v[224:227], v[80:83], a[88:91], v[224:227]
    s_lshl_b32 s42, s83, 7
    ds_read_b64_tr_b16 v[72:73], v14 offset:57344
    ds_read_b64_tr_b16 v[74:75], v14 offset:57856
    v_mfma_f32_16x16x32_bf16 v[240:243], v[80:83], a[92:95], v[240:243]
    s_lshl_b32 s34, s40, 10
    ds_read_b64_tr_b16 v[76:77], v15 offset:57344
    ds_read_b64_tr_b16 v[78:79], v15 offset:57856
    v_mfma_f32_16x16x32_bf16 v[196:199], v[84:87], a[80:83], v[196:199]
    s_add_u32 s34, s34, s42
    buffer_load_dword v21, v20, s[28:31], s44 offen sc1
    v_mfma_f32_16x16x32_bf16 v[212:215], v[84:87], a[84:87], v[212:215]
    v_accvgpr_write_b32 a6, v138
    v_accvgpr_write_b32 a7, v139
    v_mfma_f32_16x16x32_bf16 v[228:231], v[84:87], a[88:91], v[228:231]
    v_cvt_pk_bf16_f32 v144, v144, v145
    v_cvt_pk_bf16_f32 v145, v146, v147
    v_mfma_f32_16x16x32_bf16 v[244:247], v[84:87], a[92:95], v[244:247]
    v_cvt_pk_bf16_f32 v146, v148, v149
    v_cvt_pk_bf16_f32 v147, v150, v151
    v_mfma_f32_16x16x32_bf16 v[200:203], v[88:91], a[80:83], v[200:203]
    v_accvgpr_write_b32 a8, v144
    v_accvgpr_write_b32 a9, v145
    v_mfma_f32_16x16x32_bf16 v[216:219], v[88:91], a[84:87], v[216:219]
    v_accvgpr_write_b32 a10, v146
    v_accvgpr_write_b32 a11, v147
    v_mfma_f32_16x16x32_bf16 v[232:235], v[88:91], a[88:91], v[232:235]
    v_cvt_pk_bf16_f32 v152, v152, v153
    v_cvt_pk_bf16_f32 v153, v154, v155
    v_mfma_f32_16x16x32_bf16 v[248:251], v[88:91], a[92:95], v[248:251]
    v_cvt_pk_bf16_f32 v154, v156, v157
    v_cvt_pk_bf16_f32 v155, v158, v159
    v_mfma_f32_16x16x32_bf16 v[204:207], v[92:95], a[80:83], v[204:207]
    v_accvgpr_write_b32 a12, v152
    v_accvgpr_write_b32 a13, v153
    v_mfma_f32_16x16x32_bf16 v[220:223], v[92:95], a[84:87], v[220:223]
    v_accvgpr_write_b32 a14, v154
    v_accvgpr_write_b32 a15, v155
    v_mfma_f32_16x16x32_bf16 v[236:239], v[92:95], a[88:91], v[236:239]
    v_cvt_pk_bf16_f32 v160, v160, v161
    v_cvt_pk_bf16_f32 v161, v162, v163
    v_mfma_f32_16x16x32_bf16 v[252:255], v[92:95], a[92:95], v[252:255]
    s_waitcnt lgkmcnt(0)
    v_cvt_pk_bf16_f32 v162, v164, v165
    v_cvt_pk_bf16_f32 v163, v166, v167
    v_mfma_f32_16x16x32_bf16 v[192:195], v[64:67], a[96:99], v[192:195]
    ds_read_b64_tr_b16 v[80:81], v12 offset:61440
    ds_read_b64_tr_b16 v[82:83], v12 offset:61952
    v_mfma_f32_16x16x32_bf16 v[208:211], v[64:67], a[100:103], v[208:211]
    ds_read_b64_tr_b16 v[84:85], v13 offset:61440
    ds_read_b64_tr_b16 v[86:87], v13 offset:61952
    v_mfma_f32_16x16x32_bf16 v[224:227], v[64:67], a[104:107], v[224:227]
    ds_read_b64_tr_b16 v[88:89], v14 offset:61440
    ds_read_b64_tr_b16 v[90:91], v14 offset:61952
    v_mfma_f32_16x16x32_bf16 v[240:243], v[64:67], a[108:111], v[240:243]
    ds_read_b64_tr_b16 v[92:93], v15 offset:61440
    ds_read_b64_tr_b16 v[94:95], v15 offset:61952
    v_mfma_f32_16x16x32_bf16 v[196:199], v[68:71], a[96:99], v[196:199]
    ds_write_b128 v120, v[112:115]
    v_accvgpr_write_b32 a16, v160
    v_mfma_f32_16x16x32_bf16 v[212:215], v[68:71], a[100:103], v[212:215]
    v_accvgpr_write_b32 a17, v161
    v_accvgpr_write_b32 a18, v162
    v_mfma_f32_16x16x32_bf16 v[228:231], v[68:71], a[104:107], v[228:231]
    v_accvgpr_write_b32 a19, v163
    v_cvt_pk_bf16_f32 v168, v168, v169
    v_mfma_f32_16x16x32_bf16 v[244:247], v[68:71], a[108:111], v[244:247]
    v_cvt_pk_bf16_f32 v169, v170, v171
    v_cvt_pk_bf16_f32 v170, v172, v173
    v_mfma_f32_16x16x32_bf16 v[200:203], v[72:75], a[96:99], v[200:203]
    v_cvt_pk_bf16_f32 v171, v174, v175
    v_accvgpr_write_b32 a20, v168
    v_mfma_f32_16x16x32_bf16 v[216:219], v[72:75], a[100:103], v[216:219]
    v_accvgpr_write_b32 a21, v169
    v_accvgpr_write_b32 a22, v170
    v_mfma_f32_16x16x32_bf16 v[232:235], v[72:75], a[104:107], v[232:235]
    v_accvgpr_write_b32 a23, v171
    v_cvt_pk_bf16_f32 v176, v176, v177
    v_mfma_f32_16x16x32_bf16 v[248:251], v[72:75], a[108:111], v[248:251]
    v_cvt_pk_bf16_f32 v177, v178, v179
    v_cvt_pk_bf16_f32 v178, v180, v181
    v_mfma_f32_16x16x32_bf16 v[204:207], v[76:79], a[96:99], v[204:207]
    v_cvt_pk_bf16_f32 v179, v182, v183
    v_accvgpr_write_b32 a24, v176
    v_mfma_f32_16x16x32_bf16 v[220:223], v[76:79], a[100:103], v[220:223]
    v_accvgpr_write_b32 a25, v177
    v_accvgpr_write_b32 a26, v178
    v_mfma_f32_16x16x32_bf16 v[236:239], v[76:79], a[104:107], v[236:239]
    v_accvgpr_write_b32 a27, v179
    v_cvt_pk_bf16_f32 v184, v184, v185
    v_mfma_f32_16x16x32_bf16 v[252:255], v[76:79], a[108:111], v[252:255]
    s_waitcnt lgkmcnt(0)
    v_cvt_pk_bf16_f32 v185, v186, v187
    v_cvt_pk_bf16_f32 v186, v188, v189
    v_mfma_f32_16x16x32_bf16 v[192:195], v[80:83], a[112:115], v[192:195]
    s_waitcnt vmcnt(0)
    v_mfma_f32_16x16x32_bf16 v[208:211], v[80:83], a[116:119], v[208:211]
    v_mfma_f32_16x16x32_bf16 v[224:227], v[80:83], a[120:123], v[224:227]
    v_cmp_eq_u32 vcc, 0, v21
    s_nop 0
    s_cmp_lg_u64 vcc, 0
    s_cbranch_scc1 kv_spin
    kv_spin_ok:
    v_mfma_f32_16x16x32_bf16 v[240:243], v[80:83], a[124:127], v[240:243]
    s_add_u32 s52, s52, 1
    v_readlane_b32 s81, v5, s52
    v_mfma_f32_16x16x32_bf16 v[196:199], v[84:87], a[112:115], v[196:199]
    s_add_u32 s54, s54, 0x8000
    v_cvt_pk_bf16_f32 v187, v190, v191
    v_accvgpr_write_b32 a28, v184
    v_mfma_f32_16x16x32_bf16 v[212:215], v[84:87], a[116:119], v[212:215]
    s_and_b32 s54, s54, 0x1ffff
    v_accvgpr_write_b32 a29, v185
    v_accvgpr_write_b32 a30, v186
    v_mfma_f32_16x16x32_bf16 v[228:231], v[84:87], a[120:123], v[228:231]
    s_add_u32 m0, s54, s55
    v_add_u32 v4, s81, v2
    v_accvgpr_write_b32 a31, v187
    v_mfma_f32_16x16x32_bf16 v[244:247], v[84:87], a[124:127], v[244:247]
    buffer_load_dwordx4 v4, s[28:31], 0 offen offset:0 sc1 lds
    v_mfma_f32_16x16x32_bf16 v[200:203], v[88:91], a[112:115], v[200:203]
    v_mfma_f32_16x16x32_bf16 v[216:219], v[88:91], a[116:119], v[216:219]
    buffer_load_dwordx4 v4, s[28:31], 0 offen offset:1024 sc1 lds
    v_mfma_f32_16x16x32_bf16 v[232:235], v[88:91], a[120:123], v[232:235]
    v_mfma_f32_16x16x32_bf16 v[248:251], v[88:91], a[124:127], v[248:251]
    buffer_load_dwordx4 v4, s[28:31], 0 offen offset:2048 sc1 lds
    v_mfma_f32_16x16x32_bf16 v[204:207], v[92:95], a[112:115], v[204:207]
    v_mfma_f32_16x16x32_bf16 v[220:223], v[92:95], a[116:119], v[220:223]
    buffer_load_dwordx4 v4, s[28:31], 0 offen offset:3072 sc1 lds
    v_mfma_f32_16x16x32_bf16 v[236:239], v[92:95], a[120:123], v[236:239]
    s_add_u32 m0, m0, 0x1000
    v_mfma_f32_16x16x32_bf16 v[252:255], v[92:95], a[124:127], v[252:255]
    buffer_load_dwordx4 v4, s[28:31], s76 offen offset:0 sc1 lds
    buffer_load_dwordx4 v4, s[28:31], s76 offen offset:1024 sc1 lds
    s_nop 7
    v_cvt_pk_bf16_f32 v192, v192, v193
    v_cvt_pk_bf16_f32 v193, v194, v195
    v_cvt_pk_bf16_f32 v194, v196, v197
    v_cvt_pk_bf16_f32 v195, v198, v199
    buffer_load_dwordx4 v4, s[28:31], s76 offen offset:2048 sc1 lds
    v_accvgpr_write_b32 a32, v192
    v_accvgpr_write_b32 a33, v193
    v_accvgpr_write_b32 a34, v194
    v_accvgpr_write_b32 a35, v195
    v_mfma_f32_32x32x16_bf16 a[96:111], a[148:151], a[148:151], 0
    buffer_load_dwordx4 v4, s[28:31], s76 offen offset:3072 sc1 lds
    v_cvt_pk_bf16_f32 v200, v200, v201
    v_cvt_pk_bf16_f32 v201, v202, v203
    v_cvt_pk_bf16_f32 v202, v204, v205
    v_cvt_pk_bf16_f32 v203, v206, v207
    v_accvgpr_write_b32 a36, v200
    s_add_u32 s52, s52, 1
    v_readlane_b32 s81, v5, s52
    s_add_u32 s54, s54, 0x8000
    s_and_b32 s54, s54, 0x1ffff
    s_add_u32 m0, s54, s55
    v_accvgpr_write_b32 a37, v201
    v_add_u32 v4, s81, v2
    buffer_load_dwordx4 v4, s[28:31], 0 offen offset:0 sc1 lds
    v_accvgpr_write_b32 a38, v202
    v_accvgpr_write_b32 a39, v203
    v_mfma_f32_32x32x16_bf16 a[112:127], a[148:151], a[148:151], 0
    v_cvt_pk_bf16_f32 v208, v208, v209
    v_cvt_pk_bf16_f32 v209, v210, v211
    buffer_load_dwordx4 v4, s[28:31], 0 offen offset:1024 sc1 lds
    v_cvt_pk_bf16_f32 v210, v212, v213
    v_cvt_pk_bf16_f32 v211, v214, v215
    v_accvgpr_write_b32 a40, v208
    v_accvgpr_write_b32 a41, v209
    v_accvgpr_write_b32 a42, v210
    buffer_load_dwordx4 v4, s[28:31], 0 offen offset:2048 sc1 lds
    v_accvgpr_write_b32 a43, v211
    v_mfma_f32_32x32x16_bf16 a[128:143], a[148:151], a[148:151], 0
    v_cvt_pk_bf16_f32 v216, v216, v217
    v_cvt_pk_bf16_f32 v217, v218, v219
    v_cvt_pk_bf16_f32 v218, v220, v221
    buffer_load_dwordx4 v4, s[28:31], 0 offen offset:3072 sc1 lds
    v_cvt_pk_bf16_f32 v219, v222, v223
    v_accvgpr_write_b32 a44, v216
    v_accvgpr_write_b32 a45, v217
    v_accvgpr_write_b32 a46, v218
    v_accvgpr_write_b32 a47, v219
    s_add_u32 m0, m0, 0x1000
    v_mfma_f32_32x32x16_bf16 v[128:143], a[148:151], a[148:151], 0
    buffer_load_dwordx4 v4, s[28:31], s76 offen offset:0 sc1 lds
    v_cvt_pk_bf16_f32 v224, v224, v225
    v_cvt_pk_bf16_f32 v225, v226, v227
    v_cvt_pk_bf16_f32 v226, v228, v229
    v_cvt_pk_bf16_f32 v227, v230, v231
    v_accvgpr_write_b32 a48, v224
    buffer_load_dwordx4 v4, s[28:31], s76 offen offset:1024 sc1 lds
    v_accvgpr_write_b32 a49, v225
    v_accvgpr_write_b32 a50, v226
    v_accvgpr_write_b32 a51, v227
    v_mfma_f32_32x32x16_bf16 v[144:159], a[148:151], a[148:151], 0
    v_cvt_pk_bf16_f32 v232, v232, v233
    buffer_load_dwordx4 v4, s[28:31], s76 offen offset:2048 sc1 lds
    v_cvt_pk_bf16_f32 v233, v234, v235
    v_cvt_pk_bf16_f32 v234, v236, v237
    v_cvt_pk_bf16_f32 v235, v238, v239
    v_accvgpr_write_b32 a52, v232
    v_accvgpr_write_b32 a53, v233
    buffer_load_dwordx4 v4, s[28:31], s76 offen offset:3072 sc1 lds
    v_accvgpr_write_b32 a54, v234
    v_accvgpr_write_b32 a55, v235
    v_mfma_f32_32x32x16_bf16 v[160:175], a[148:151], a[148:151], 0
    v_cvt_pk_bf16_f32 v240, v240, v241
    v_cvt_pk_bf16_f32 v241, v242, v243
    s_add_u32 s52, s52, 1
    v_readlane_b32 s81, v5, s52
    s_add_u32 s54, s54, 0x8000
    s_and_b32 s54, s54, 0x1ffff
    s_add_u32 m0, s54, s55
    v_cvt_pk_bf16_f32 v242, v244, v245
    v_add_u32 v4, s81, v2
    buffer_load_dwordx4 v4, s[28:31], 0 offen offset:0 sc1 lds
    v_cvt_pk_bf16_f32 v243, v246, v247
    v_accvgpr_write_b32 a56, v240
    v_accvgpr_write_b32 a57, v241
    v_accvgpr_write_b32 a58, v242
    v_accvgpr_write_b32 a59, v243
    buffer_load_dwordx4 v4, s[28:31], 0 offen offset:1024 sc1 lds
    v_mfma_f32_32x32x16_bf16 v[176:191], a[148:151], a[148:151], 0
    v_cvt_pk_bf16_f32 v248, v248, v249
    v_cvt_pk_bf16_f32 v249, v250, v251
    v_cvt_pk_bf16_f32 v250, v252, v253
    v_cvt_pk_bf16_f32 v251, v254, v255
    buffer_load_dwordx4 v4, s[28:31], 0 offen offset:2048 sc1 lds
    v_accvgpr_write_b32 a60, v248
    v_accvgpr_write_b32 a61, v249
    v_accvgpr_write_b32 a62, v250
    v_accvgpr_write_b32 a63, v251
    buffer_load_dwordx4 v4, s[28:31], 0 offen offset:3072 sc1 lds
    s_add_u32 m0, m0, 0x1000
    s_nop 0
    buffer_load_dwordx4 v4, s[28:31], s76 offen offset:0 sc1 lds
    buffer_load_dwordx4 v4, s[28:31], s76 offen offset:1024 sc1 lds
    buffer_load_dwordx4 v4, s[28:31], s76 offen offset:2048 sc1 lds
    buffer_load_dwordx4 v4, s[28:31], s76 offen offset:3072 sc1 lds
    s_waitcnt lgkmcnt(0)
    s_barrier
    v_lshrrev_b32 v100, 4, v1
    v_and_b32 v102, 1, v1
    v_lshlrev_b32 v101, 5, v100
    v_lshl_add_u32 v101, v102, 4, v101
    v_add_u32 v101, 0x21c00, v101
    ds_read_b128 v[108:111], v101 offset:0
    ds_read_b128 v[112:115], v101 offset:128
    ds_read_b128 v[116:119], v101 offset:256
    ds_read_b128 v[120:123], v101 offset:384
    v_lshlrev_b32 v100, 4, v100
    v_mfma_f32_32x32x16_bf16 v[192:207], a[148:151], a[148:151], 0
    v_lshl_add_u32 v100, v102, 5, v100
    v_mov_b32 v103, 0x7f000000
    s_lshl_b32 s48, s43, 2
    s_add_u32 s48, s48, 0x340a000
    s_cmp_ge_u32 s43, 3584
    s_cselect_b32 s49, 1, s3
    s_cmp_lg_u32 s49, 0
    s_cselect_b64 vcc, 0, 0x30003
    v_cndmask_b32 v100, v103, v100, vcc
    v_mov_b32 v104, s50
    v_mov_b32 v105, s51
    v_cmp_eq_u32 vcc, 1, v102
    s_andn2_b32 s37, 0x7ff, s50
    v_mfma_f32_32x32x16_bf16 v[208:223], a[148:151], a[148:151], 0
    s_andn2_b32 s43, 0x7ff, s51
    v_cndmask_b32 v104, v104, v105, vcc
    v_lshrrev_b32 v88, 4, v1
    v_lshlrev_b32 v88, 2, v88
    v_and_b32 v89, 15, v1
    v_sub_u32 v89, v89, v88
    v_cmp_gt_i32 s[64:65], 0, v89
    v_cmp_gt_i32 s[66:67], 1, v89
    v_cmp_gt_i32 s[68:69], 2, v89
    v_cmp_gt_i32 s[70:71], 3, v89
    v_mfma_f32_32x32x16_bf16 v[224:239], a[148:151], a[148:151], 0
    v_add_u32 v13, 0x20000, v12
    v_add_u32 v12, 0x1000, v2
    v_and_b32 v15, 31, v1
    v_lshlrev_b32 v15, 2, v15
    s_cmp_eq_u32 s5, 7
    s_cselect_b32 s44, 0x2000, 0
    s_sub_u32 s44, s80, s44
    v_mov_b32 v96, -1
    v_mov_b32 v97, -1
    v_mov_b32 v98, -1
    v_mov_b32 v99, -1
    s_and_b32 s17, s17, 0xffff
    v_mfma_f32_32x32x16_bf16 v[240:255], a[148:151], a[148:151], 0
    s_mov_b32 s18, 0x200000
    s_mov_b32 s19, 0x00020000
    v_mov_b32 v56, 0
    v_mov_b32 v57, 0
    v_mov_b32 v58, 0
    v_mov_b32 v59, 0
    v_mov_b32 v60, 0
    v_mov_b32 v61, 0
    v_mov_b32 v62, 0
    v_mov_b32 v63, 0
att_w0:
    s_waitcnt vmcnt(16) lgkmcnt(0)
    s_barrier
    v_xor_b32 v3, s54, v7
    ds_read_b128 a[64:67], v3 offset:0
    ds_read_b128 a[68:71], v3 offset:1024
    ds_read_b128 a[72:75], v3 offset:2048
    ds_read_b128 a[76:79], v3 offset:3072
    ds_read_b128 a[80:83], v3 offset:4096
    ds_read_b128 a[84:87], v3 offset:5120
    ds_read_b128 a[88:91], v3 offset:6144
    ds_read_b128 a[92:95], v3 offset:7168
    s_waitcnt lgkmcnt(4)
    v_mfma_f32_16x16x32_bf16 v[16:19], a[64:67], a[0:3], 0
    v_accvgpr_read_b32 v92, a152
    v_accvgpr_read_b32 v93, a153
    v_mfma_f32_16x16x32_bf16 v[20:23], a[68:71], a[0:3], 0
    s_add_u32 m0, s55, 0x20000
    v_lshlrev_b32 v106, 11, v1
    v_mov_b32 v107, 0x7f000000
    v_mfma_f32_16x16x32_bf16 v[24:27], a[64:67], a[8:11], 0
    s_xor_b32 s81, s41, 0x0
    buffer_load_dwordx4 v92, s[8:11], s81 offen offset:0 lds
    v_mfma_f32_16x16x32_bf16 v[28:31], a[68:71], a[8:11], 0
    v_cmp_gt_u32 vcc, 56, v1
    v_mfma_f32_16x16x32_bf16 v[16:19], a[72:75], a[4:7], v[16:19]
    s_lshr_b32 s50, s2, 6
    buffer_load_dwordx4 v93, s[8:11], s81 offen offset:1024 lds
    v_mfma_f32_16x16x32_bf16 v[20:23], a[76:79], a[4:7], v[20:23]
    s_add_u32 s81, s81, 6144
    v_mfma_f32_16x16x32_bf16 v[24:27], a[72:75], a[12:15], v[24:27]
    s_lshl_b32 s50, s50, 2
    buffer_load_dwordx4 v92, s[8:11], s81 offen offset:2048 lds
    v_mfma_f32_16x16x32_bf16 v[28:31], a[76:79], a[12:15], v[28:31]
    s_waitcnt lgkmcnt(0)
    v_mfma_f32_16x16x32_bf16 v[16:19], a[80:83], a[32:35], v[16:19]
    s_add_u32 s50, s50, s3
    buffer_load_dwordx4 v93, s[8:11], s81 offen offset:3072 lds
    v_mfma_f32_16x16x32_bf16 v[20:23], a[84:87], a[32:35], v[20:23]
    s_add_u32 m0, m0, 0x1000
    v_mfma_f32_16x16x32_bf16 v[24:27], a[80:83], a[40:43], v[24:27]
    s_sub_u32 s81, s81, 6016
    buffer_load_dwordx4 v92, s[8:11], s81 offen offset:0 lds
    v_mfma_f32_16x16x32_bf16 v[28:31], a[84:87], a[40:43], v[28:31]
    s_mul_i32 s50, s50, 114688
    v_mfma_f32_16x16x32_bf16 v[16:19], a[88:91], a[36:39], v[16:19]
    s_and_b32 s51, s2, 7
    buffer_load_dwordx4 v93, s[8:11], s81 offen offset:1024 lds
    v_mfma_f32_16x16x32_bf16 v[20:23], a[92:95], a[36:39], v[20:23]
    s_add_u32 s81, s81, 6144
    v_mfma_f32_16x16x32_bf16 v[24:27], a[88:91], a[44:47], v[24:27]
    s_lshl_b32 s51, s51, 7
    buffer_load_dwordx4 v92, s[8:11], s81 offen offset:2048 lds
    v_mfma_f32_16x16x32_bf16 v[28:31], a[92:95], a[44:47], v[28:31]
    s_add_u32 s50, s50, s51
    v_mfma_f32_16x16x32_bf16 v[32:35], a[64:67], a[16:19], 0
    s_bfe_u32 s51, s2, 0x30003
    buffer_load_dwordx4 v93, s[8:11], s81 offen offset:3072 lds
    v_mfma_f32_16x16x32_bf16 v[36:39], a[68:71], a[16:19], 0
    s_add_u32 s52, s52, 1
    v_readlane_b32 s81, v5, s52
    v_mfma_f32_16x16x32_bf16 v[40:43], a[64:67], a[24:27], 0
    s_add_u32 s54, s54, 0x8000
    v_mfma_f32_16x16x32_bf16 v[44:47], a[68:71], a[24:27], 0
    s_and_b32 s54, s54, 0x1ffff
    v_mfma_f32_16x16x32_bf16 v[32:35], a[72:75], a[20:23], v[32:35]
    s_add_u32 m0, s54, s55
    v_add_u32 v4, s81, v2
    v_mfma_f32_16x16x32_bf16 v[36:39], a[76:79], a[20:23], v[36:39]
    s_lshl_b32 s51, s51, 4
    buffer_load_dwordx4 v4, s[28:31], 0 offen offset:0 sc1 lds
    v_mfma_f32_16x16x32_bf16 v[40:43], a[72:75], a[28:31], v[40:43]
    s_add_u32 s50, s50, s51
    v_cndmask_b32 v106, v107, v106, vcc
    v_ashrrev_i32 v105, 31, v104
    v_mfma_f32_16x16x32_bf16 v[44:47], a[76:79], a[28:31], v[44:47]
    buffer_load_dwordx4 v4, s[28:31], 0 offen offset:1024 sc1 lds
    v_mfma_f32_16x16x32_bf16 v[32:35], a[80:83], a[48:51], v[32:35]
    v_not_b32 v105, v105
    v_or_b32 v105, 0x80000000, v105
    v_mfma_f32_16x16x32_bf16 v[36:39], a[84:87], a[48:51], v[36:39]
    buffer_load_dwordx4 v4, s[28:31], 0 offen offset:2048 sc1 lds
    v_mfma_f32_16x16x32_bf16 v[40:43], a[80:83], a[56:59], v[40:43]
    v_xor_b32 v104, v104, v105
    v_mul_f32 v104, 0xbfb8aa3b, v104
    v_mfma_f32_16x16x32_bf16 v[44:47], a[84:87], a[56:59], v[44:47]
    buffer_load_dwordx4 v4, s[28:31], 0 offen offset:3072 sc1 lds
    v_mfma_f32_16x16x32_bf16 v[32:35], a[88:91], a[52:55], v[32:35]
    s_add_u32 m0, m0, 0x1000
    v_exp_f32 v104, v104
    v_mfma_f32_16x16x32_bf16 v[36:39], a[92:95], a[52:55], v[36:39]
    buffer_load_dwordx4 v4, s[28:31], s76 offen offset:0 sc1 lds
    v_mfma_f32_16x16x32_bf16 v[40:43], a[88:91], a[60:63], v[40:43]
    v_add_f32 v108, v108, v112
    v_add_f32 v109, v109, v113
    v_mfma_f32_16x16x32_bf16 v[44:47], a[92:95], a[60:63], v[44:47]
    buffer_load_dwordx4 v4, s[28:31], s76 offen offset:1024 sc1 lds
    buffer_load_dwordx4 v4, s[28:31], s76 offen offset:2048 sc1 lds
    buffer_load_dwordx4 v4, s[28:31], s76 offen offset:3072 sc1 lds
    buffer_store_dwordx4 v[96:99], v2, s[28:31], s44 offen sc1
    s_add_u32 s52, s52, 1
    v_readlane_b32 s81, v5, s52
    v_add_f32 v110, v110, v114
    v_add_f32 v111, v111, v115
    v_add_f32 v116, v116, v120
    v_add_f32 v117, v117, v121
    v_add_f32 v118, v118, v122
    v_add_f32 v119, v119, v123
    v_add_f32 v104, 1.0, v104
    v_add_f32 v112, v108, v116
    v_add_f32 v113, v109, v117
    v_add_f32 v114, v110, v118
    v_add_f32 v115, v111, v119
    v_add_f32 v108, v108, v116
    v_add_f32 v109, v109, v117
    v_add_f32 v110, v110, v118
    v_add_f32 v111, v111, v119
    v_rcp_f32 v104, v104
    s_nop 0
    v_permlane32_swap_b32 v108, v112
    v_permlane32_swap_b32 v109, v113
    v_permlane32_swap_b32 v110, v114
    v_permlane32_swap_b32 v111, v115
    v_mul_f32 v124, 0xbfb8aa3b, v108
    v_mul_f32 v125, 0xbfb8aa3b, v109
    v_mul_f32 v126, 0xbfb8aa3b, v110
    v_mul_f32 v127, 0xbfb8aa3b, v111
    v_exp_f32 v124, v124
    v_exp_f32 v125, v125
    v_exp_f32 v126, v126
    v_exp_f32 v127, v127
    v_mul_f32 v108, v108, v112
    v_mul_f32 v109, v109, v113
    v_mul_f32 v110, v110, v114
    v_mul_f32 v111, v111, v115
    v_add_f32 v124, 1.0, v124
    v_add_f32 v125, 1.0, v125
    v_add_f32 v126, 1.0, v126
    v_add_f32 v127, 1.0, v127
    v_rcp_f32 v124, v124
    v_rcp_f32 v125, v125
    v_rcp_f32 v126, v126
    v_rcp_f32 v127, v127
    v_mul_f32 v108, v108, v104
    v_mul_f32 v109, v109, v104
    v_mul_f32 v110, v110, v104
    v_mul_f32 v111, v111, v104
    v_mul_f32 v108, v108, v124
    v_mul_f32 v109, v109, v125
    v_mul_f32 v110, v110, v126
    v_mul_f32 v111, v111, v127
    v_or_b32 v108, 1, v108
    v_or_b32 v109, 1, v109
    v_or_b32 v110, 1, v110
    v_or_b32 v111, 1, v111
    buffer_store_dwordx4 v[108:111], v100, s[28:31], s48 offen sc1
    buffer_load_dwordx4 v[80:83], v106, s[60:63], s50 offen offset:0
    buffer_load_dwordx4 v[84:87], v106, s[60:63], s50 offen offset:1024
    s_cmp_lg_u32 s6, 0
    s_cbranch_scc1 w0_nomask
    v_cndmask_b32 v16, v16, v6, s[64:65]
    v_cndmask_b32 v17, v17, v6, s[66:67]
    v_cndmask_b32 v18, v18, v6, s[68:69]
    v_cndmask_b32 v19, v19, v6, s[70:71]
    v_mov_b32 v20, v6
    v_mov_b32 v21, v6
    v_mov_b32 v22, v6
    v_mov_b32 v23, v6
    v_cndmask_b32 v28, v28, v6, s[64:65]
    v_cndmask_b32 v29, v29, v6, s[66:67]
    v_cndmask_b32 v30, v30, v6, s[68:69]
    v_cndmask_b32 v31, v31, v6, s[70:71]
w0_nomask:
    v_max3_f32 v88, v16, v17, v8
    v_max3_f32 v89, v18, v19, v20
    v_max3_f32 v88, v88, v21, v22
    v_max3_f32 v88, v88, v89, v23
    v_max3_f32 v90, v24, v25, v9
    v_max3_f32 v91, v26, v27, v28
    v_max3_f32 v90, v90, v29, v30
    v_max3_f32 v90, v90, v91, v31
    v_mov_b32 v89, v88
    v_mov_b32 v91, v90
    s_nop 1
    v_permlane32_swap_b32 v88, v89
    v_permlane32_swap_b32 v90, v91
    s_nop 0
    v_max_f32 v88, v88, v89
    v_max_f32 v90, v90, v91
    v_mov_b32 v89, v88
    v_mov_b32 v91, v90
    s_nop 1
    v_permlane16_swap_b32 v88, v89
    v_permlane16_swap_b32 v90, v91
    s_nop 0
    v_max_f32 v88, v88, v89
    v_max_f32 v90, v90, v91
    v_sub_f32 v16, v16, v88
    v_sub_f32 v17, v17, v88
    v_sub_f32 v18, v18, v88
    v_sub_f32 v19, v19, v88
    v_sub_f32 v20, v20, v88
    v_sub_f32 v21, v21, v88
    v_sub_f32 v22, v22, v88
    v_sub_f32 v23, v23, v88
    v_sub_f32 v64, 0, v88
    v_sub_f32 v65, 0, v88
    v_sub_f32 v66, 0, v88
    v_sub_f32 v67, 0, v88
    v_sub_f32 v24, v24, v90
    v_sub_f32 v25, v25, v90
    v_sub_f32 v26, v26, v90
    v_sub_f32 v27, v27, v90
    v_sub_f32 v28, v28, v90
    v_sub_f32 v29, v29, v90
    v_sub_f32 v30, v30, v90
    v_sub_f32 v31, v31, v90
    v_sub_f32 v68, 0, v90
    v_sub_f32 v69, 0, v90
    v_sub_f32 v70, 0, v90
    v_sub_f32 v71, 0, v90
    v_max3_f32 v88, v32, v33, v10
    v_max3_f32 v89, v34, v35, v36
    v_max3_f32 v88, v88, v37, v38
    v_max3_f32 v88, v88, v89, v39
    v_max3_f32 v90, v40, v41, v11
    v_max3_f32 v91, v42, v43, v44
    v_max3_f32 v90, v90, v45, v46
    v_max3_f32 v90, v90, v91, v47
    v_mov_b32 v89, v88
    v_mov_b32 v91, v90
    s_nop 1
    v_permlane32_swap_b32 v88, v89
    v_permlane32_swap_b32 v90, v91
    s_nop 0
    v_max_f32 v88, v88, v89
    v_max_f32 v90, v90, v91
    v_mov_b32 v89, v88
    v_mov_b32 v91, v90
    s_nop 1
    v_permlane16_swap_b32 v88, v89
    v_permlane16_swap_b32 v90, v91
    s_nop 0
    v_max_f32 v88, v88, v89
    v_max_f32 v90, v90, v91
    v_sub_f32 v32, v32, v88
    v_sub_f32 v33, v33, v88
    v_sub_f32 v34, v34, v88
    v_sub_f32 v35, v35, v88
    v_sub_f32 v36, v36, v88
    v_sub_f32 v37, v37, v88
    v_sub_f32 v38, v38, v88
    v_sub_f32 v39, v39, v88
    v_sub_f32 v72, 0, v88
    v_sub_f32 v73, 0, v88
    v_sub_f32 v74, 0, v88
    v_sub_f32 v75, 0, v88
    v_sub_f32 v40, v40, v90
    v_sub_f32 v41, v41, v90
    v_sub_f32 v42, v42, v90
    v_sub_f32 v43, v43, v90
    v_sub_f32 v44, v44, v90
    v_sub_f32 v45, v45, v90
    v_sub_f32 v46, v46, v90
    v_sub_f32 v47, v47, v90
    v_sub_f32 v76, 0, v90
    v_sub_f32 v77, 0, v90
    v_sub_f32 v78, 0, v90
    v_sub_f32 v79, 0, v90
    v_exp_f32 v16, v16
    v_exp_f32 v17, v17
    s_nop 0
    v_cvt_pk_bf16_f32 v48, v16, v17
    v_exp_f32 v18, v18
    v_exp_f32 v19, v19
    s_nop 0
    v_cvt_pk_bf16_f32 v49, v18, v19
    v_exp_f32 v20, v20
    v_exp_f32 v21, v21
    s_nop 0
    v_cvt_pk_bf16_f32 v50, v20, v21
    v_exp_f32 v22, v22
    v_exp_f32 v23, v23
    s_waitcnt vmcnt(25) lgkmcnt(0)
    s_add_u32 s53, s6, 3
    s_cmp_lt_u32 s6, 2
    s_cbranch_scc1 dd_done
.p2align 3
dd_loop:
    v_mfma_f32_16x16x32_bf16 v[192:195], a[96:99], v[56:59], v[192:195]
    s_barrier
    v_exp_f32 v24, v24
    v_mfma_f32_16x16x32_bf16 v[224:227], a[96:99], v[60:63], v[224:227]
    v_cvt_pk_bf16_f32 v51, v22, v23
    v_xor_b32 v3, s54, v7
    v_mfma_f32_16x16x32_bf16 v[196:199], a[100:103], v[56:59], v[196:199]
    s_add_u32 s54, s54, 0x8000
    v_exp_f32 v25, v25
    v_mfma_f32_16x16x32_bf16 v[228:231], a[100:103], v[60:63], v[228:231]
    s_and_b32 s54, s54, 0x1ffff
    v_cvt_pk_bf16_f32 v52, v24, v25
    ds_read_b128 a[64:67], v3 offset:0
    v_mfma_f32_16x16x32_bf16 v[200:203], a[104:107], v[56:59], v[200:203]
    s_add_u32 m0, s54, s55
    v_exp_f32 v26, v26
    v_mfma_f32_16x16x32_bf16 v[232:235], a[104:107], v[60:63], v[232:235]
    s_add_u32 s44, s44, 1024
    ds_read_b128 a[68:71], v3 offset:1024
    ds_read_b128 a[72:75], v3 offset:2048
    v_mfma_f32_16x16x32_bf16 v[204:207], a[108:111], v[56:59], v[204:207]
    v_exp_f32 v27, v27
    v_mfma_f32_16x16x32_bf16 v[236:239], a[108:111], v[60:63], v[236:239]
    v_cvt_pk_bf16_f32 v53, v26, v27
    v_add_u32 v4, s81, v2
    v_mfma_f32_16x16x32_bf16 v[208:211], a[112:115], v[56:59], v[208:211]
    v_exp_f32 v28, v28
    v_mfma_f32_16x16x32_bf16 v[240:243], a[112:115], v[60:63], v[240:243]
    buffer_load_dwordx4 v4, s[28:31], 0 offen offset:0 sc1 lds
    v_mfma_f32_16x16x32_bf16 v[212:215], a[116:119], v[56:59], v[212:215]
    v_exp_f32 v29, v29
    v_mfma_f32_16x16x32_bf16 v[244:247], a[116:119], v[60:63], v[244:247]
    v_cvt_pk_bf16_f32 v54, v28, v29
    ds_read_b128 a[76:79], v3 offset:3072
    v_mfma_f32_16x16x32_bf16 v[216:219], a[120:123], v[56:59], v[216:219]
    v_exp_f32 v30, v30
    v_mfma_f32_16x16x32_bf16 v[248:251], a[120:123], v[60:63], v[248:251]
    ds_read_b128 a[80:83], v3 offset:4096
    ds_read_b128 a[84:87], v3 offset:5120
    v_mfma_f32_16x16x32_bf16 v[220:223], a[124:127], v[56:59], v[220:223]
    v_exp_f32 v31, v31
    v_mfma_f32_16x16x32_bf16 v[252:255], a[124:127], v[60:63], v[252:255]
    v_cvt_pk_bf16_f32 v55, v30, v31
    ds_read_b128 a[88:91], v3 offset:6144
    v_mfma_f32_16x16x32_bf16 a[136:139], a[144:147], v[56:59], a[136:139]
    ds_read_b128 a[92:95], v3 offset:7168
    ds_read_b128 a[96:99], v3 offset:16384
    v_mfma_f32_16x16x32_bf16 a[140:143], a[144:147], v[60:63], a[140:143]
    s_waitcnt lgkmcnt(7)
    buffer_load_dwordx4 v4, s[28:31], 0 offen offset:1024 sc1 lds
    v_mfma_f32_16x16x32_bf16 v[16:19], a[64:67], a[0:3], v[64:67]
    v_exp_f32 v32, v32
    v_mfma_f32_16x16x32_bf16 v[20:23], a[68:71], a[0:3], v[64:67]
    ds_read_b128 a[100:103], v3 offset:17408
    ds_read_b128 a[104:107], v3 offset:18432
    v_mfma_f32_16x16x32_bf16 v[24:27], a[64:67], a[8:11], v[68:71]
    v_exp_f32 v33, v33
    v_mfma_f32_16x16x32_bf16 v[28:31], a[68:71], a[8:11], v[68:71]
    s_waitcnt lgkmcnt(7)
    v_cvt_pk_bf16_f32 v56, v32, v33
    ds_read_b128 a[108:111], v3 offset:19456
    v_mfma_f32_16x16x32_bf16 v[16:19], a[72:75], a[4:7], v[16:19]
    v_exp_f32 v34, v34
    v_mfma_f32_16x16x32_bf16 v[20:23], a[76:79], a[4:7], v[20:23]
    buffer_load_dwordx4 v4, s[28:31], 0 offen offset:2048 sc1 lds
    v_mfma_f32_16x16x32_bf16 v[24:27], a[72:75], a[12:15], v[24:27]
    v_exp_f32 v35, v35
    v_mfma_f32_16x16x32_bf16 v[28:31], a[76:79], a[12:15], v[28:31]
    s_waitcnt lgkmcnt(6)
    v_cvt_pk_bf16_f32 v57, v34, v35
    ds_read_b128 a[112:115], v3 offset:20480
    v_mfma_f32_16x16x32_bf16 v[16:19], a[80:83], a[32:35], v[16:19]
    v_exp_f32 v36, v36
    v_mfma_f32_16x16x32_bf16 v[20:23], a[84:87], a[32:35], v[20:23]
    ds_read_b128 a[116:119], v3 offset:21504
    ds_read_b128 a[120:123], v3 offset:22528
    v_mfma_f32_16x16x32_bf16 v[24:27], a[80:83], a[40:43], v[24:27]
    v_exp_f32 v37, v37
    v_mfma_f32_16x16x32_bf16 v[28:31], a[84:87], a[40:43], v[28:31]
    s_waitcnt lgkmcnt(7)
    v_cvt_pk_bf16_f32 v58, v36, v37
    ds_read_b128 a[124:127], v3 offset:23552
    v_mfma_f32_16x16x32_bf16 v[16:19], a[88:91], a[36:39], v[16:19]
    v_exp_f32 v38, v38
    v_mfma_f32_16x16x32_bf16 v[20:23], a[92:95], a[36:39], v[20:23]
    buffer_load_dwordx4 v4, s[28:31], 0 offen offset:3072 sc1 lds
    v_mfma_f32_16x16x32_bf16 v[24:27], a[88:91], a[44:47], v[24:27]
    v_exp_f32 v39, v39
    v_mfma_f32_16x16x32_bf16 v[28:31], a[92:95], a[44:47], v[28:31]
    s_waitcnt lgkmcnt(6)
    v_cvt_pk_bf16_f32 v59, v38, v39
    v_mfma_f32_16x16x32_bf16 v[128:131], a[96:99], v[48:51], v[128:131]
    s_add_u32 m0, m0, 0x1000
    v_exp_f32 v40, v40
    v_mfma_f32_16x16x32_bf16 v[160:163], a[96:99], v[52:55], v[160:163]
    v_mfma_f32_16x16x32_bf16 v[132:135], a[100:103], v[48:51], v[132:135]
    v_exp_f32 v41, v41
    v_mfma_f32_16x16x32_bf16 v[164:167], a[100:103], v[52:55], v[164:167]
    s_waitcnt lgkmcnt(4)
    v_cvt_pk_bf16_f32 v60, v40, v41
    v_mfma_f32_16x16x32_bf16 v[136:139], a[104:107], v[48:51], v[136:139]
    v_exp_f32 v42, v42
    v_mfma_f32_16x16x32_bf16 v[168:171], a[104:107], v[52:55], v[168:171]
    buffer_load_dwordx4 v4, s[28:31], s76 offen offset:0 sc1 lds
    v_mfma_f32_16x16x32_bf16 v[140:143], a[108:111], v[48:51], v[140:143]
    v_exp_f32 v43, v43
    v_mfma_f32_16x16x32_bf16 v[172:175], a[108:111], v[52:55], v[172:175]
    s_waitcnt lgkmcnt(2)
    v_cvt_pk_bf16_f32 v61, v42, v43
    v_mfma_f32_16x16x32_bf16 v[144:147], a[112:115], v[48:51], v[144:147]
    v_exp_f32 v44, v44
    v_mfma_f32_16x16x32_bf16 v[176:179], a[112:115], v[52:55], v[176:179]
    v_mfma_f32_16x16x32_bf16 v[148:151], a[116:119], v[48:51], v[148:151]
    v_exp_f32 v45, v45
    v_mfma_f32_16x16x32_bf16 v[180:183], a[116:119], v[52:55], v[180:183]
    s_waitcnt lgkmcnt(0)
    v_cvt_pk_bf16_f32 v62, v44, v45
    v_mfma_f32_16x16x32_bf16 v[152:155], a[120:123], v[48:51], v[152:155]
    v_exp_f32 v46, v46
    v_mfma_f32_16x16x32_bf16 v[184:187], a[120:123], v[52:55], v[184:187]
    buffer_load_dwordx4 v4, s[28:31], s76 offen offset:1024 sc1 lds
    v_mfma_f32_16x16x32_bf16 v[156:159], a[124:127], v[48:51], v[156:159]
    v_exp_f32 v47, v47
    v_mfma_f32_16x16x32_bf16 v[188:191], a[124:127], v[52:55], v[188:191]
    v_cvt_pk_bf16_f32 v63, v46, v47
    v_mfma_f32_16x16x32_bf16 a[128:131], a[144:147], v[48:51], a[128:131]
    v_mfma_f32_16x16x32_bf16 a[132:135], a[144:147], v[52:55], a[132:135]
    v_mfma_f32_16x16x32_bf16 v[32:35], a[64:67], a[16:19], v[72:75]
    v_exp_f32 v16, v16
    v_mfma_f32_16x16x32_bf16 v[36:39], a[68:71], a[16:19], v[72:75]
    buffer_load_dwordx4 v4, s[28:31], s76 offen offset:2048 sc1 lds
    v_mfma_f32_16x16x32_bf16 v[40:43], a[64:67], a[24:27], v[76:79]
    v_exp_f32 v17, v17
    v_mfma_f32_16x16x32_bf16 v[44:47], a[68:71], a[24:27], v[76:79]
    v_cvt_pk_bf16_f32 v48, v16, v17
    v_mfma_f32_16x16x32_bf16 v[32:35], a[72:75], a[20:23], v[32:35]
    v_exp_f32 v18, v18
    v_mfma_f32_16x16x32_bf16 v[36:39], a[76:79], a[20:23], v[36:39]
    v_mfma_f32_16x16x32_bf16 v[40:43], a[72:75], a[28:31], v[40:43]
    v_exp_f32 v19, v19
    v_mfma_f32_16x16x32_bf16 v[44:47], a[76:79], a[28:31], v[44:47]
    buffer_load_dwordx4 v4, s[28:31], s76 offen offset:3072 sc1 lds
    v_mfma_f32_16x16x32_bf16 v[32:35], a[80:83], a[48:51], v[32:35]
    v_exp_f32 v20, v20
    v_mfma_f32_16x16x32_bf16 v[36:39], a[84:87], a[48:51], v[36:39]
    buffer_store_dwordx4 v[96:99], v2, s[28:31], s44 offen sc1
    v_mfma_f32_16x16x32_bf16 v[40:43], a[80:83], a[56:59], v[40:43]
    s_add_u32 s52, s52, 1
    v_exp_f32 v21, v21
    v_mfma_f32_16x16x32_bf16 v[44:47], a[84:87], a[56:59], v[44:47]
    v_cvt_pk_bf16_f32 v49, v18, v19
    v_cvt_pk_bf16_f32 v50, v20, v21
    v_mfma_f32_16x16x32_bf16 v[32:35], a[88:91], a[52:55], v[32:35]
    v_exp_f32 v22, v22
    v_mfma_f32_16x16x32_bf16 v[36:39], a[92:95], a[52:55], v[36:39]
    s_cmp_lg_u32 s52, s53
    v_readlane_b32 s81, v5, s52
    v_mfma_f32_16x16x32_bf16 v[40:43], a[88:91], a[60:63], v[40:43]
    s_waitcnt vmcnt(19) lgkmcnt(0)
    v_exp_f32 v23, v23
    v_mfma_f32_16x16x32_bf16 v[44:47], a[92:95], a[60:63], v[44:47]
    s_cbranch_scc1 dd_loop
    s_cmp_lg_u32 s5, 7
    s_cbranch_scc1 dd_done
    v_mov_b32 v89, 4
    s_mov_b64 exec, 1
    buffer_store_dword v89, off, s[28:31], s26 sc1
    s_mov_b64 exec, -1
dd_done:
    s_cmp_eq_u32 s6, 0
    s_cbranch_scc1 ds_win
    v_mfma_f32_16x16x32_bf16 v[192:195], a[96:99], v[56:59], v[192:195]
    s_barrier
    v_exp_f32 v24, v24
    v_mfma_f32_16x16x32_bf16 v[224:227], a[96:99], v[60:63], v[224:227]
    v_cvt_pk_bf16_f32 v51, v22, v23
    v_xor_b32 v3, s54, v7
    v_mfma_f32_16x16x32_bf16 v[196:199], a[100:103], v[56:59], v[196:199]
    s_add_u32 s54, s54, 0x8000
    v_exp_f32 v25, v25
    v_mfma_f32_16x16x32_bf16 v[228:231], a[100:103], v[60:63], v[228:231]
    s_and_b32 s54, s54, 0x1ffff
    v_cvt_pk_bf16_f32 v52, v24, v25
    ds_read_b128 a[64:67], v3 offset:0
    v_mfma_f32_16x16x32_bf16 v[200:203], a[104:107], v[56:59], v[200:203]
    s_add_u32 m0, s54, s55
    v_exp_f32 v26, v26
    v_mfma_f32_16x16x32_bf16 v[232:235], a[104:107], v[60:63], v[232:235]
    s_add_u32 s44, s44, 1024
    ds_read_b128 a[68:71], v3 offset:1024
    ds_read_b128 a[72:75], v3 offset:2048
    v_mfma_f32_16x16x32_bf16 v[204:207], a[108:111], v[56:59], v[204:207]
    v_exp_f32 v27, v27
    v_mfma_f32_16x16x32_bf16 v[236:239], a[108:111], v[60:63], v[236:239]
    v_cvt_pk_bf16_f32 v53, v26, v27
    v_add_u32 v4, s81, v2
    v_mfma_f32_16x16x32_bf16 v[208:211], a[112:115], v[56:59], v[208:211]
    v_exp_f32 v28, v28
    v_mfma_f32_16x16x32_bf16 v[240:243], a[112:115], v[60:63], v[240:243]
    buffer_load_dwordx4 v4, s[28:31], 0 offen offset:0 sc1 lds
    v_mfma_f32_16x16x32_bf16 v[212:215], a[116:119], v[56:59], v[212:215]
    v_exp_f32 v29, v29
    v_mfma_f32_16x16x32_bf16 v[244:247], a[116:119], v[60:63], v[244:247]
    v_cvt_pk_bf16_f32 v54, v28, v29
    ds_read_b128 a[76:79], v3 offset:3072
    v_mfma_f32_16x16x32_bf16 v[216:219], a[120:123], v[56:59], v[216:219]
    v_exp_f32 v30, v30
    v_mfma_f32_16x16x32_bf16 v[248:251], a[120:123], v[60:63], v[248:251]
    ds_read_b128 a[80:83], v3 offset:4096
    ds_read_b128 a[84:87], v3 offset:5120
    v_mfma_f32_16x16x32_bf16 v[220:223], a[124:127], v[56:59], v[220:223]
    v_exp_f32 v31, v31
    v_mfma_f32_16x16x32_bf16 v[252:255], a[124:127], v[60:63], v[252:255]
    v_cvt_pk_bf16_f32 v55, v30, v31
    ds_read_b128 a[88:91], v3 offset:6144
    v_mfma_f32_16x16x32_bf16 a[136:139], a[144:147], v[56:59], a[136:139]
    ds_read_b128 a[92:95], v3 offset:7168
    ds_read_b128 a[96:99], v3 offset:16384
    v_mfma_f32_16x16x32_bf16 a[140:143], a[144:147], v[60:63], a[140:143]
    s_waitcnt lgkmcnt(7)
    buffer_load_dwordx4 v4, s[28:31], 0 offen offset:1024 sc1 lds
    v_mfma_f32_16x16x32_bf16 v[16:19], a[64:67], a[0:3], v[64:67]
    v_exp_f32 v32, v32
    v_mfma_f32_16x16x32_bf16 v[20:23], a[68:71], a[0:3], v[64:67]
    ds_read_b128 a[100:103], v3 offset:17408
    ds_read_b128 a[104:107], v3 offset:18432
    v_mfma_f32_16x16x32_bf16 v[24:27], a[64:67], a[8:11], v[68:71]
    v_exp_f32 v33, v33
    v_mfma_f32_16x16x32_bf16 v[28:31], a[68:71], a[8:11], v[68:71]
    s_waitcnt lgkmcnt(7)
    v_cvt_pk_bf16_f32 v56, v32, v33
    ds_read_b128 a[108:111], v3 offset:19456
    v_mfma_f32_16x16x32_bf16 v[16:19], a[72:75], a[4:7], v[16:19]
    v_exp_f32 v34, v34
    v_mfma_f32_16x16x32_bf16 v[20:23], a[76:79], a[4:7], v[20:23]
    buffer_load_dwordx4 v4, s[28:31], 0 offen offset:2048 sc1 lds
    v_mfma_f32_16x16x32_bf16 v[24:27], a[72:75], a[12:15], v[24:27]
    v_exp_f32 v35, v35
    v_mfma_f32_16x16x32_bf16 v[28:31], a[76:79], a[12:15], v[28:31]
    s_waitcnt lgkmcnt(6)
    v_cvt_pk_bf16_f32 v57, v34, v35
    ds_read_b128 a[112:115], v3 offset:20480
    v_mfma_f32_16x16x32_bf16 v[16:19], a[80:83], a[32:35], v[16:19]
    v_exp_f32 v36, v36
    v_mfma_f32_16x16x32_bf16 v[20:23], a[84:87], a[32:35], v[20:23]
    ds_read_b128 a[116:119], v3 offset:21504
    ds_read_b128 a[120:123], v3 offset:22528
    v_mfma_f32_16x16x32_bf16 v[24:27], a[80:83], a[40:43], v[24:27]
    v_exp_f32 v37, v37
    v_mfma_f32_16x16x32_bf16 v[28:31], a[84:87], a[40:43], v[28:31]
    s_waitcnt lgkmcnt(7)
    v_cvt_pk_bf16_f32 v58, v36, v37
    ds_read_b128 a[124:127], v3 offset:23552
    v_mfma_f32_16x16x32_bf16 v[16:19], a[88:91], a[36:39], v[16:19]
    v_exp_f32 v38, v38
    v_mfma_f32_16x16x32_bf16 v[20:23], a[92:95], a[36:39], v[20:23]
    buffer_load_dwordx4 v4, s[28:31], 0 offen offset:3072 sc1 lds
    v_mfma_f32_16x16x32_bf16 v[24:27], a[88:91], a[44:47], v[24:27]
    v_exp_f32 v39, v39
    v_mfma_f32_16x16x32_bf16 v[28:31], a[92:95], a[44:47], v[28:31]
    s_waitcnt lgkmcnt(6)
    v_cvt_pk_bf16_f32 v59, v38, v39
    v_mfma_f32_16x16x32_bf16 v[128:131], a[96:99], v[48:51], v[128:131]
    s_add_u32 m0, m0, 0x1000
    v_exp_f32 v40, v40
    v_mfma_f32_16x16x32_bf16 v[160:163], a[96:99], v[52:55], v[160:163]
    v_cndmask_b32 v16, v16, v6, s[64:65]
    v_cndmask_b32 v17, v17, v6, s[66:67]
    v_mfma_f32_16x16x32_bf16 v[132:135], a[100:103], v[48:51], v[132:135]
    v_exp_f32 v41, v41
    v_mfma_f32_16x16x32_bf16 v[164:167], a[100:103], v[52:55], v[164:167]
    s_waitcnt lgkmcnt(4)
    v_cvt_pk_bf16_f32 v60, v40, v41
    v_cndmask_b32 v18, v18, v6, s[68:69]
    v_mfma_f32_16x16x32_bf16 v[136:139], a[104:107], v[48:51], v[136:139]
    v_exp_f32 v42, v42
    v_mfma_f32_16x16x32_bf16 v[168:171], a[104:107], v[52:55], v[168:171]
    buffer_load_dwordx4 v4, s[28:31], s76 offen offset:0 sc1 lds
    v_mfma_f32_16x16x32_bf16 v[140:143], a[108:111], v[48:51], v[140:143]
    v_exp_f32 v43, v43
    v_mfma_f32_16x16x32_bf16 v[172:175], a[108:111], v[52:55], v[172:175]
    s_waitcnt lgkmcnt(2)
    v_cvt_pk_bf16_f32 v61, v42, v43
    v_cndmask_b32 v19, v19, v6, s[70:71]
    v_mfma_f32_16x16x32_bf16 v[144:147], a[112:115], v[48:51], v[144:147]
    v_exp_f32 v44, v44
    v_mfma_f32_16x16x32_bf16 v[176:179], a[112:115], v[52:55], v[176:179]
    v_mov_b32 v20, v6
    v_mov_b32 v21, v6
    v_mfma_f32_16x16x32_bf16 v[148:151], a[116:119], v[48:51], v[148:151]
    v_exp_f32 v45, v45
    v_mfma_f32_16x16x32_bf16 v[180:183], a[116:119], v[52:55], v[180:183]
    s_waitcnt lgkmcnt(0)
    v_cvt_pk_bf16_f32 v62, v44, v45
    v_mov_b32 v22, v6
    v_mfma_f32_16x16x32_bf16 v[152:155], a[120:123], v[48:51], v[152:155]
    v_exp_f32 v46, v46
    v_mfma_f32_16x16x32_bf16 v[184:187], a[120:123], v[52:55], v[184:187]
    buffer_load_dwordx4 v4, s[28:31], s76 offen offset:1024 sc1 lds
    v_mfma_f32_16x16x32_bf16 v[156:159], a[124:127], v[48:51], v[156:159]
    v_exp_f32 v47, v47
    v_mfma_f32_16x16x32_bf16 v[188:191], a[124:127], v[52:55], v[188:191]
    v_cvt_pk_bf16_f32 v63, v46, v47
    v_mov_b32 v23, v6
    v_mfma_f32_16x16x32_bf16 a[128:131], a[144:147], v[48:51], a[128:131]
    v_cndmask_b32 v28, v28, v6, s[64:65]
    v_cndmask_b32 v29, v29, v6, s[66:67]
    v_mfma_f32_16x16x32_bf16 a[132:135], a[144:147], v[52:55], a[132:135]
    v_cndmask_b32 v30, v30, v6, s[68:69]
    v_cndmask_b32 v31, v31, v6, s[70:71]
    v_mfma_f32_16x16x32_bf16 v[32:35], a[64:67], a[16:19], v[72:75]
    v_exp_f32 v16, v16
    v_mfma_f32_16x16x32_bf16 v[36:39], a[68:71], a[16:19], v[72:75]
    buffer_load_dwordx4 v4, s[28:31], s76 offen offset:2048 sc1 lds
    v_mfma_f32_16x16x32_bf16 v[40:43], a[64:67], a[24:27], v[76:79]
    v_exp_f32 v17, v17
    v_mfma_f32_16x16x32_bf16 v[44:47], a[68:71], a[24:27], v[76:79]
    v_cvt_pk_bf16_f32 v48, v16, v17
    v_mfma_f32_16x16x32_bf16 v[32:35], a[72:75], a[20:23], v[32:35]
    v_exp_f32 v18, v18
    v_mfma_f32_16x16x32_bf16 v[36:39], a[76:79], a[20:23], v[36:39]
    v_mfma_f32_16x16x32_bf16 v[40:43], a[72:75], a[28:31], v[40:43]
    v_exp_f32 v19, v19
    v_mfma_f32_16x16x32_bf16 v[44:47], a[76:79], a[28:31], v[44:47]
    buffer_load_dwordx4 v4, s[28:31], s76 offen offset:3072 sc1 lds
    v_mfma_f32_16x16x32_bf16 v[32:35], a[80:83], a[48:51], v[32:35]
    v_exp_f32 v20, v20
    v_mfma_f32_16x16x32_bf16 v[36:39], a[84:87], a[48:51], v[36:39]
    buffer_store_dwordx4 v[96:99], v2, s[28:31], s44 offen sc1
    v_mfma_f32_16x16x32_bf16 v[40:43], a[80:83], a[56:59], v[40:43]
    s_add_u32 s52, s52, 1
    v_exp_f32 v21, v21
    v_mfma_f32_16x16x32_bf16 v[44:47], a[84:87], a[56:59], v[44:47]
    v_cvt_pk_bf16_f32 v49, v18, v19
    v_cvt_pk_bf16_f32 v50, v20, v21
    v_mfma_f32_16x16x32_bf16 v[32:35], a[88:91], a[52:55], v[32:35]
    v_exp_f32 v22, v22
    v_mfma_f32_16x16x32_bf16 v[36:39], a[92:95], a[52:55], v[36:39]
    s_cmp_eq_u32 s52, 35
    v_readlane_b32 s81, v5, s52
    v_mfma_f32_16x16x32_bf16 v[40:43], a[88:91], a[60:63], v[40:43]
    s_waitcnt vmcnt(19) lgkmcnt(0)
    v_exp_f32 v23, v23
    v_mfma_f32_16x16x32_bf16 v[44:47], a[92:95], a[60:63], v[44:47]
    s_cbranch_scc1 fin_d
ds_win:
    v_mfma_f32_16x16x32_bf16 v[192:195], a[96:99], v[56:59], v[192:195]
    s_barrier
    v_exp_f32 v24, v24
    v_mfma_f32_16x16x32_bf16 v[224:227], a[96:99], v[60:63], v[224:227]
    v_cvt_pk_bf16_f32 v51, v22, v23
    v_xor_b32 v3, s54, v7
    v_mfma_f32_16x16x32_bf16 v[196:199], a[100:103], v[56:59], v[196:199]
    s_add_u32 s54, s54, 0x8000
    v_exp_f32 v25, v25
    v_mfma_f32_16x16x32_bf16 v[228:231], a[100:103], v[60:63], v[228:231]
    s_and_b32 s54, s54, 0x1ffff
    v_cvt_pk_bf16_f32 v52, v24, v25
    ds_read_b128 a[64:67], v3 offset:0
    v_mfma_f32_16x16x32_bf16 v[200:203], a[104:107], v[56:59], v[200:203]
    s_add_u32 m0, s54, s55
    v_exp_f32 v26, v26
    v_mfma_f32_16x16x32_bf16 v[232:235], a[104:107], v[60:63], v[232:235]
    s_add_u32 s44, s44, 1024
    ds_read_b128 a[68:71], v3 offset:1024
    ds_read_b128 a[72:75], v3 offset:2048
    v_mfma_f32_16x16x32_bf16 v[204:207], a[108:111], v[56:59], v[204:207]
    v_exp_f32 v27, v27
    v_mfma_f32_16x16x32_bf16 v[236:239], a[108:111], v[60:63], v[236:239]
    v_cvt_pk_bf16_f32 v53, v26, v27
    v_add_u32 v4, s81, v2
    v_mfma_f32_16x16x32_bf16 v[208:211], a[112:115], v[56:59], v[208:211]
    v_exp_f32 v28, v28
    v_mfma_f32_16x16x32_bf16 v[240:243], a[112:115], v[60:63], v[240:243]
    buffer_load_dwordx4 v4, s[28:31], 0 offen offset:0 sc1 lds
    v_mfma_f32_16x16x32_bf16 v[212:215], a[116:119], v[56:59], v[212:215]
    v_exp_f32 v29, v29
    v_mfma_f32_16x16x32_bf16 v[244:247], a[116:119], v[60:63], v[244:247]
    v_cvt_pk_bf16_f32 v54, v28, v29
    ds_read_b128 a[76:79], v3 offset:3072
    v_mfma_f32_16x16x32_bf16 v[216:219], a[120:123], v[56:59], v[216:219]
    v_exp_f32 v30, v30
    v_mfma_f32_16x16x32_bf16 v[248:251], a[120:123], v[60:63], v[248:251]
    ds_read_b128 a[80:83], v3 offset:4096
    ds_read_b128 a[84:87], v3 offset:5120
    v_mfma_f32_16x16x32_bf16 v[220:223], a[124:127], v[56:59], v[220:223]
    v_exp_f32 v31, v31
    v_mfma_f32_16x16x32_bf16 v[252:255], a[124:127], v[60:63], v[252:255]
    v_cvt_pk_bf16_f32 v55, v30, v31
    ds_read_b128 a[88:91], v3 offset:6144
    v_mfma_f32_16x16x32_bf16 a[136:139], a[144:147], v[56:59], a[136:139]
    ds_read_b128 a[92:95], v3 offset:7168
    ds_read_b128 a[96:99], v3 offset:16384
    v_mfma_f32_16x16x32_bf16 a[140:143], a[144:147], v[60:63], a[140:143]
    s_waitcnt lgkmcnt(7)
    buffer_load_dwordx4 v4, s[28:31], 0 offen offset:1024 sc1 lds
    v_mfma_f32_16x16x32_bf16 v[16:19], a[64:67], a[16:19], v[72:75]
    v_exp_f32 v32, v32
    v_mfma_f32_16x16x32_bf16 v[20:23], a[68:71], a[16:19], v[72:75]
    ds_read_b128 a[100:103], v3 offset:17408
    ds_read_b128 a[104:107], v3 offset:18432
    v_mfma_f32_16x16x32_bf16 v[24:27], a[64:67], a[24:27], v[76:79]
    v_exp_f32 v33, v33
    v_mfma_f32_16x16x32_bf16 v[28:31], a[68:71], a[24:27], v[76:79]
    s_waitcnt lgkmcnt(7)
    v_cvt_pk_bf16_f32 v56, v32, v33
    ds_read_b128 a[108:111], v3 offset:19456
    v_mfma_f32_16x16x32_bf16 v[16:19], a[72:75], a[20:23], v[16:19]
    v_exp_f32 v34, v34
    v_mfma_f32_16x16x32_bf16 v[20:23], a[76:79], a[20:23], v[20:23]
    buffer_load_dwordx4 v4, s[28:31], 0 offen offset:2048 sc1 lds
    v_mfma_f32_16x16x32_bf16 v[24:27], a[72:75], a[28:31], v[24:27]
    v_exp_f32 v35, v35
    v_mfma_f32_16x16x32_bf16 v[28:31], a[76:79], a[28:31], v[28:31]
    s_waitcnt lgkmcnt(6)
    v_cvt_pk_bf16_f32 v57, v34, v35
    ds_read_b128 a[112:115], v3 offset:20480
    v_mfma_f32_16x16x32_bf16 v[16:19], a[80:83], a[48:51], v[16:19]
    v_exp_f32 v36, v36
    v_mfma_f32_16x16x32_bf16 v[20:23], a[84:87], a[48:51], v[20:23]
    ds_read_b128 a[116:119], v3 offset:21504
    ds_read_b128 a[120:123], v3 offset:22528
    v_mfma_f32_16x16x32_bf16 v[24:27], a[80:83], a[56:59], v[24:27]
    v_exp_f32 v37, v37
    v_mfma_f32_16x16x32_bf16 v[28:31], a[84:87], a[56:59], v[28:31]
    s_waitcnt lgkmcnt(7)
    v_cvt_pk_bf16_f32 v58, v36, v37
    ds_read_b128 a[124:127], v3 offset:23552
    v_mfma_f32_16x16x32_bf16 v[16:19], a[88:91], a[52:55], v[16:19]
    v_exp_f32 v38, v38
    v_mfma_f32_16x16x32_bf16 v[20:23], a[92:95], a[52:55], v[20:23]
    buffer_load_dwordx4 v4, s[28:31], 0 offen offset:3072 sc1 lds
    v_mfma_f32_16x16x32_bf16 v[24:27], a[88:91], a[60:63], v[24:27]
    v_exp_f32 v39, v39
    v_mfma_f32_16x16x32_bf16 v[28:31], a[92:95], a[60:63], v[28:31]
    s_waitcnt lgkmcnt(6)
    v_cvt_pk_bf16_f32 v59, v38, v39
    ds_read_b128 a[64:67], v3 offset:8192
    v_mfma_f32_16x16x32_bf16 v[128:131], a[96:99], v[48:51], v[128:131]
    s_add_u32 m0, m0, 0x1000
    v_exp_f32 v40, v40
    v_mfma_f32_16x16x32_bf16 v[160:163], a[96:99], v[52:55], v[160:163]
    ds_read_b128 a[68:71], v3 offset:9216
    ds_read_b128 a[72:75], v3 offset:10240
    v_mfma_f32_16x16x32_bf16 v[132:135], a[100:103], v[48:51], v[132:135]
    v_exp_f32 v41, v41
    v_mfma_f32_16x16x32_bf16 v[164:167], a[100:103], v[52:55], v[164:167]
    s_waitcnt lgkmcnt(7)
    v_cvt_pk_bf16_f32 v60, v40, v41
    ds_read_b128 a[76:79], v3 offset:11264
    v_mfma_f32_16x16x32_bf16 v[136:139], a[104:107], v[48:51], v[136:139]
    v_exp_f32 v42, v42
    v_mfma_f32_16x16x32_bf16 v[168:171], a[104:107], v[52:55], v[168:171]
    buffer_load_dwordx4 v4, s[28:31], s76 offen offset:0 sc1 lds
    v_mfma_f32_16x16x32_bf16 v[140:143], a[108:111], v[48:51], v[140:143]
    v_exp_f32 v43, v43
    v_mfma_f32_16x16x32_bf16 v[172:175], a[108:111], v[52:55], v[172:175]
    s_waitcnt lgkmcnt(6)
    v_cvt_pk_bf16_f32 v61, v42, v43
    ds_read_b128 a[80:83], v3 offset:12288
    v_mfma_f32_16x16x32_bf16 v[144:147], a[112:115], v[48:51], v[144:147]
    v_exp_f32 v44, v44
    v_mfma_f32_16x16x32_bf16 v[176:179], a[112:115], v[52:55], v[176:179]
    ds_read_b128 a[84:87], v3 offset:13312
    ds_read_b128 a[88:91], v3 offset:14336
    v_mfma_f32_16x16x32_bf16 v[148:151], a[116:119], v[48:51], v[148:151]
    v_exp_f32 v45, v45
    v_mfma_f32_16x16x32_bf16 v[180:183], a[116:119], v[52:55], v[180:183]
    s_waitcnt lgkmcnt(7)
    v_cvt_pk_bf16_f32 v62, v44, v45
    ds_read_b128 a[92:95], v3 offset:15360
    v_mfma_f32_16x16x32_bf16 v[152:155], a[120:123], v[48:51], v[152:155]
    v_exp_f32 v46, v46
    v_mfma_f32_16x16x32_bf16 v[184:187], a[120:123], v[52:55], v[184:187]
    buffer_load_dwordx4 v4, s[28:31], s76 offen offset:1024 sc1 lds
    v_mfma_f32_16x16x32_bf16 v[156:159], a[124:127], v[48:51], v[156:159]
    v_exp_f32 v47, v47
    v_mfma_f32_16x16x32_bf16 v[188:191], a[124:127], v[52:55], v[188:191]
    v_cvt_pk_bf16_f32 v63, v46, v47
    v_mfma_f32_16x16x32_bf16 a[128:131], a[144:147], v[48:51], a[128:131]
    v_mfma_f32_16x16x32_bf16 a[132:135], a[144:147], v[52:55], a[132:135]
    s_waitcnt lgkmcnt(6)
    v_mfma_f32_16x16x32_bf16 v[32:35], a[64:67], a[16:19], v[72:75]
    v_exp_f32 v16, v16
    v_mfma_f32_16x16x32_bf16 v[36:39], a[68:71], a[16:19], v[72:75]
    buffer_load_dwordx4 v4, s[28:31], s76 offen offset:2048 sc1 lds
    v_mfma_f32_16x16x32_bf16 v[40:43], a[64:67], a[24:27], v[76:79]
    v_exp_f32 v17, v17
    v_mfma_f32_16x16x32_bf16 v[44:47], a[68:71], a[24:27], v[76:79]
    s_waitcnt lgkmcnt(4)
    v_cvt_pk_bf16_f32 v48, v16, v17
    v_mfma_f32_16x16x32_bf16 v[32:35], a[72:75], a[20:23], v[32:35]
    v_exp_f32 v18, v18
    v_mfma_f32_16x16x32_bf16 v[36:39], a[76:79], a[20:23], v[36:39]
    v_mfma_f32_16x16x32_bf16 v[40:43], a[72:75], a[28:31], v[40:43]
    v_exp_f32 v19, v19
    v_mfma_f32_16x16x32_bf16 v[44:47], a[76:79], a[28:31], v[44:47]
    s_waitcnt lgkmcnt(2)
    buffer_load_dwordx4 v4, s[28:31], s76 offen offset:3072 sc1 lds
    v_mfma_f32_16x16x32_bf16 v[32:35], a[80:83], a[48:51], v[32:35]
    v_exp_f32 v20, v20
    v_mfma_f32_16x16x32_bf16 v[36:39], a[84:87], a[48:51], v[36:39]
    s_lshl_b32 s53, s5, 2
    buffer_store_dwordx4 v[96:99], v2, s[28:31], s44 offen sc1
    v_mfma_f32_16x16x32_bf16 v[40:43], a[80:83], a[56:59], v[40:43]
    s_add_u32 s52, s52, 1
    v_exp_f32 v21, v21
    v_mfma_f32_16x16x32_bf16 v[44:47], a[84:87], a[56:59], v[44:47]
    s_add_u32 s53, s53, 8
    s_waitcnt lgkmcnt(0)
    v_cvt_pk_bf16_f32 v49, v18, v19
    v_cvt_pk_bf16_f32 v50, v20, v21
    v_mfma_f32_16x16x32_bf16 v[32:35], a[88:91], a[52:55], v[32:35]
    s_min_u32 s53, s53, 35
    v_exp_f32 v22, v22
    v_mfma_f32_16x16x32_bf16 v[36:39], a[92:95], a[52:55], v[36:39]
    s_cmp_eq_u32 s3, 3
    v_readlane_b32 s81, v5, s52
    v_mfma_f32_16x16x32_bf16 v[40:43], a[88:91], a[60:63], v[40:43]
    s_waitcnt vmcnt(19) lgkmcnt(0)
    v_exp_f32 v23, v23
    v_mfma_f32_16x16x32_bf16 v[44:47], a[92:95], a[60:63], v[44:47]
    s_cbranch_scc1 ss_chk
    s_nop 6
    v_cndmask_b32 v32, v32, v6, s[64:65]
    v_cndmask_b32 v33, v33, v6, s[66:67]
    v_cndmask_b32 v34, v34, v6, s[68:69]
    v_cndmask_b32 v35, v35, v6, s[70:71]
    v_mov_b32 v36, v6
    v_mov_b32 v37, v6
    v_mov_b32 v38, v6
    v_mov_b32 v39, v6
    v_cndmask_b32 v44, v44, v6, s[64:65]
    v_cndmask_b32 v45, v45, v6, s[66:67]
    v_cndmask_b32 v46, v46, v6, s[68:69]
    v_cndmask_b32 v47, v47, v6, s[70:71]
ss_chk:
    s_cmp_lg_u32 s52, s53
    s_cbranch_scc1 ss_loop
    s_cmp_eq_u32 s53, 35
    s_cbranch_scc1 fin_s
    s_cmp_lg_u32 s78, 0
    s_cbranch_scc1 s_flag
    v_accvgpr_read_b32 v88, a128
    v_accvgpr_read_b32 v89, a132
    v_rcp_f32 v90, v88
    v_rcp_f32 v91, v89
    v_max_f32 v88, v88, v89
    v_cmp_nlt_f32 vcc, v88, s45
    s_nop 1
    v_cndmask_b32_e64 v90, v90, -1, vcc
    v_cndmask_b32_e64 v91, v91, -1, vcc
    v_pk_mul_f32 v[128:129], v[128:129], v[90:91] op_sel:[0,0] op_sel_hi:[1,0]
    v_pk_mul_f32 v[130:131], v[130:131], v[90:91] op_sel:[0,0] op_sel_hi:[1,0]
    v_pk_mul_f32 v[132:133], v[132:133], v[90:91] op_sel:[0,0] op_sel_hi:[1,0]
    v_pk_mul_f32 v[134:135], v[134:135], v[90:91] op_sel:[0,0] op_sel_hi:[1,0]
    v_cvt_pk_bf16_f32 v128, v128, v129
    v_cvt_pk_bf16_f32 v129, v130, v131
    v_cvt_pk_bf16_f32 v130, v132, v133
    v_cvt_pk_bf16_f32 v131, v134, v135
    s_or_b64 s[72:73], s[72:73], vcc
    buffer_store_dwordx4 v[128:131], v2, s[28:31], s79 offen offset:0 sc1
    v_pk_mul_f32 v[160:161], v[160:161], v[90:91] op_sel:[0,1] op_sel_hi:[1,1]
    v_pk_mul_f32 v[162:163], v[162:163], v[90:91] op_sel:[0,1] op_sel_hi:[1,1]
    v_pk_mul_f32 v[164:165], v[164:165], v[90:91] op_sel:[0,1] op_sel_hi:[1,1]
    v_pk_mul_f32 v[166:167], v[166:167], v[90:91] op_sel:[0,1] op_sel_hi:[1,1]
    v_cvt_pk_bf16_f32 v132, v160, v161
    v_cvt_pk_bf16_f32 v133, v162, v163
    v_cvt_pk_bf16_f32 v134, v164, v165
    v_cvt_pk_bf16_f32 v135, v166, v167
    buffer_store_dwordx4 v[132:135], v2, s[28:31], s79 offen offset:1024 sc1
    v_pk_mul_f32 v[136:137], v[136:137], v[90:91] op_sel:[0,0] op_sel_hi:[1,0]
    v_pk_mul_f32 v[138:139], v[138:139], v[90:91] op_sel:[0,0] op_sel_hi:[1,0]
    v_pk_mul_f32 v[140:141], v[140:141], v[90:91] op_sel:[0,0] op_sel_hi:[1,0]
    v_pk_mul_f32 v[142:143], v[142:143], v[90:91] op_sel:[0,0] op_sel_hi:[1,0]
    v_cvt_pk_bf16_f32 v136, v136, v137
    v_cvt_pk_bf16_f32 v137, v138, v139
    v_cvt_pk_bf16_f32 v138, v140, v141
    v_cvt_pk_bf16_f32 v139, v142, v143
    buffer_store_dwordx4 v[136:139], v2, s[28:31], s79 offen offset:2048 sc1
    v_pk_mul_f32 v[168:169], v[168:169], v[90:91] op_sel:[0,1] op_sel_hi:[1,1]
    v_pk_mul_f32 v[170:171], v[170:171], v[90:91] op_sel:[0,1] op_sel_hi:[1,1]
    v_pk_mul_f32 v[172:173], v[172:173], v[90:91] op_sel:[0,1] op_sel_hi:[1,1]
    v_pk_mul_f32 v[174:175], v[174:175], v[90:91] op_sel:[0,1] op_sel_hi:[1,1]
    v_cvt_pk_bf16_f32 v140, v168, v169
    v_cvt_pk_bf16_f32 v141, v170, v171
    v_cvt_pk_bf16_f32 v142, v172, v173
    v_cvt_pk_bf16_f32 v143, v174, v175
    buffer_store_dwordx4 v[140:143], v2, s[28:31], s79 offen offset:3072 sc1
    v_pk_mul_f32 v[144:145], v[144:145], v[90:91] op_sel:[0,0] op_sel_hi:[1,0]
    v_pk_mul_f32 v[146:147], v[146:147], v[90:91] op_sel:[0,0] op_sel_hi:[1,0]
    v_pk_mul_f32 v[148:149], v[148:149], v[90:91] op_sel:[0,0] op_sel_hi:[1,0]
    v_pk_mul_f32 v[150:151], v[150:151], v[90:91] op_sel:[0,0] op_sel_hi:[1,0]
    v_cvt_pk_bf16_f32 v144, v144, v145
    v_cvt_pk_bf16_f32 v145, v146, v147
    v_cvt_pk_bf16_f32 v146, v148, v149
    v_cvt_pk_bf16_f32 v147, v150, v151
    buffer_store_dwordx4 v[144:147], v12, s[28:31], s79 offen offset:0 sc1
    v_pk_mul_f32 v[176:177], v[176:177], v[90:91] op_sel:[0,1] op_sel_hi:[1,1]
    v_pk_mul_f32 v[178:179], v[178:179], v[90:91] op_sel:[0,1] op_sel_hi:[1,1]
    v_pk_mul_f32 v[180:181], v[180:181], v[90:91] op_sel:[0,1] op_sel_hi:[1,1]
    v_pk_mul_f32 v[182:183], v[182:183], v[90:91] op_sel:[0,1] op_sel_hi:[1,1]
    v_cvt_pk_bf16_f32 v148, v176, v177
    v_cvt_pk_bf16_f32 v149, v178, v179
    v_cvt_pk_bf16_f32 v150, v180, v181
    v_cvt_pk_bf16_f32 v151, v182, v183
    buffer_store_dwordx4 v[148:151], v12, s[28:31], s79 offen offset:1024 sc1
    v_pk_mul_f32 v[152:153], v[152:153], v[90:91] op_sel:[0,0] op_sel_hi:[1,0]
    v_pk_mul_f32 v[154:155], v[154:155], v[90:91] op_sel:[0,0] op_sel_hi:[1,0]
    v_pk_mul_f32 v[156:157], v[156:157], v[90:91] op_sel:[0,0] op_sel_hi:[1,0]
    v_pk_mul_f32 v[158:159], v[158:159], v[90:91] op_sel:[0,0] op_sel_hi:[1,0]
    v_cvt_pk_bf16_f32 v152, v152, v153
    v_cvt_pk_bf16_f32 v153, v154, v155
    v_cvt_pk_bf16_f32 v154, v156, v157
    v_cvt_pk_bf16_f32 v155, v158, v159
    buffer_store_dwordx4 v[152:155], v12, s[28:31], s79 offen offset:2048 sc1
    v_pk_mul_f32 v[184:185], v[184:185], v[90:91] op_sel:[0,1] op_sel_hi:[1,1]
    v_pk_mul_f32 v[186:187], v[186:187], v[90:91] op_sel:[0,1] op_sel_hi:[1,1]
    v_pk_mul_f32 v[188:189], v[188:189], v[90:91] op_sel:[0,1] op_sel_hi:[1,1]
    v_pk_mul_f32 v[190:191], v[190:191], v[90:91] op_sel:[0,1] op_sel_hi:[1,1]
    v_cvt_pk_bf16_f32 v156, v184, v185
    v_cvt_pk_bf16_f32 v157, v186, v187
    v_cvt_pk_bf16_f32 v158, v188, v189
    v_cvt_pk_bf16_f32 v159, v190, v191
    buffer_store_dwordx4 v[156:159], v12, s[28:31], s79 offen offset:3072 sc1
    s_nop 0
    v_mfma_f32_16x16x32_bf16 v[92:95], v[128:131], v[132:135], 0
    v_mfma_f32_16x16x32_bf16 v[92:95], v[136:139], v[140:143], v[92:95]
    v_mfma_f32_16x16x32_bf16 v[92:95], v[144:147], v[148:151], v[92:95]
    v_mfma_f32_16x16x32_bf16 v[92:95], v[152:155], v[156:159], v[92:95]
    s_nop 7
    v_add_f32 v92, |v92|, |v93|
    v_add_f32 v94, |v94|, |v95|
    v_add_f32 v92, v92, v94
    v_cmp_ngt_f32 vcc, -v6, v92
    s_nop 0
    s_or_b64 s[72:73], s[72:73], vcc
    s_mov_b32 s78, 1
    s_add_u32 s53, s53, 2
    s_max_u32 s53, s53, 13
    s_branch ss_loop
s_flag:
    s_mov_b32 s53, 35
    s_cmp_lg_u64 s[72:73], 0
    s_cbranch_scc1 ss_loop
    s_waitcnt vmcnt(18)
    v_mov_b32 v89, 1
    s_mov_b64 exec, 1
    buffer_store_dword v89, off, s[28:31], s26 sc1
    s_mov_b64 exec, -1
    s_mov_b32 s79, 0x3800000
.p2align 3
ss_loop:
    v_mfma_f32_16x16x32_bf16 v[192:195], a[96:99], v[56:59], v[192:195]
    s_barrier
    v_exp_f32 v24, v24
    v_mfma_f32_16x16x32_bf16 v[224:227], a[96:99], v[60:63], v[224:227]
    v_cvt_pk_bf16_f32 v51, v22, v23
    v_xor_b32 v3, s54, v7
    v_mfma_f32_16x16x32_bf16 v[196:199], a[100:103], v[56:59], v[196:199]
    s_add_u32 s54, s54, 0x8000
    v_exp_f32 v25, v25
    v_mfma_f32_16x16x32_bf16 v[228:231], a[100:103], v[60:63], v[228:231]
    s_and_b32 s54, s54, 0x1ffff
    v_cvt_pk_bf16_f32 v52, v24, v25
    ds_read_b128 a[64:67], v3 offset:0
    v_mfma_f32_16x16x32_bf16 v[200:203], a[104:107], v[56:59], v[200:203]
    s_add_u32 m0, s54, s55
    v_exp_f32 v26, v26
    v_mfma_f32_16x16x32_bf16 v[232:235], a[104:107], v[60:63], v[232:235]
    s_add_u32 s44, s44, 1024
    ds_read_b128 a[68:71], v3 offset:1024
    ds_read_b128 a[72:75], v3 offset:2048
    v_mfma_f32_16x16x32_bf16 v[204:207], a[108:111], v[56:59], v[204:207]
    v_exp_f32 v27, v27
    v_mfma_f32_16x16x32_bf16 v[236:239], a[108:111], v[60:63], v[236:239]
    v_cvt_pk_bf16_f32 v53, v26, v27
    v_add_u32 v4, s81, v2
    v_mfma_f32_16x16x32_bf16 v[208:211], a[112:115], v[56:59], v[208:211]
    v_exp_f32 v28, v28
    v_mfma_f32_16x16x32_bf16 v[240:243], a[112:115], v[60:63], v[240:243]
    buffer_load_dwordx4 v4, s[28:31], 0 offen offset:0 sc1 lds
    v_mfma_f32_16x16x32_bf16 v[212:215], a[116:119], v[56:59], v[212:215]
    v_exp_f32 v29, v29
    v_mfma_f32_16x16x32_bf16 v[244:247], a[116:119], v[60:63], v[244:247]
    v_cvt_pk_bf16_f32 v54, v28, v29
    ds_read_b128 a[76:79], v3 offset:3072
    v_mfma_f32_16x16x32_bf16 v[216:219], a[120:123], v[56:59], v[216:219]
    v_exp_f32 v30, v30
    v_mfma_f32_16x16x32_bf16 v[248:251], a[120:123], v[60:63], v[248:251]
    ds_read_b128 a[80:83], v3 offset:4096
    ds_read_b128 a[84:87], v3 offset:5120
    v_mfma_f32_16x16x32_bf16 v[220:223], a[124:127], v[56:59], v[220:223]
    v_exp_f32 v31, v31
    v_mfma_f32_16x16x32_bf16 v[252:255], a[124:127], v[60:63], v[252:255]
    v_cvt_pk_bf16_f32 v55, v30, v31
    ds_read_b128 a[88:91], v3 offset:6144
    v_mfma_f32_16x16x32_bf16 a[136:139], a[144:147], v[56:59], a[136:139]
    ds_read_b128 a[92:95], v3 offset:7168
    ds_read_b128 a[96:99], v3 offset:16384
    v_mfma_f32_16x16x32_bf16 a[140:143], a[144:147], v[60:63], a[140:143]
    s_waitcnt lgkmcnt(7)
    buffer_load_dwordx4 v4, s[28:31], 0 offen offset:1024 sc1 lds
    v_mfma_f32_16x16x32_bf16 v[16:19], a[64:67], a[16:19], v[72:75]
    v_exp_f32 v32, v32
    v_mfma_f32_16x16x32_bf16 v[20:23], a[68:71], a[16:19], v[72:75]
    ds_read_b128 a[100:103], v3 offset:17408
    ds_read_b128 a[104:107], v3 offset:18432
    v_mfma_f32_16x16x32_bf16 v[24:27], a[64:67], a[24:27], v[76:79]
    v_exp_f32 v33, v33
    v_mfma_f32_16x16x32_bf16 v[28:31], a[68:71], a[24:27], v[76:79]
    s_waitcnt lgkmcnt(7)
    v_cvt_pk_bf16_f32 v56, v32, v33
    ds_read_b128 a[108:111], v3 offset:19456
    v_mfma_f32_16x16x32_bf16 v[16:19], a[72:75], a[20:23], v[16:19]
    v_exp_f32 v34, v34
    v_mfma_f32_16x16x32_bf16 v[20:23], a[76:79], a[20:23], v[20:23]
    buffer_load_dwordx4 v4, s[28:31], 0 offen offset:2048 sc1 lds
    v_mfma_f32_16x16x32_bf16 v[24:27], a[72:75], a[28:31], v[24:27]
    v_exp_f32 v35, v35
    v_mfma_f32_16x16x32_bf16 v[28:31], a[76:79], a[28:31], v[28:31]
    s_waitcnt lgkmcnt(6)
    v_cvt_pk_bf16_f32 v57, v34, v35
    ds_read_b128 a[112:115], v3 offset:20480
    v_mfma_f32_16x16x32_bf16 v[16:19], a[80:83], a[48:51], v[16:19]
    v_exp_f32 v36, v36
    v_mfma_f32_16x16x32_bf16 v[20:23], a[84:87], a[48:51], v[20:23]
    ds_read_b128 a[116:119], v3 offset:21504
    ds_read_b128 a[120:123], v3 offset:22528
    v_mfma_f32_16x16x32_bf16 v[24:27], a[80:83], a[56:59], v[24:27]
    v_exp_f32 v37, v37
    v_mfma_f32_16x16x32_bf16 v[28:31], a[84:87], a[56:59], v[28:31]
    s_waitcnt lgkmcnt(7)
    v_cvt_pk_bf16_f32 v58, v36, v37
    ds_read_b128 a[124:127], v3 offset:23552
    v_mfma_f32_16x16x32_bf16 v[16:19], a[88:91], a[52:55], v[16:19]
    v_exp_f32 v38, v38
    v_mfma_f32_16x16x32_bf16 v[20:23], a[92:95], a[52:55], v[20:23]
    buffer_load_dwordx4 v4, s[28:31], 0 offen offset:3072 sc1 lds
    v_mfma_f32_16x16x32_bf16 v[24:27], a[88:91], a[60:63], v[24:27]
    v_exp_f32 v39, v39
    v_mfma_f32_16x16x32_bf16 v[28:31], a[92:95], a[60:63], v[28:31]
    s_waitcnt lgkmcnt(6)
    v_cvt_pk_bf16_f32 v59, v38, v39
    ds_read_b128 a[64:67], v3 offset:8192
    v_mfma_f32_16x16x32_bf16 v[192:195], a[96:99], v[48:51], v[192:195]
    s_add_u32 m0, m0, 0x1000
    v_exp_f32 v40, v40
    v_mfma_f32_16x16x32_bf16 v[224:227], a[96:99], v[52:55], v[224:227]
    ds_read_b128 a[68:71], v3 offset:9216
    ds_read_b128 a[72:75], v3 offset:10240
    v_mfma_f32_16x16x32_bf16 v[196:199], a[100:103], v[48:51], v[196:199]
    v_exp_f32 v41, v41
    v_mfma_f32_16x16x32_bf16 v[228:231], a[100:103], v[52:55], v[228:231]
    s_waitcnt lgkmcnt(7)
    v_cvt_pk_bf16_f32 v60, v40, v41
    ds_read_b128 a[76:79], v3 offset:11264
    v_mfma_f32_16x16x32_bf16 v[200:203], a[104:107], v[48:51], v[200:203]
    v_exp_f32 v42, v42
    v_mfma_f32_16x16x32_bf16 v[232:235], a[104:107], v[52:55], v[232:235]
    buffer_load_dwordx4 v4, s[28:31], s76 offen offset:0 sc1 lds
    v_mfma_f32_16x16x32_bf16 v[204:207], a[108:111], v[48:51], v[204:207]
    v_exp_f32 v43, v43
    v_mfma_f32_16x16x32_bf16 v[236:239], a[108:111], v[52:55], v[236:239]
    s_waitcnt lgkmcnt(6)
    v_cvt_pk_bf16_f32 v61, v42, v43
    ds_read_b128 a[80:83], v3 offset:12288
    v_mfma_f32_16x16x32_bf16 v[208:211], a[112:115], v[48:51], v[208:211]
    v_exp_f32 v44, v44
    v_mfma_f32_16x16x32_bf16 v[240:243], a[112:115], v[52:55], v[240:243]
    ds_read_b128 a[84:87], v3 offset:13312
    ds_read_b128 a[88:91], v3 offset:14336
    v_mfma_f32_16x16x32_bf16 v[212:215], a[116:119], v[48:51], v[212:215]
    v_exp_f32 v45, v45
    v_mfma_f32_16x16x32_bf16 v[244:247], a[116:119], v[52:55], v[244:247]
    s_waitcnt lgkmcnt(7)
    v_cvt_pk_bf16_f32 v62, v44, v45
    ds_read_b128 a[92:95], v3 offset:15360
    v_mfma_f32_16x16x32_bf16 v[216:219], a[120:123], v[48:51], v[216:219]
    v_exp_f32 v46, v46
    v_mfma_f32_16x16x32_bf16 v[248:251], a[120:123], v[52:55], v[248:251]
    buffer_load_dwordx4 v4, s[28:31], s76 offen offset:1024 sc1 lds
    v_mfma_f32_16x16x32_bf16 v[220:223], a[124:127], v[48:51], v[220:223]
    v_exp_f32 v47, v47
    v_mfma_f32_16x16x32_bf16 v[252:255], a[124:127], v[52:55], v[252:255]
    v_cvt_pk_bf16_f32 v63, v46, v47
    ds_read_b128 a[96:99], v3 offset:24576
    v_mfma_f32_16x16x32_bf16 a[136:139], a[144:147], v[48:51], a[136:139]
    ds_read_b128 a[100:103], v3 offset:25600
    ds_read_b128 a[104:107], v3 offset:26624
    v_mfma_f32_16x16x32_bf16 a[140:143], a[144:147], v[52:55], a[140:143]
    s_waitcnt lgkmcnt(9)
    ds_read_b128 a[108:111], v3 offset:27648
    ds_read_b128 a[112:115], v3 offset:28672
    v_mfma_f32_16x16x32_bf16 v[32:35], a[64:67], a[16:19], v[72:75]
    v_exp_f32 v16, v16
    v_mfma_f32_16x16x32_bf16 v[36:39], a[68:71], a[16:19], v[72:75]
    buffer_load_dwordx4 v4, s[28:31], s76 offen offset:2048 sc1 lds
    v_mfma_f32_16x16x32_bf16 v[40:43], a[64:67], a[24:27], v[76:79]
    v_exp_f32 v17, v17
    v_mfma_f32_16x16x32_bf16 v[44:47], a[68:71], a[24:27], v[76:79]
    s_waitcnt lgkmcnt(9)
    v_cvt_pk_bf16_f32 v48, v16, v17
    ds_read_b128 a[116:119], v3 offset:29696
    v_mfma_f32_16x16x32_bf16 v[32:35], a[72:75], a[20:23], v[32:35]
    v_exp_f32 v18, v18
    v_mfma_f32_16x16x32_bf16 v[36:39], a[76:79], a[20:23], v[36:39]
    ds_read_b128 a[120:123], v3 offset:30720
    ds_read_b128 a[124:127], v3 offset:31744
    v_mfma_f32_16x16x32_bf16 v[40:43], a[72:75], a[28:31], v[40:43]
    v_exp_f32 v19, v19
    v_mfma_f32_16x16x32_bf16 v[44:47], a[76:79], a[28:31], v[44:47]
    s_waitcnt lgkmcnt(10)
    buffer_load_dwordx4 v4, s[28:31], s76 offen offset:3072 sc1 lds
    v_mfma_f32_16x16x32_bf16 v[32:35], a[80:83], a[48:51], v[32:35]
    v_exp_f32 v20, v20
    v_mfma_f32_16x16x32_bf16 v[36:39], a[84:87], a[48:51], v[36:39]
    buffer_store_dwordx4 v[96:99], v2, s[28:31], s44 offen sc1
    v_mfma_f32_16x16x32_bf16 v[40:43], a[80:83], a[56:59], v[40:43]
    s_add_u32 s52, s52, 1
    v_exp_f32 v21, v21
    v_mfma_f32_16x16x32_bf16 v[44:47], a[84:87], a[56:59], v[44:47]
    s_waitcnt lgkmcnt(8)
    v_cvt_pk_bf16_f32 v49, v18, v19
    v_cvt_pk_bf16_f32 v50, v20, v21
    v_mfma_f32_16x16x32_bf16 v[32:35], a[88:91], a[52:55], v[32:35]
    v_exp_f32 v22, v22
    v_mfma_f32_16x16x32_bf16 v[36:39], a[92:95], a[52:55], v[36:39]
    s_cmp_lg_u32 s52, s53
    v_readlane_b32 s81, v5, s52
    v_mfma_f32_16x16x32_bf16 v[40:43], a[88:91], a[60:63], v[40:43]
    s_waitcnt vmcnt(19) lgkmcnt(0)
    v_exp_f32 v23, v23
    v_mfma_f32_16x16x32_bf16 v[44:47], a[92:95], a[60:63], v[44:47]
    s_cbranch_scc1 ss_loop
    s_branch ss_chk
fin_d:
    s_waitcnt vmcnt(1)
    s_barrier
    v_cvt_pk_bf16_f32 v51, v22, v23
    v_xor_b32 v3, s54, v7
    s_add_u32 s54, s54, 0x8000
    s_and_b32 s54, s54, 0x1ffff
    v_mfma_f32_16x16x32_bf16 v[192:195], a[96:99], v[56:59], v[192:195]
    v_exp_f32 v24, v24
    v_mfma_f32_16x16x32_bf16 v[224:227], a[96:99], v[60:63], v[224:227]
    ds_read_b128 a[64:67], v3 offset:0
    ds_read_b128 a[68:71], v3 offset:1024
    v_mfma_f32_16x16x32_bf16 v[196:199], a[100:103], v[56:59], v[196:199]
    v_exp_f32 v25, v25
    v_mfma_f32_16x16x32_bf16 v[228:231], a[100:103], v[60:63], v[228:231]
    v_cvt_pk_bf16_f32 v52, v24, v25
    ds_read_b128 a[72:75], v3 offset:2048
    v_mfma_f32_16x16x32_bf16 v[200:203], a[104:107], v[56:59], v[200:203]
    v_exp_f32 v26, v26
    v_mfma_f32_16x16x32_bf16 v[232:235], a[104:107], v[60:63], v[232:235]
    ds_read_b128 a[76:79], v3 offset:3072
    ds_read_b128 a[80:83], v3 offset:4096
    v_mfma_f32_16x16x32_bf16 v[204:207], a[108:111], v[56:59], v[204:207]
    v_exp_f32 v27, v27
    v_mfma_f32_16x16x32_bf16 v[236:239], a[108:111], v[60:63], v[236:239]
    v_cvt_pk_bf16_f32 v53, v26, v27
    ds_read_b128 a[84:87], v3 offset:5120
    v_mfma_f32_16x16x32_bf16 v[208:211], a[112:115], v[56:59], v[208:211]
    v_exp_f32 v28, v28
    v_mfma_f32_16x16x32_bf16 v[240:243], a[112:115], v[60:63], v[240:243]
    ds_read_b128 a[88:91], v3 offset:6144
    ds_read_b128 a[92:95], v3 offset:7168
    v_mfma_f32_16x16x32_bf16 v[212:215], a[116:119], v[56:59], v[212:215]
    v_exp_f32 v29, v29
    v_mfma_f32_16x16x32_bf16 v[244:247], a[116:119], v[60:63], v[244:247]
    v_cvt_pk_bf16_f32 v54, v28, v29
    v_xor_b32 v88, s54, v7
    v_mfma_f32_16x16x32_bf16 v[216:219], a[120:123], v[56:59], v[216:219]
    v_exp_f32 v30, v30
    v_mfma_f32_16x16x32_bf16 v[248:251], a[120:123], v[60:63], v[248:251]
    buffer_load_dword v14, v15, s[28:31], s27 offen sc1
    v_mfma_f32_16x16x32_bf16 v[220:223], a[124:127], v[56:59], v[220:223]
    v_exp_f32 v31, v31
    v_mfma_f32_16x16x32_bf16 v[252:255], a[124:127], v[60:63], v[252:255]
    v_cvt_pk_bf16_f32 v55, v30, v31
    v_accvgpr_read_b32 v92, a152
    v_mfma_f32_16x16x32_bf16 a[136:139], a[144:147], v[56:59], a[136:139]
    v_accvgpr_read_b32 v93, a153
    v_mfma_f32_16x16x32_bf16 a[140:143], a[144:147], v[60:63], a[140:143]
    s_add_u32 m0, s55, 0x0
    s_waitcnt lgkmcnt(4)
    v_mfma_f32_16x16x32_bf16 v[16:19], a[64:67], a[16:19], v[72:75]
    s_xor_b32 s81, s41, 0x20000
    v_exp_f32 v32, v32
    v_mfma_f32_16x16x32_bf16 v[20:23], a[68:71], a[16:19], v[72:75]
    ds_read_b128 a[96:99], v3 offset:16384
    ds_read_b128 a[100:103], v3 offset:17408
    v_mfma_f32_16x16x32_bf16 v[24:27], a[64:67], a[24:27], v[76:79]
    v_exp_f32 v33, v33
    v_mfma_f32_16x16x32_bf16 v[28:31], a[68:71], a[24:27], v[76:79]
    v_cvt_pk_bf16_f32 v56, v32, v33
    ds_read_b128 a[104:107], v3 offset:18432
    v_mfma_f32_16x16x32_bf16 v[16:19], a[72:75], a[20:23], v[16:19]
    v_exp_f32 v34, v34
    v_mfma_f32_16x16x32_bf16 v[20:23], a[76:79], a[20:23], v[20:23]
    ds_read_b128 a[108:111], v3 offset:19456
    ds_read_b128 a[112:115], v3 offset:20480
    v_mfma_f32_16x16x32_bf16 v[24:27], a[72:75], a[28:31], v[24:27]
    v_exp_f32 v35, v35
    v_mfma_f32_16x16x32_bf16 v[28:31], a[76:79], a[28:31], v[28:31]
    s_waitcnt lgkmcnt(5)
    v_cvt_pk_bf16_f32 v57, v34, v35
    ds_read_b128 a[116:119], v3 offset:21504
    v_mfma_f32_16x16x32_bf16 v[16:19], a[80:83], a[48:51], v[16:19]
    v_exp_f32 v36, v36
    v_mfma_f32_16x16x32_bf16 v[20:23], a[84:87], a[48:51], v[20:23]
    ds_read_b128 a[120:123], v3 offset:22528
    ds_read_b128 a[124:127], v3 offset:23552
    v_mfma_f32_16x16x32_bf16 v[24:27], a[80:83], a[56:59], v[24:27]
    v_exp_f32 v37, v37
    v_mfma_f32_16x16x32_bf16 v[28:31], a[84:87], a[56:59], v[28:31]
    v_cvt_pk_bf16_f32 v58, v36, v37
    v_mfma_f32_16x16x32_bf16 v[16:19], a[88:91], a[52:55], v[16:19]
    v_exp_f32 v38, v38
    v_mfma_f32_16x16x32_bf16 v[20:23], a[92:95], a[52:55], v[20:23]
    buffer_load_dwordx4 v92, s[8:11], s81 offen offset:0 lds
    v_mfma_f32_16x16x32_bf16 v[24:27], a[88:91], a[60:63], v[24:27]
    v_exp_f32 v39, v39
    v_mfma_f32_16x16x32_bf16 v[28:31], a[92:95], a[60:63], v[28:31]
    v_cvt_pk_bf16_f32 v59, v38, v39
    s_waitcnt lgkmcnt(4)
    v_mfma_f32_16x16x32_bf16 v[128:131], a[96:99], v[48:51], v[128:131]
    v_exp_f32 v40, v40
    v_mfma_f32_16x16x32_bf16 v[160:163], a[96:99], v[52:55], v[160:163]
    ds_read_b128 a[64:67], v88 offset:16384
    ds_read_b128 a[68:71], v88 offset:17408
    v_mfma_f32_16x16x32_bf16 v[132:135], a[100:103], v[48:51], v[132:135]
    v_exp_f32 v41, v41
    v_mfma_f32_16x16x32_bf16 v[164:167], a[100:103], v[52:55], v[164:167]
    v_cvt_pk_bf16_f32 v60, v40, v41
    ds_read_b128 a[72:75], v88 offset:18432
    v_mfma_f32_16x16x32_bf16 v[136:139], a[104:107], v[48:51], v[136:139]
    v_exp_f32 v42, v42
    v_mfma_f32_16x16x32_bf16 v[168:171], a[104:107], v[52:55], v[168:171]
    ds_read_b128 a[76:79], v88 offset:19456
    ds_read_b128 a[80:83], v88 offset:20480
    v_mfma_f32_16x16x32_bf16 v[140:143], a[108:111], v[48:51], v[140:143]
    v_exp_f32 v43, v43
    v_mfma_f32_16x16x32_bf16 v[172:175], a[108:111], v[52:55], v[172:175]
    s_waitcnt lgkmcnt(5)
    v_cvt_pk_bf16_f32 v61, v42, v43
    ds_read_b128 a[84:87], v88 offset:21504
    v_mfma_f32_16x16x32_bf16 v[144:147], a[112:115], v[48:51], v[144:147]
    v_exp_f32 v44, v44
    v_mfma_f32_16x16x32_bf16 v[176:179], a[112:115], v[52:55], v[176:179]
    ds_read_b128 a[88:91], v88 offset:22528
    ds_read_b128 a[92:95], v88 offset:23552
    v_mfma_f32_16x16x32_bf16 v[148:151], a[116:119], v[48:51], v[148:151]
    v_exp_f32 v45, v45
    v_mfma_f32_16x16x32_bf16 v[180:183], a[116:119], v[52:55], v[180:183]
    v_cvt_pk_bf16_f32 v62, v44, v45
    v_mfma_f32_16x16x32_bf16 v[152:155], a[120:123], v[48:51], v[152:155]
    v_exp_f32 v46, v46
    v_mfma_f32_16x16x32_bf16 v[184:187], a[120:123], v[52:55], v[184:187]
    buffer_load_dwordx4 v93, s[8:11], s81 offen offset:1024 lds
    v_mfma_f32_16x16x32_bf16 v[156:159], a[124:127], v[48:51], v[156:159]
    s_add_u32 s81, s81, 6144
    v_exp_f32 v47, v47
    v_mfma_f32_16x16x32_bf16 v[188:191], a[124:127], v[52:55], v[188:191]
    v_cvt_pk_bf16_f32 v63, v46, v47
    v_mfma_f32_16x16x32_bf16 a[128:131], a[144:147], v[48:51], a[128:131]
    buffer_load_dwordx4 v92, s[8:11], s81 offen offset:2048 lds
    v_mfma_f32_16x16x32_bf16 a[132:135], a[144:147], v[52:55], a[132:135]
    buffer_load_dwordx4 v93, s[8:11], s81 offen offset:3072 lds
    s_cmp_lg_u32 s3, 3
    s_cbranch_scc1 nomask_1
    v_cndmask_b32 v16, v16, v6, s[64:65]
    v_cndmask_b32 v17, v17, v6, s[66:67]
    v_cndmask_b32 v18, v18, v6, s[68:69]
    v_cndmask_b32 v19, v19, v6, s[70:71]
    v_mov_b32 v20, v6
    v_mov_b32 v21, v6
    v_mov_b32 v22, v6
    v_mov_b32 v23, v6
    v_cndmask_b32 v28, v28, v6, s[64:65]
    v_cndmask_b32 v29, v29, v6, s[66:67]
    v_cndmask_b32 v30, v30, v6, s[68:69]
    v_cndmask_b32 v31, v31, v6, s[70:71]
nomask_1:
    v_mfma_f32_16x16x32_bf16 v[192:195], a[96:99], v[56:59], v[192:195]
    s_add_u32 m0, m0, 0x1000
    v_exp_f32 v16, v16
    v_mfma_f32_16x16x32_bf16 v[224:227], a[96:99], v[60:63], v[224:227]
    s_sub_u32 s81, s81, 6016
    v_exp_f32 v17, v17
    v_mfma_f32_16x16x32_bf16 v[196:199], a[100:103], v[56:59], v[196:199]
    v_exp_f32 v18, v18
    v_mfma_f32_16x16x32_bf16 v[228:231], a[100:103], v[60:63], v[228:231]
    v_exp_f32 v19, v19
    v_mfma_f32_16x16x32_bf16 v[200:203], a[104:107], v[56:59], v[200:203]
    v_cvt_pk_bf16_f32 v48, v16, v17
    buffer_load_dwordx4 v92, s[8:11], s81 offen offset:0 lds
    v_mfma_f32_16x16x32_bf16 v[232:235], a[104:107], v[60:63], v[232:235]
    v_exp_f32 v20, v20
    v_mfma_f32_16x16x32_bf16 v[204:207], a[108:111], v[56:59], v[204:207]
    v_exp_f32 v21, v21
    v_mfma_f32_16x16x32_bf16 v[236:239], a[108:111], v[60:63], v[236:239]
    v_cvt_pk_bf16_f32 v49, v18, v19
    buffer_load_dwordx4 v93, s[8:11], s81 offen offset:1024 lds
    v_mfma_f32_16x16x32_bf16 v[208:211], a[112:115], v[56:59], v[208:211]
    s_add_u32 s81, s81, 6144
    v_exp_f32 v22, v22
    v_mfma_f32_16x16x32_bf16 v[240:243], a[112:115], v[60:63], v[240:243]
    v_exp_f32 v23, v23
    v_mfma_f32_16x16x32_bf16 v[212:215], a[116:119], v[56:59], v[212:215]
    v_cvt_pk_bf16_f32 v50, v20, v21
    buffer_load_dwordx4 v92, s[8:11], s81 offen offset:2048 lds
    v_mfma_f32_16x16x32_bf16 v[244:247], a[116:119], v[60:63], v[244:247]
    v_exp_f32 v24, v24
    v_mfma_f32_16x16x32_bf16 v[216:219], a[120:123], v[56:59], v[216:219]
    v_exp_f32 v25, v25
    v_mfma_f32_16x16x32_bf16 v[248:251], a[120:123], v[60:63], v[248:251]
    v_cvt_pk_bf16_f32 v51, v22, v23
    buffer_load_dwordx4 v93, s[8:11], s81 offen offset:3072 lds
    v_mfma_f32_16x16x32_bf16 v[220:223], a[124:127], v[56:59], v[220:223]
    s_add_u32 m0, s55, 0x8000
    v_exp_f32 v26, v26
    v_mfma_f32_16x16x32_bf16 v[252:255], a[124:127], v[60:63], v[252:255]
    s_xor_b32 s81, s41, 0x40000
    v_exp_f32 v27, v27
    v_mfma_f32_16x16x32_bf16 a[136:139], a[144:147], v[56:59], a[136:139]
    v_cvt_pk_bf16_f32 v52, v24, v25
    buffer_load_dwordx4 v92, s[8:11], s81 offen offset:0 lds
    v_mfma_f32_16x16x32_bf16 a[140:143], a[144:147], v[60:63], a[140:143]
    v_exp_f32 v28, v28
    v_exp_f32 v29, v29
    v_cvt_pk_bf16_f32 v53, v26, v27
    v_exp_f32 v30, v30
    v_exp_f32 v31, v31
    v_cvt_pk_bf16_f32 v54, v28, v29
    s_nop 0
    v_cvt_pk_bf16_f32 v55, v30, v31
    buffer_load_dwordx4 v93, s[8:11], s81 offen offset:1024 lds
    s_add_u32 s81, s81, 6144
    buffer_load_dwordx4 v92, s[8:11], s81 offen offset:2048 lds
    buffer_load_dwordx4 v93, s[8:11], s81 offen offset:3072 lds
    s_add_u32 m0, m0, 0x1000
    s_sub_u32 s81, s81, 6016
    buffer_load_dwordx4 v92, s[8:11], s81 offen offset:0 lds
    buffer_load_dwordx4 v93, s[8:11], s81 offen offset:1024 lds
    s_add_u32 s81, s81, 6144
    buffer_load_dwordx4 v92, s[8:11], s81 offen offset:2048 lds
    buffer_load_dwordx4 v93, s[8:11], s81 offen offset:3072 lds
    s_waitcnt vmcnt(16)
    v_and_b32 v91, 3, v14
    v_cmp_eq_u32 vcc, 0, v91
    s_waitcnt lgkmcnt(0)
    s_and_b32 s36, vcc_lo, s35
    s_cselect_b32 s47, s45, s20
    s_cselect_b32 s48, s45, s21
    s_cselect_b32 s49, s45, s22
    v_mfma_f32_16x16x32_bf16 v[192:195], a[64:67], v[48:51], v[192:195]
    v_xor_b32 v3, 32, v13
    v_xor_b32 v4, 64, v13
    v_mfma_f32_16x16x32_bf16 v[224:227], a[64:67], v[52:55], v[224:227]
    v_xor_b32 v0, 96, v13
    ds_read_b64_tr_b16 v[96:97], v13 offset:0
    v_mfma_f32_16x16x32_bf16 v[196:199], a[68:71], v[48:51], v[196:199]
    ds_read_b64_tr_b16 v[98:99], v13 offset:512
    ds_read_b64_tr_b16 v[100:101], v3 offset:0
    v_mfma_f32_16x16x32_bf16 v[228:231], a[68:71], v[52:55], v[228:231]
    ds_read_b64_tr_b16 v[102:103], v3 offset:512
    ds_read_b64_tr_b16 v[104:105], v4 offset:0
    v_mfma_f32_16x16x32_bf16 v[200:203], a[72:75], v[48:51], v[200:203]
    ds_read_b64_tr_b16 v[106:107], v4 offset:512
    ds_read_b64_tr_b16 v[108:109], v0 offset:0
    v_mfma_f32_16x16x32_bf16 v[232:235], a[72:75], v[52:55], v[232:235]
    ds_read_b64_tr_b16 v[110:111], v0 offset:512
    ds_read_b64_tr_b16 v[112:113], v13 offset:4096
    v_mfma_f32_16x16x32_bf16 v[204:207], a[76:79], v[48:51], v[204:207]
    ds_read_b64_tr_b16 v[114:115], v13 offset:4608
    ds_read_b64_tr_b16 v[116:117], v3 offset:4096
    v_mfma_f32_16x16x32_bf16 v[236:239], a[76:79], v[52:55], v[236:239]
    ds_read_b64_tr_b16 v[118:119], v3 offset:4608
    ds_read_b64_tr_b16 v[120:121], v4 offset:4096
    v_mfma_f32_16x16x32_bf16 v[208:211], a[80:83], v[48:51], v[208:211]
    ds_read_b64_tr_b16 v[122:123], v4 offset:4608
    ds_read_b64_tr_b16 v[124:125], v0 offset:4096
    v_mfma_f32_16x16x32_bf16 v[240:243], a[80:83], v[52:55], v[240:243]
    ds_read_b64_tr_b16 v[126:127], v0 offset:4608
    v_mfma_f32_16x16x32_bf16 v[212:215], a[84:87], v[48:51], v[212:215]
    buffer_load_dwordx4 a[160:163], v2, s[28:31], s47 offen offset:0 sc1
    v_mfma_f32_16x16x32_bf16 v[244:247], a[84:87], v[52:55], v[244:247]
    buffer_load_dwordx4 a[164:167], v2, s[28:31], s47 offen offset:1024 sc1
    v_mfma_f32_16x16x32_bf16 v[216:219], a[88:91], v[48:51], v[216:219]
    buffer_load_dwordx4 a[168:171], v2, s[28:31], s47 offen offset:2048 sc1
    v_mfma_f32_16x16x32_bf16 v[248:251], a[88:91], v[52:55], v[248:251]
    buffer_load_dwordx4 a[172:175], v2, s[28:31], s47 offen offset:3072 sc1
    v_mfma_f32_16x16x32_bf16 v[220:223], a[92:95], v[48:51], v[220:223]
    buffer_load_dwordx4 a[176:179], v12, s[28:31], s47 offen offset:0 sc1
    v_mfma_f32_16x16x32_bf16 v[252:255], a[92:95], v[52:55], v[252:255]
    buffer_load_dwordx4 a[180:183], v12, s[28:31], s47 offen offset:1024 sc1
    v_mfma_f32_16x16x32_bf16 a[136:139], a[144:147], v[48:51], a[136:139]
    buffer_load_dwordx4 a[184:187], v12, s[28:31], s47 offen offset:2048 sc1
    v_mfma_f32_16x16x32_bf16 a[140:143], a[144:147], v[52:55], a[140:143]
    buffer_load_dwordx4 a[188:191], v12, s[28:31], s47 offen offset:3072 sc1
    s_branch att_epi
fin_s:
    s_waitcnt vmcnt(1)
    s_barrier
    v_cvt_pk_bf16_f32 v51, v22, v23
    v_xor_b32 v3, s54, v7
    s_add_u32 s54, s54, 0x8000
    s_and_b32 s54, s54, 0x1ffff
    v_mfma_f32_16x16x32_bf16 v[192:195], a[96:99], v[56:59], v[192:195]
    v_exp_f32 v24, v24
    v_mfma_f32_16x16x32_bf16 v[224:227], a[96:99], v[60:63], v[224:227]
    ds_read_b128 a[64:67], v3 offset:0
    ds_read_b128 a[68:71], v3 offset:1024
    v_mfma_f32_16x16x32_bf16 v[196:199], a[100:103], v[56:59], v[196:199]
    v_exp_f32 v25, v25
    v_mfma_f32_16x16x32_bf16 v[228:231], a[100:103], v[60:63], v[228:231]
    v_cvt_pk_bf16_f32 v52, v24, v25
    ds_read_b128 a[72:75], v3 offset:2048
    v_mfma_f32_16x16x32_bf16 v[200:203], a[104:107], v[56:59], v[200:203]
    v_exp_f32 v26, v26
    v_mfma_f32_16x16x32_bf16 v[232:235], a[104:107], v[60:63], v[232:235]
    ds_read_b128 a[76:79], v3 offset:3072
    ds_read_b128 a[80:83], v3 offset:4096
    v_mfma_f32_16x16x32_bf16 v[204:207], a[108:111], v[56:59], v[204:207]
    v_exp_f32 v27, v27
    v_mfma_f32_16x16x32_bf16 v[236:239], a[108:111], v[60:63], v[236:239]
    v_cvt_pk_bf16_f32 v53, v26, v27
    ds_read_b128 a[84:87], v3 offset:5120
    v_mfma_f32_16x16x32_bf16 v[208:211], a[112:115], v[56:59], v[208:211]
    v_exp_f32 v28, v28
    v_mfma_f32_16x16x32_bf16 v[240:243], a[112:115], v[60:63], v[240:243]
    ds_read_b128 a[88:91], v3 offset:6144
    ds_read_b128 a[92:95], v3 offset:7168
    v_mfma_f32_16x16x32_bf16 v[212:215], a[116:119], v[56:59], v[212:215]
    v_exp_f32 v29, v29
    v_mfma_f32_16x16x32_bf16 v[244:247], a[116:119], v[60:63], v[244:247]
    v_cvt_pk_bf16_f32 v54, v28, v29
    v_xor_b32 v88, s54, v7
    v_mfma_f32_16x16x32_bf16 v[216:219], a[120:123], v[56:59], v[216:219]
    v_exp_f32 v30, v30
    v_mfma_f32_16x16x32_bf16 v[248:251], a[120:123], v[60:63], v[248:251]
    buffer_load_dword v14, v15, s[28:31], s27 offen sc1
    v_mfma_f32_16x16x32_bf16 v[220:223], a[124:127], v[56:59], v[220:223]
    v_exp_f32 v31, v31
    v_mfma_f32_16x16x32_bf16 v[252:255], a[124:127], v[60:63], v[252:255]
    v_cvt_pk_bf16_f32 v55, v30, v31
    v_accvgpr_read_b32 v92, a152
    v_mfma_f32_16x16x32_bf16 a[136:139], a[144:147], v[56:59], a[136:139]
    v_accvgpr_read_b32 v93, a153
    v_mfma_f32_16x16x32_bf16 a[140:143], a[144:147], v[60:63], a[140:143]
    s_add_u32 m0, s55, 0x0
    s_waitcnt lgkmcnt(4)
    v_mfma_f32_16x16x32_bf16 v[16:19], a[64:67], a[16:19], v[72:75]
    s_xor_b32 s81, s41, 0x20000
    v_exp_f32 v32, v32
    v_mfma_f32_16x16x32_bf16 v[20:23], a[68:71], a[16:19], v[72:75]
    ds_read_b128 a[96:99], v3 offset:16384
    ds_read_b128 a[100:103], v3 offset:17408
    v_mfma_f32_16x16x32_bf16 v[24:27], a[64:67], a[24:27], v[76:79]
    v_exp_f32 v33, v33
    v_mfma_f32_16x16x32_bf16 v[28:31], a[68:71], a[24:27], v[76:79]
    v_cvt_pk_bf16_f32 v56, v32, v33
    ds_read_b128 a[104:107], v3 offset:18432
    v_mfma_f32_16x16x32_bf16 v[16:19], a[72:75], a[20:23], v[16:19]
    v_exp_f32 v34, v34
    v_mfma_f32_16x16x32_bf16 v[20:23], a[76:79], a[20:23], v[20:23]
    ds_read_b128 a[108:111], v3 offset:19456
    ds_read_b128 a[112:115], v3 offset:20480
    v_mfma_f32_16x16x32_bf16 v[24:27], a[72:75], a[28:31], v[24:27]
    v_exp_f32 v35, v35
    v_mfma_f32_16x16x32_bf16 v[28:31], a[76:79], a[28:31], v[28:31]
    s_waitcnt lgkmcnt(5)
    v_cvt_pk_bf16_f32 v57, v34, v35
    ds_read_b128 a[116:119], v3 offset:21504
    v_mfma_f32_16x16x32_bf16 v[16:19], a[80:83], a[48:51], v[16:19]
    v_exp_f32 v36, v36
    v_mfma_f32_16x16x32_bf16 v[20:23], a[84:87], a[48:51], v[20:23]
    ds_read_b128 a[120:123], v3 offset:22528
    ds_read_b128 a[124:127], v3 offset:23552
    v_mfma_f32_16x16x32_bf16 v[24:27], a[80:83], a[56:59], v[24:27]
    v_exp_f32 v37, v37
    v_mfma_f32_16x16x32_bf16 v[28:31], a[84:87], a[56:59], v[28:31]
    v_cvt_pk_bf16_f32 v58, v36, v37
    v_mfma_f32_16x16x32_bf16 v[16:19], a[88:91], a[52:55], v[16:19]
    v_exp_f32 v38, v38
    v_mfma_f32_16x16x32_bf16 v[20:23], a[92:95], a[52:55], v[20:23]
    buffer_load_dwordx4 v92, s[8:11], s81 offen offset:0 lds
    v_mfma_f32_16x16x32_bf16 v[24:27], a[88:91], a[60:63], v[24:27]
    v_exp_f32 v39, v39
    v_mfma_f32_16x16x32_bf16 v[28:31], a[92:95], a[60:63], v[28:31]
    v_cvt_pk_bf16_f32 v59, v38, v39
    s_waitcnt lgkmcnt(4)
    v_mfma_f32_16x16x32_bf16 v[192:195], a[96:99], v[48:51], v[192:195]
    v_exp_f32 v40, v40
    v_mfma_f32_16x16x32_bf16 v[224:227], a[96:99], v[52:55], v[224:227]
    ds_read_b128 a[64:67], v3 offset:24576
    ds_read_b128 a[68:71], v3 offset:25600
    v_mfma_f32_16x16x32_bf16 v[196:199], a[100:103], v[48:51], v[196:199]
    v_exp_f32 v41, v41
    v_mfma_f32_16x16x32_bf16 v[228:231], a[100:103], v[52:55], v[228:231]
    v_cvt_pk_bf16_f32 v60, v40, v41
    ds_read_b128 a[72:75], v3 offset:26624
    v_mfma_f32_16x16x32_bf16 v[200:203], a[104:107], v[48:51], v[200:203]
    v_exp_f32 v42, v42
    v_mfma_f32_16x16x32_bf16 v[232:235], a[104:107], v[52:55], v[232:235]
    ds_read_b128 a[76:79], v3 offset:27648
    ds_read_b128 a[80:83], v3 offset:28672
    v_mfma_f32_16x16x32_bf16 v[204:207], a[108:111], v[48:51], v[204:207]
    v_exp_f32 v43, v43
    v_mfma_f32_16x16x32_bf16 v[236:239], a[108:111], v[52:55], v[236:239]
    s_waitcnt lgkmcnt(5)
    v_cvt_pk_bf16_f32 v61, v42, v43
    ds_read_b128 a[84:87], v3 offset:29696
    v_mfma_f32_16x16x32_bf16 v[208:211], a[112:115], v[48:51], v[208:211]
    v_exp_f32 v44, v44
    v_mfma_f32_16x16x32_bf16 v[240:243], a[112:115], v[52:55], v[240:243]
    ds_read_b128 a[88:91], v3 offset:30720
    ds_read_b128 a[92:95], v3 offset:31744
    v_mfma_f32_16x16x32_bf16 v[212:215], a[116:119], v[48:51], v[212:215]
    v_exp_f32 v45, v45
    v_mfma_f32_16x16x32_bf16 v[244:247], a[116:119], v[52:55], v[244:247]
    v_cvt_pk_bf16_f32 v62, v44, v45
    v_mfma_f32_16x16x32_bf16 v[216:219], a[120:123], v[48:51], v[216:219]
    v_exp_f32 v46, v46
    v_mfma_f32_16x16x32_bf16 v[248:251], a[120:123], v[52:55], v[248:251]
    buffer_load_dwordx4 v93, s[8:11], s81 offen offset:1024 lds
    v_mfma_f32_16x16x32_bf16 v[220:223], a[124:127], v[48:51], v[220:223]
    s_add_u32 s81, s81, 6144
    v_exp_f32 v47, v47
    v_mfma_f32_16x16x32_bf16 v[252:255], a[124:127], v[52:55], v[252:255]
    v_cvt_pk_bf16_f32 v63, v46, v47
    v_mfma_f32_16x16x32_bf16 a[136:139], a[144:147], v[48:51], a[136:139]
    buffer_load_dwordx4 v92, s[8:11], s81 offen offset:2048 lds
    v_mfma_f32_16x16x32_bf16 a[140:143], a[144:147], v[52:55], a[140:143]
    buffer_load_dwordx4 v93, s[8:11], s81 offen offset:3072 lds
    s_cmp_lg_u32 s3, 3
    s_cbranch_scc1 nomask_2
    v_cndmask_b32 v16, v16, v6, s[64:65]
    v_cndmask_b32 v17, v17, v6, s[66:67]
    v_cndmask_b32 v18, v18, v6, s[68:69]
    v_cndmask_b32 v19, v19, v6, s[70:71]
    v_mov_b32 v20, v6
    v_mov_b32 v21, v6
    v_mov_b32 v22, v6
    v_mov_b32 v23, v6
    v_cndmask_b32 v28, v28, v6, s[64:65]
    v_cndmask_b32 v29, v29, v6, s[66:67]
    v_cndmask_b32 v30, v30, v6, s[68:69]
    v_cndmask_b32 v31, v31, v6, s[70:71]
nomask_2:
    s_waitcnt lgkmcnt(4)
    v_mfma_f32_16x16x32_bf16 v[192:195], a[64:67], v[56:59], v[192:195]
    s_add_u32 m0, m0, 0x1000
    v_exp_f32 v16, v16
    ds_read_b128 a[96:99], v88 offset:16384
    v_mfma_f32_16x16x32_bf16 v[224:227], a[64:67], v[60:63], v[224:227]
    s_sub_u32 s81, s81, 6016
    v_exp_f32 v17, v17
    ds_read_b128 a[100:103], v88 offset:17408
    v_mfma_f32_16x16x32_bf16 v[196:199], a[68:71], v[56:59], v[196:199]
    v_exp_f32 v18, v18
    ds_read_b128 a[104:107], v88 offset:18432
    v_mfma_f32_16x16x32_bf16 v[228:231], a[68:71], v[60:63], v[228:231]
    v_exp_f32 v19, v19
    ds_read_b128 a[108:111], v88 offset:19456
    v_mfma_f32_16x16x32_bf16 v[200:203], a[72:75], v[56:59], v[200:203]
    v_cvt_pk_bf16_f32 v48, v16, v17
    ds_read_b128 a[112:115], v88 offset:20480
    v_mfma_f32_16x16x32_bf16 v[232:235], a[72:75], v[60:63], v[232:235]
    v_exp_f32 v20, v20
    ds_read_b128 a[116:119], v88 offset:21504
    v_mfma_f32_16x16x32_bf16 v[204:207], a[76:79], v[56:59], v[204:207]
    v_exp_f32 v21, v21
    ds_read_b128 a[120:123], v88 offset:22528
    v_mfma_f32_16x16x32_bf16 v[236:239], a[76:79], v[60:63], v[236:239]
    s_waitcnt lgkmcnt(7)
    v_cvt_pk_bf16_f32 v49, v18, v19
    ds_read_b128 a[124:127], v88 offset:23552
    v_mfma_f32_16x16x32_bf16 v[208:211], a[80:83], v[56:59], v[208:211]
    v_exp_f32 v22, v22
    v_mfma_f32_16x16x32_bf16 v[240:243], a[80:83], v[60:63], v[240:243]
    v_exp_f32 v23, v23
    v_mfma_f32_16x16x32_bf16 v[212:215], a[84:87], v[56:59], v[212:215]
    v_cvt_pk_bf16_f32 v50, v20, v21
    buffer_load_dwordx4 v92, s[8:11], s81 offen offset:0 lds
    v_mfma_f32_16x16x32_bf16 v[244:247], a[84:87], v[60:63], v[244:247]
    v_exp_f32 v24, v24
    v_mfma_f32_16x16x32_bf16 v[216:219], a[88:91], v[56:59], v[216:219]
    v_exp_f32 v25, v25
    v_mfma_f32_16x16x32_bf16 v[248:251], a[88:91], v[60:63], v[248:251]
    v_cvt_pk_bf16_f32 v51, v22, v23
    buffer_load_dwordx4 v93, s[8:11], s81 offen offset:1024 lds
    v_mfma_f32_16x16x32_bf16 v[220:223], a[92:95], v[56:59], v[220:223]
    s_add_u32 s81, s81, 6144
    v_exp_f32 v26, v26
    v_mfma_f32_16x16x32_bf16 v[252:255], a[92:95], v[60:63], v[252:255]
    v_exp_f32 v27, v27
    v_mfma_f32_16x16x32_bf16 a[136:139], a[144:147], v[56:59], a[136:139]
    v_cvt_pk_bf16_f32 v52, v24, v25
    buffer_load_dwordx4 v92, s[8:11], s81 offen offset:2048 lds
    v_mfma_f32_16x16x32_bf16 a[140:143], a[144:147], v[60:63], a[140:143]
    v_exp_f32 v28, v28
    v_exp_f32 v29, v29
    v_cvt_pk_bf16_f32 v53, v26, v27
    v_exp_f32 v30, v30
    v_exp_f32 v31, v31
    v_cvt_pk_bf16_f32 v54, v28, v29
    s_nop 0
    v_cvt_pk_bf16_f32 v55, v30, v31
    buffer_load_dwordx4 v93, s[8:11], s81 offen offset:3072 lds
    s_add_u32 m0, s55, 0x8000
    s_xor_b32 s81, s41, 0x40000
    buffer_load_dwordx4 v92, s[8:11], s81 offen offset:0 lds
    buffer_load_dwordx4 v93, s[8:11], s81 offen offset:1024 lds
    s_add_u32 s81, s81, 6144
    buffer_load_dwordx4 v92, s[8:11], s81 offen offset:2048 lds
    buffer_load_dwordx4 v93, s[8:11], s81 offen offset:3072 lds
    s_add_u32 m0, m0, 0x1000
    s_sub_u32 s81, s81, 6016
    buffer_load_dwordx4 v92, s[8:11], s81 offen offset:0 lds
    buffer_load_dwordx4 v93, s[8:11], s81 offen offset:1024 lds
    s_add_u32 s81, s81, 6144
    buffer_load_dwordx4 v92, s[8:11], s81 offen offset:2048 lds
    buffer_load_dwordx4 v93, s[8:11], s81 offen offset:3072 lds
    s_waitcnt vmcnt(16)
    v_and_b32 v91, 3, v14
    v_cmp_eq_u32 vcc, 0, v91
    s_waitcnt lgkmcnt(0)
    s_and_b32 s36, vcc_lo, s35
    s_cselect_b32 s47, s45, s20
    s_cselect_b32 s48, s45, s21
    s_cselect_b32 s49, s45, s22
    v_mfma_f32_16x16x32_bf16 v[192:195], a[96:99], v[48:51], v[192:195]
    v_xor_b32 v3, 32, v13
    v_xor_b32 v4, 64, v13
    v_mfma_f32_16x16x32_bf16 v[224:227], a[96:99], v[52:55], v[224:227]
    v_xor_b32 v0, 96, v13
    ds_read_b64_tr_b16 v[96:97], v13 offset:0
    v_mfma_f32_16x16x32_bf16 v[196:199], a[100:103], v[48:51], v[196:199]
    ds_read_b64_tr_b16 v[98:99], v13 offset:512
    ds_read_b64_tr_b16 v[100:101], v3 offset:0
    v_mfma_f32_16x16x32_bf16 v[228:231], a[100:103], v[52:55], v[228:231]
    ds_read_b64_tr_b16 v[102:103], v3 offset:512
    ds_read_b64_tr_b16 v[104:105], v4 offset:0
    v_mfma_f32_16x16x32_bf16 v[200:203], a[104:107], v[48:51], v[200:203]
    ds_read_b64_tr_b16 v[106:107], v4 offset:512
    ds_read_b64_tr_b16 v[108:109], v0 offset:0
    v_mfma_f32_16x16x32_bf16 v[232:235], a[104:107], v[52:55], v[232:235]
    ds_read_b64_tr_b16 v[110:111], v0 offset:512
    ds_read_b64_tr_b16 v[112:113], v13 offset:4096
    v_mfma_f32_16x16x32_bf16 v[204:207], a[108:111], v[48:51], v[204:207]
    ds_read_b64_tr_b16 v[114:115], v13 offset:4608
    ds_read_b64_tr_b16 v[116:117], v3 offset:4096
    v_mfma_f32_16x16x32_bf16 v[236:239], a[108:111], v[52:55], v[236:239]
    ds_read_b64_tr_b16 v[118:119], v3 offset:4608
    ds_read_b64_tr_b16 v[120:121], v4 offset:4096
    v_mfma_f32_16x16x32_bf16 v[208:211], a[112:115], v[48:51], v[208:211]
    ds_read_b64_tr_b16 v[122:123], v4 offset:4608
    ds_read_b64_tr_b16 v[124:125], v0 offset:4096
    v_mfma_f32_16x16x32_bf16 v[240:243], a[112:115], v[52:55], v[240:243]
    ds_read_b64_tr_b16 v[126:127], v0 offset:4608
    v_mfma_f32_16x16x32_bf16 v[212:215], a[116:119], v[48:51], v[212:215]
    buffer_load_dwordx4 a[160:163], v2, s[28:31], s47 offen offset:0 sc1
    v_mfma_f32_16x16x32_bf16 v[244:247], a[116:119], v[52:55], v[244:247]
    buffer_load_dwordx4 a[164:167], v2, s[28:31], s47 offen offset:1024 sc1
    v_mfma_f32_16x16x32_bf16 v[216:219], a[120:123], v[48:51], v[216:219]
    buffer_load_dwordx4 a[168:171], v2, s[28:31], s47 offen offset:2048 sc1
    v_mfma_f32_16x16x32_bf16 v[248:251], a[120:123], v[52:55], v[248:251]
    buffer_load_dwordx4 a[172:175], v2, s[28:31], s47 offen offset:3072 sc1
    v_mfma_f32_16x16x32_bf16 v[220:223], a[124:127], v[48:51], v[220:223]
    buffer_load_dwordx4 a[176:179], v12, s[28:31], s47 offen offset:0 sc1
    v_mfma_f32_16x16x32_bf16 v[252:255], a[124:127], v[52:55], v[252:255]
    buffer_load_dwordx4 a[180:183], v12, s[28:31], s47 offen offset:1024 sc1
    v_mfma_f32_16x16x32_bf16 a[136:139], a[144:147], v[48:51], a[136:139]
    buffer_load_dwordx4 a[184:187], v12, s[28:31], s47 offen offset:2048 sc1
    v_mfma_f32_16x16x32_bf16 a[140:143], a[144:147], v[52:55], a[140:143]
    buffer_load_dwordx4 a[188:191], v12, s[28:31], s47 offen offset:3072 sc1
att_epi:
    s_cmp_lg_u32 s78, 0
    s_cbranch_scc1 att_epi_l
    v_accvgpr_read_b32 v88, a128
    v_accvgpr_read_b32 v89, a132
    v_rcp_f32 v90, v88
    v_rcp_f32 v91, v89
    v_max_f32 v88, v88, v89
    v_cmp_nlt_f32 vcc, v88, s45
    s_nop 1
    v_cndmask_b32_e64 v90, v90, -1, vcc
    v_cndmask_b32_e64 v91, v91, -1, vcc
    v_pk_mul_f32 v[128:129], v[128:129], v[90:91] op_sel:[0,0] op_sel_hi:[1,0]
    v_pk_mul_f32 v[130:131], v[130:131], v[90:91] op_sel:[0,0] op_sel_hi:[1,0]
    v_pk_mul_f32 v[132:133], v[132:133], v[90:91] op_sel:[0,0] op_sel_hi:[1,0]
    v_pk_mul_f32 v[134:135], v[134:135], v[90:91] op_sel:[0,0] op_sel_hi:[1,0]
    v_cvt_pk_bf16_f32 v128, v128, v129
    v_cvt_pk_bf16_f32 v129, v130, v131
    v_cvt_pk_bf16_f32 v130, v132, v133
    v_cvt_pk_bf16_f32 v131, v134, v135
    s_or_b64 s[72:73], s[72:73], vcc
    buffer_store_dwordx4 v[128:131], v2, s[28:31], s79 offen offset:0 sc1
    v_pk_mul_f32 v[160:161], v[160:161], v[90:91] op_sel:[0,1] op_sel_hi:[1,1]
    v_pk_mul_f32 v[162:163], v[162:163], v[90:91] op_sel:[0,1] op_sel_hi:[1,1]
    v_pk_mul_f32 v[164:165], v[164:165], v[90:91] op_sel:[0,1] op_sel_hi:[1,1]
    v_pk_mul_f32 v[166:167], v[166:167], v[90:91] op_sel:[0,1] op_sel_hi:[1,1]
    v_cvt_pk_bf16_f32 v132, v160, v161
    v_cvt_pk_bf16_f32 v133, v162, v163
    v_cvt_pk_bf16_f32 v134, v164, v165
    v_cvt_pk_bf16_f32 v135, v166, v167
    buffer_store_dwordx4 v[132:135], v2, s[28:31], s79 offen offset:1024 sc1
    v_pk_mul_f32 v[136:137], v[136:137], v[90:91] op_sel:[0,0] op_sel_hi:[1,0]
    v_pk_mul_f32 v[138:139], v[138:139], v[90:91] op_sel:[0,0] op_sel_hi:[1,0]
    v_pk_mul_f32 v[140:141], v[140:141], v[90:91] op_sel:[0,0] op_sel_hi:[1,0]
    v_pk_mul_f32 v[142:143], v[142:143], v[90:91] op_sel:[0,0] op_sel_hi:[1,0]
    v_cvt_pk_bf16_f32 v136, v136, v137
    v_cvt_pk_bf16_f32 v137, v138, v139
    v_cvt_pk_bf16_f32 v138, v140, v141
    v_cvt_pk_bf16_f32 v139, v142, v143
    buffer_store_dwordx4 v[136:139], v2, s[28:31], s79 offen offset:2048 sc1
    v_pk_mul_f32 v[168:169], v[168:169], v[90:91] op_sel:[0,1] op_sel_hi:[1,1]
    v_pk_mul_f32 v[170:171], v[170:171], v[90:91] op_sel:[0,1] op_sel_hi:[1,1]
    v_pk_mul_f32 v[172:173], v[172:173], v[90:91] op_sel:[0,1] op_sel_hi:[1,1]
    v_pk_mul_f32 v[174:175], v[174:175], v[90:91] op_sel:[0,1] op_sel_hi:[1,1]
    v_cvt_pk_bf16_f32 v140, v168, v169
    v_cvt_pk_bf16_f32 v141, v170, v171
    v_cvt_pk_bf16_f32 v142, v172, v173
    v_cvt_pk_bf16_f32 v143, v174, v175
    buffer_store_dwordx4 v[140:143], v2, s[28:31], s79 offen offset:3072 sc1
    v_pk_mul_f32 v[144:145], v[144:145], v[90:91] op_sel:[0,0] op_sel_hi:[1,0]
    v_pk_mul_f32 v[146:147], v[146:147], v[90:91] op_sel:[0,0] op_sel_hi:[1,0]
    v_pk_mul_f32 v[148:149], v[148:149], v[90:91] op_sel:[0,0] op_sel_hi:[1,0]
    v_pk_mul_f32 v[150:151], v[150:151], v[90:91] op_sel:[0,0] op_sel_hi:[1,0]
    v_cvt_pk_bf16_f32 v144, v144, v145
    v_cvt_pk_bf16_f32 v145, v146, v147
    v_cvt_pk_bf16_f32 v146, v148, v149
    v_cvt_pk_bf16_f32 v147, v150, v151
    buffer_store_dwordx4 v[144:147], v12, s[28:31], s79 offen offset:0 sc1
    v_pk_mul_f32 v[176:177], v[176:177], v[90:91] op_sel:[0,1] op_sel_hi:[1,1]
    v_pk_mul_f32 v[178:179], v[178:179], v[90:91] op_sel:[0,1] op_sel_hi:[1,1]
    v_pk_mul_f32 v[180:181], v[180:181], v[90:91] op_sel:[0,1] op_sel_hi:[1,1]
    v_pk_mul_f32 v[182:183], v[182:183], v[90:91] op_sel:[0,1] op_sel_hi:[1,1]
    v_cvt_pk_bf16_f32 v148, v176, v177
    v_cvt_pk_bf16_f32 v149, v178, v179
    v_cvt_pk_bf16_f32 v150, v180, v181
    v_cvt_pk_bf16_f32 v151, v182, v183
    buffer_store_dwordx4 v[148:151], v12, s[28:31], s79 offen offset:1024 sc1
    v_pk_mul_f32 v[152:153], v[152:153], v[90:91] op_sel:[0,0] op_sel_hi:[1,0]
    v_pk_mul_f32 v[154:155], v[154:155], v[90:91] op_sel:[0,0] op_sel_hi:[1,0]
    v_pk_mul_f32 v[156:157], v[156:157], v[90:91] op_sel:[0,0] op_sel_hi:[1,0]
    v_pk_mul_f32 v[158:159], v[158:159], v[90:91] op_sel:[0,0] op_sel_hi:[1,0]
    v_cvt_pk_bf16_f32 v152, v152, v153
    v_cvt_pk_bf16_f32 v153, v154, v155
    v_cvt_pk_bf16_f32 v154, v156, v157
    v_cvt_pk_bf16_f32 v155, v158, v159
    buffer_store_dwordx4 v[152:155], v12, s[28:31], s79 offen offset:2048 sc1
    v_pk_mul_f32 v[184:185], v[184:185], v[90:91] op_sel:[0,1] op_sel_hi:[1,1]
    v_pk_mul_f32 v[186:187], v[186:187], v[90:91] op_sel:[0,1] op_sel_hi:[1,1]
    v_pk_mul_f32 v[188:189], v[188:189], v[90:91] op_sel:[0,1] op_sel_hi:[1,1]
    v_pk_mul_f32 v[190:191], v[190:191], v[90:91] op_sel:[0,1] op_sel_hi:[1,1]
    v_cvt_pk_bf16_f32 v156, v184, v185
    v_cvt_pk_bf16_f32 v157, v186, v187
    v_cvt_pk_bf16_f32 v158, v188, v189
    v_cvt_pk_bf16_f32 v159, v190, v191
    buffer_store_dwordx4 v[156:159], v12, s[28:31], s79 offen offset:3072 sc1
    s_nop 0
    v_mfma_f32_16x16x32_bf16 v[92:95], v[128:131], v[132:135], 0
    v_mfma_f32_16x16x32_bf16 v[92:95], v[136:139], v[140:143], v[92:95]
    v_mfma_f32_16x16x32_bf16 v[92:95], v[144:147], v[148:151], v[92:95]
    v_mfma_f32_16x16x32_bf16 v[92:95], v[152:155], v[156:159], v[92:95]
    s_nop 7
    v_add_f32 v92, |v92|, |v93|
    v_add_f32 v94, |v94|, |v95|
    v_add_f32 v92, v92, v94
    v_cmp_ngt_f32 vcc, -v6, v92
    s_nop 0
    s_or_b64 s[72:73], s[72:73], vcc
att_epi_l:
    s_waitcnt lgkmcnt(8)
    v_mfma_f32_16x16x32_bf16 v[16:19], v[96:99], v[128:131], 0
    ds_read_b64_tr_b16 a[64:65], v13 offset:8192
    ds_read_b64_tr_b16 a[66:67], v13 offset:8704
    v_mfma_f32_16x16x32_bf16 v[48:51], v[96:99], v[132:135], 0
    ds_read_b64_tr_b16 a[68:69], v3 offset:8192
    ds_read_b64_tr_b16 a[70:71], v3 offset:8704
    v_mfma_f32_16x16x32_bf16 v[20:23], v[100:103], v[128:131], 0
    ds_read_b64_tr_b16 a[72:73], v4 offset:8192
    ds_read_b64_tr_b16 a[74:75], v4 offset:8704
    v_mfma_f32_16x16x32_bf16 v[52:55], v[100:103], v[132:135], 0
    ds_read_b64_tr_b16 a[76:77], v0 offset:8192
    ds_read_b64_tr_b16 a[78:79], v0 offset:8704
    v_mfma_f32_16x16x32_bf16 v[24:27], v[104:107], v[128:131], 0
    v_accvgpr_read_b32 v88, a136
    v_accvgpr_read_b32 v89, a140
    v_mfma_f32_16x16x32_bf16 v[56:59], v[104:107], v[132:135], 0
    v_rcp_f32 v90, v88
    v_mfma_f32_16x16x32_bf16 v[28:31], v[108:111], v[128:131], 0
    v_rcp_f32 v91, v89
    v_mfma_f32_16x16x32_bf16 v[60:63], v[108:111], v[132:135], 0
    v_max_f32 v88, v88, v89
    v_cmp_nlt_f32 vcc, v88, s45
    s_waitcnt lgkmcnt(8)
    v_mfma_f32_16x16x32_bf16 v[32:35], v[112:115], v[128:131], 0
    s_nop 1
    ds_read_b64_tr_b16 a[80:81], v13 offset:12288
    ds_read_b64_tr_b16 a[82:83], v13 offset:12800
    v_mfma_f32_16x16x32_bf16 v[64:67], v[112:115], v[132:135], 0
    ds_read_b64_tr_b16 a[84:85], v3 offset:12288
    ds_read_b64_tr_b16 a[86:87], v3 offset:12800
    v_mfma_f32_16x16x32_bf16 v[36:39], v[116:119], v[128:131], 0
    ds_read_b64_tr_b16 a[88:89], v4 offset:12288
    ds_read_b64_tr_b16 a[90:91], v4 offset:12800
    v_mfma_f32_16x16x32_bf16 v[68:71], v[116:119], v[132:135], 0
    ds_read_b64_tr_b16 a[92:93], v0 offset:12288
    ds_read_b64_tr_b16 a[94:95], v0 offset:12800
    v_mfma_f32_16x16x32_bf16 v[40:43], v[120:123], v[128:131], 0
    v_cndmask_b32_e64 v90, v90, -1, vcc
    v_cndmask_b32_e64 v91, v91, -1, vcc
    v_mfma_f32_16x16x32_bf16 v[72:75], v[120:123], v[132:135], 0
    v_mul_f32 v192, v192, v90
    v_mul_f32 v193, v193, v90
    v_mfma_f32_16x16x32_bf16 v[44:47], v[124:127], v[128:131], 0
    v_mul_f32 v194, v194, v90
    v_mul_f32 v195, v195, v90
    v_mfma_f32_16x16x32_bf16 v[76:79], v[124:127], v[132:135], 0
    v_mul_f32 v196, v196, v90
    v_mul_f32 v197, v197, v90
    s_waitcnt lgkmcnt(8)
    v_mfma_f32_16x16x32_bf16 v[16:19], a[64:67], v[136:139], v[16:19]
    ds_read_b64_tr_b16 v[96:97], v13 offset:16384
    ds_read_b64_tr_b16 v[98:99], v13 offset:16896
    v_mfma_f32_16x16x32_bf16 v[48:51], a[64:67], v[140:143], v[48:51]
    ds_read_b64_tr_b16 v[100:101], v3 offset:16384
    ds_read_b64_tr_b16 v[102:103], v3 offset:16896
    v_mfma_f32_16x16x32_bf16 v[20:23], a[68:71], v[136:139], v[20:23]
    ds_read_b64_tr_b16 v[104:105], v4 offset:16384
    ds_read_b64_tr_b16 v[106:107], v4 offset:16896
    v_mfma_f32_16x16x32_bf16 v[52:55], a[68:71], v[140:143], v[52:55]
    ds_read_b64_tr_b16 v[108:109], v0 offset:16384
    ds_read_b64_tr_b16 v[110:111], v0 offset:16896
    v_mfma_f32_16x16x32_bf16 v[24:27], a[72:75], v[136:139], v[24:27]
    v_mul_f32 v198, v198, v90
    v_mul_f32 v199, v199, v90
    v_mfma_f32_16x16x32_bf16 v[56:59], a[72:75], v[140:143], v[56:59]
    v_cvt_pk_bf16_f32 v160, v192, v193
    v_cvt_pk_bf16_f32 v161, v194, v195
    v_mfma_f32_16x16x32_bf16 v[28:31], a[76:79], v[136:139], v[28:31]
    v_cvt_pk_bf16_f32 v162, v196, v197
    v_cvt_pk_bf16_f32 v163, v198, v199
    v_mfma_f32_16x16x32_bf16 v[60:63], a[76:79], v[140:143], v[60:63]
    s_or_b64 s[72:73], s[72:73], vcc
    buffer_store_dwordx4 v[160:163], v2, s[28:31], s80 offen offset:0 sc1
    s_waitcnt lgkmcnt(8)
    v_mfma_f32_16x16x32_bf16 v[32:35], a[80:83], v[136:139], v[32:35]
    ds_read_b64_tr_b16 v[112:113], v13 offset:20480
    ds_read_b64_tr_b16 v[114:115], v13 offset:20992
    v_mfma_f32_16x16x32_bf16 v[64:67], a[80:83], v[140:143], v[64:67]
    ds_read_b64_tr_b16 v[116:117], v3 offset:20480
    ds_read_b64_tr_b16 v[118:119], v3 offset:20992
    v_mfma_f32_16x16x32_bf16 v[36:39], a[84:87], v[136:139], v[36:39]
    ds_read_b64_tr_b16 v[120:121], v4 offset:20480
    ds_read_b64_tr_b16 v[122:123], v4 offset:20992
    v_mfma_f32_16x16x32_bf16 v[68:71], a[84:87], v[140:143], v[68:71]
    ds_read_b64_tr_b16 v[124:125], v0 offset:20480
    ds_read_b64_tr_b16 v[126:127], v0 offset:20992
    v_mfma_f32_16x16x32_bf16 v[40:43], a[88:91], v[136:139], v[40:43]
    v_mul_f32 v224, v224, v91
    v_mul_f32 v225, v225, v91
    v_mfma_f32_16x16x32_bf16 v[72:75], a[88:91], v[140:143], v[72:75]
    v_mul_f32 v226, v226, v91
    v_mul_f32 v227, v227, v91
    v_mfma_f32_16x16x32_bf16 v[44:47], a[92:95], v[136:139], v[44:47]
    v_mul_f32 v228, v228, v91
    v_mul_f32 v229, v229, v91
    v_mfma_f32_16x16x32_bf16 v[76:79], a[92:95], v[140:143], v[76:79]
    v_mul_f32 v230, v230, v91
    v_mul_f32 v231, v231, v91
    s_waitcnt lgkmcnt(8)
    v_mfma_f32_16x16x32_bf16 v[16:19], v[96:99], v[144:147], v[16:19]
    ds_read_b64_tr_b16 a[96:97], v13 offset:24576
    ds_read_b64_tr_b16 a[98:99], v13 offset:25088
    v_mfma_f32_16x16x32_bf16 v[48:51], v[96:99], v[148:151], v[48:51]
    ds_read_b64_tr_b16 a[100:101], v3 offset:24576
    ds_read_b64_tr_b16 a[102:103], v3 offset:25088
    v_mfma_f32_16x16x32_bf16 v[20:23], v[100:103], v[144:147], v[20:23]
    ds_read_b64_tr_b16 a[104:105], v4 offset:24576
    ds_read_b64_tr_b16 a[106:107], v4 offset:25088
    v_mfma_f32_16x16x32_bf16 v[52:55], v[100:103], v[148:151], v[52:55]
    ds_read_b64_tr_b16 a[108:109], v0 offset:24576
    ds_read_b64_tr_b16 a[110:111], v0 offset:25088
    v_mfma_f32_16x16x32_bf16 v[24:27], v[104:107], v[144:147], v[24:27]
    v_cvt_pk_bf16_f32 v164, v224, v225
    v_cvt_pk_bf16_f32 v165, v226, v227
    v_mfma_f32_16x16x32_bf16 v[56:59], v[104:107], v[148:151], v[56:59]
    v_cvt_pk_bf16_f32 v166, v228, v229
    v_cvt_pk_bf16_f32 v167, v230, v231
    v_mfma_f32_16x16x32_bf16 v[28:31], v[108:111], v[144:147], v[28:31]
    buffer_store_dwordx4 v[164:167], v2, s[28:31], s80 offen offset:1024 sc1
    v_mfma_f32_16x16x32_bf16 v[60:63], v[108:111], v[148:151], v[60:63]
    v_mul_f32 v200, v200, v90
    v_mul_f32 v201, v201, v90
    s_waitcnt lgkmcnt(8)
    v_mfma_f32_16x16x32_bf16 v[32:35], v[112:115], v[144:147], v[32:35]
    ds_read_b64_tr_b16 a[112:113], v13 offset:28672
    ds_read_b64_tr_b16 a[114:115], v13 offset:29184
    v_mfma_f32_16x16x32_bf16 v[64:67], v[112:115], v[148:151], v[64:67]
    ds_read_b64_tr_b16 a[116:117], v3 offset:28672
    ds_read_b64_tr_b16 a[118:119], v3 offset:29184
    v_mfma_f32_16x16x32_bf16 v[36:39], v[116:119], v[144:147], v[36:39]
    ds_read_b64_tr_b16 a[120:121], v4 offset:28672
    ds_read_b64_tr_b16 a[122:123], v4 offset:29184
    v_mfma_f32_16x16x32_bf16 v[68:71], v[116:119], v[148:151], v[68:71]
    ds_read_b64_tr_b16 a[124:125], v0 offset:28672
    ds_read_b64_tr_b16 a[126:127], v0 offset:29184
    v_mfma_f32_16x16x32_bf16 v[40:43], v[120:123], v[144:147], v[40:43]
    v_mul_f32 v202, v202, v90
    v_mul_f32 v203, v203, v90
    v_mfma_f32_16x16x32_bf16 v[72:75], v[120:123], v[148:151], v[72:75]
    v_mul_f32 v204, v204, v90
    v_mul_f32 v205, v205, v90
    v_mfma_f32_16x16x32_bf16 v[44:47], v[124:127], v[144:147], v[44:47]
    v_mul_f32 v206, v206, v90
    v_mul_f32 v207, v207, v90
    v_mfma_f32_16x16x32_bf16 v[76:79], v[124:127], v[148:151], v[76:79]
    v_cvt_pk_bf16_f32 v168, v200, v201
    v_cvt_pk_bf16_f32 v169, v202, v203
    s_waitcnt lgkmcnt(8)
    v_mfma_f32_16x16x32_bf16 v[16:19], a[96:99], v[152:155], v[16:19]
    ds_read_b64_tr_b16 v[96:97], v13 offset:0
    ds_read_b64_tr_b16 v[98:99], v13 offset:512
    v_mfma_f32_16x16x32_bf16 v[48:51], a[96:99], v[156:159], v[48:51]
    ds_read_b64_tr_b16 v[100:101], v3 offset:0
    ds_read_b64_tr_b16 v[102:103], v3 offset:512
    v_mfma_f32_16x16x32_bf16 v[20:23], a[100:103], v[152:155], v[20:23]
    ds_read_b64_tr_b16 v[104:105], v4 offset:0
    ds_read_b64_tr_b16 v[106:107], v4 offset:512
    v_mfma_f32_16x16x32_bf16 v[52:55], a[100:103], v[156:159], v[52:55]
    ds_read_b64_tr_b16 v[108:109], v0 offset:0
    ds_read_b64_tr_b16 v[110:111], v0 offset:512
    v_mfma_f32_16x16x32_bf16 v[24:27], a[104:107], v[152:155], v[24:27]
    v_cvt_pk_bf16_f32 v170, v204, v205
    v_cvt_pk_bf16_f32 v171, v206, v207
    v_mfma_f32_16x16x32_bf16 v[56:59], a[104:107], v[156:159], v[56:59]
    buffer_store_dwordx4 v[168:171], v2, s[28:31], s80 offen offset:2048 sc1
    v_mfma_f32_16x16x32_bf16 v[28:31], a[108:111], v[152:155], v[28:31]
    v_mul_f32 v232, v232, v91
    v_mul_f32 v233, v233, v91
    v_mfma_f32_16x16x32_bf16 v[60:63], a[108:111], v[156:159], v[60:63]
    v_mul_f32 v234, v234, v91
    v_mul_f32 v235, v235, v91
    s_waitcnt lgkmcnt(8)
    v_mfma_f32_16x16x32_bf16 v[32:35], a[112:115], v[152:155], v[32:35]
    ds_read_b64_tr_b16 v[112:113], v13 offset:4096
    ds_read_b64_tr_b16 v[114:115], v13 offset:4608
    v_mfma_f32_16x16x32_bf16 v[64:67], a[112:115], v[156:159], v[64:67]
    ds_read_b64_tr_b16 v[116:117], v3 offset:4096
    ds_read_b64_tr_b16 v[118:119], v3 offset:4608
    v_mfma_f32_16x16x32_bf16 v[36:39], a[116:119], v[152:155], v[36:39]
    ds_read_b64_tr_b16 v[120:121], v4 offset:4096
    ds_read_b64_tr_b16 v[122:123], v4 offset:4608
    v_mfma_f32_16x16x32_bf16 v[68:71], a[116:119], v[156:159], v[68:71]
    ds_read_b64_tr_b16 v[124:125], v0 offset:4096
    ds_read_b64_tr_b16 v[126:127], v0 offset:4608
    v_mfma_f32_16x16x32_bf16 v[40:43], a[120:123], v[152:155], v[40:43]
    v_mul_f32 v236, v236, v91
    v_mul_f32 v237, v237, v91
    v_mfma_f32_16x16x32_bf16 v[72:75], a[120:123], v[156:159], v[72:75]
    v_mul_f32 v238, v238, v91
    v_mul_f32 v239, v239, v91
    v_mfma_f32_16x16x32_bf16 v[44:47], a[124:127], v[152:155], v[44:47]
    v_cvt_pk_bf16_f32 v172, v232, v233
    v_cvt_pk_bf16_f32 v173, v234, v235
    v_mfma_f32_16x16x32_bf16 v[76:79], a[124:127], v[156:159], v[76:79]
    v_cvt_pk_bf16_f32 v174, v236, v237
    v_cvt_pk_bf16_f32 v175, v238, v239
    buffer_store_dwordx4 v[172:175], v2, s[28:31], s80 offen offset:3072 sc1
    v_mul_f32 v208, v208, v90
    v_mul_f32 v209, v209, v90
    v_mul_f32 v210, v210, v90
    v_mul_f32 v211, v211, v90
    v_mul_f32 v212, v212, v90
    v_mul_f32 v213, v213, v90
    v_mul_f32 v214, v214, v90
    v_mul_f32 v215, v215, v90
    v_cvt_pk_bf16_f32 v176, v208, v209
    v_cvt_pk_bf16_f32 v177, v210, v211
    v_cvt_pk_bf16_f32 v178, v212, v213
    v_cvt_pk_bf16_f32 v179, v214, v215
    buffer_store_dwordx4 v[176:179], v12, s[28:31], s80 offen offset:0 sc1
    v_mul_f32 v240, v240, v91
    v_mul_f32 v241, v241, v91
    v_mul_f32 v242, v242, v91
    v_mul_f32 v243, v243, v91
    v_mul_f32 v244, v244, v91
    v_mul_f32 v245, v245, v91
    v_mul_f32 v246, v246, v91
    v_mul_f32 v247, v247, v91
    v_cvt_pk_bf16_f32 v180, v240, v241
    v_cvt_pk_bf16_f32 v181, v242, v243
    v_cvt_pk_bf16_f32 v182, v244, v245
    v_cvt_pk_bf16_f32 v183, v246, v247
    buffer_store_dwordx4 v[180:183], v12, s[28:31], s80 offen offset:1024 sc1
    v_mul_f32 v216, v216, v90
    v_mul_f32 v217, v217, v90
    v_mul_f32 v218, v218, v90
    v_mul_f32 v219, v219, v90
    v_mul_f32 v220, v220, v90
    v_mul_f32 v221, v221, v90
    v_mul_f32 v222, v222, v90
    v_mul_f32 v223, v223, v90
    v_cvt_pk_bf16_f32 v184, v216, v217
    v_cvt_pk_bf16_f32 v185, v218, v219
    v_cvt_pk_bf16_f32 v186, v220, v221
    v_cvt_pk_bf16_f32 v187, v222, v223
    buffer_store_dwordx4 v[184:187], v12, s[28:31], s80 offen offset:2048 sc1
    v_mul_f32 v248, v248, v91
    v_mul_f32 v249, v249, v91
    v_mul_f32 v250, v250, v91
    v_mul_f32 v251, v251, v91
    v_mul_f32 v252, v252, v91
    v_mul_f32 v253, v253, v91
    v_mul_f32 v254, v254, v91
    v_mul_f32 v255, v255, v91
    v_cvt_pk_bf16_f32 v188, v248, v249
    v_cvt_pk_bf16_f32 v189, v250, v251
    v_cvt_pk_bf16_f32 v190, v252, v253
    v_cvt_pk_bf16_f32 v191, v254, v255
    buffer_store_dwordx4 v[188:191], v12, s[28:31], s80 offen offset:3072 sc1
    s_nop 0
    v_mfma_f32_16x16x32_bf16 v[92:95], v[160:163], v[164:167], 0
    buffer_load_dwordx4 a[192:195], v2, s[28:31], s48 offen offset:0 sc1
    v_mfma_f32_16x16x32_bf16 v[92:95], v[168:171], v[172:175], v[92:95]
    buffer_load_dwordx4 a[196:199], v2, s[28:31], s48 offen offset:1024 sc1
    v_mfma_f32_16x16x32_bf16 v[92:95], v[176:179], v[180:183], v[92:95]
    buffer_load_dwordx4 a[200:203], v2, s[28:31], s48 offen offset:2048 sc1
    v_mfma_f32_16x16x32_bf16 v[92:95], v[184:187], v[188:191], v[92:95]
    buffer_load_dwordx4 a[204:207], v2, s[28:31], s48 offen offset:3072 sc1
    s_waitcnt lgkmcnt(8)
    v_mfma_f32_16x16x32_bf16 v[192:195], v[96:99], v[160:163], 0
    buffer_load_dwordx4 a[208:211], v12, s[28:31], s48 offen offset:0 sc1
    v_mfma_f32_16x16x32_bf16 v[224:227], v[96:99], v[164:167], 0
    s_lshl_b32 s83, s3, 2
    buffer_load_dwordx4 a[212:215], v12, s[28:31], s48 offen offset:1024 sc1
    v_mfma_f32_16x16x32_bf16 v[196:199], v[100:103], v[160:163], 0
    s_add_u32 s83, s83, 0x1a000
    buffer_load_dwordx4 a[216:219], v12, s[28:31], s48 offen offset:2048 sc1
    v_mfma_f32_16x16x32_bf16 v[228:231], v[100:103], v[164:167], 0
    buffer_load_dwordx4 a[220:223], v12, s[28:31], s48 offen offset:3072 sc1
    v_mfma_f32_16x16x32_bf16 v[200:203], v[104:107], v[160:163], 0
    buffer_load_dwordx4 a[224:227], v2, s[28:31], s49 offen offset:0 sc1
    v_mfma_f32_16x16x32_bf16 v[232:235], v[104:107], v[164:167], 0
    buffer_load_dwordx4 a[228:231], v2, s[28:31], s49 offen offset:1024 sc1
    v_mfma_f32_16x16x32_bf16 v[204:207], v[108:111], v[160:163], 0
    buffer_load_dwordx4 a[232:235], v2, s[28:31], s49 offen offset:2048 sc1
    v_mfma_f32_16x16x32_bf16 v[236:239], v[108:111], v[164:167], 0
    buffer_load_dwordx4 a[236:239], v2, s[28:31], s49 offen offset:3072 sc1
    s_waitcnt lgkmcnt(0)
    v_mfma_f32_16x16x32_bf16 v[208:211], v[112:115], v[160:163], 0
    v_add_f32 v92, |v92|, |v93|
    v_add_f32 v94, |v94|, |v95|
    v_mfma_f32_16x16x32_bf16 v[240:243], v[112:115], v[164:167], 0
    v_add_f32 v92, v92, v94
    v_mfma_f32_16x16x32_bf16 v[212:215], v[116:119], v[160:163], 0
    v_cmp_ngt_f32 vcc, -v6, v92
    v_mov_b32 v89, s83
    v_mfma_f32_16x16x32_bf16 v[244:247], v[116:119], v[164:167], 0
    buffer_load_dwordx4 a[240:243], v12, s[28:31], s49 offen offset:0 sc1
    v_mfma_f32_16x16x32_bf16 v[216:219], v[120:123], v[160:163], 0
    s_or_b64 s[72:73], s[72:73], vcc
    buffer_load_dwordx4 a[244:247], v12, s[28:31], s49 offen offset:1024 sc1
    v_mfma_f32_16x16x32_bf16 v[248:251], v[120:123], v[164:167], 0
    s_cmp_lg_u64 s[72:73], 0
    buffer_load_dwordx4 a[248:251], v12, s[28:31], s49 offen offset:2048 sc1
    v_mfma_f32_16x16x32_bf16 v[220:223], v[124:127], v[160:163], 0
    s_cselect_b32 s82, 1, 0
    buffer_load_dwordx4 a[252:255], v12, s[28:31], s49 offen offset:3072 sc1
    v_mfma_f32_16x16x32_bf16 v[252:255], v[124:127], v[164:167], 0
    v_mov_b32 v88, s82
    v_mov_b32 v90, 0x1a000
    v_mfma_f32_16x16x32_bf16 v[192:195], a[64:67], v[168:171], v[192:195]
    ds_write_b32 v89, v88
    ds_read_b64_tr_b16 v[96:97], v13 offset:16384
    v_mfma_f32_16x16x32_bf16 v[224:227], a[64:67], v[172:175], v[224:227]
    ds_read_b64_tr_b16 v[98:99], v13 offset:16896
    ds_read_b64_tr_b16 v[100:101], v3 offset:16384
    v_mfma_f32_16x16x32_bf16 v[196:199], a[68:71], v[168:171], v[196:199]
    ds_read_b64_tr_b16 v[102:103], v3 offset:16896
    ds_read_b64_tr_b16 v[104:105], v4 offset:16384
    v_mfma_f32_16x16x32_bf16 v[228:231], a[68:71], v[172:175], v[228:231]
    s_waitcnt vmcnt(32)
    ds_read_b64_tr_b16 v[106:107], v4 offset:16896
    ds_read_b64_tr_b16 v[108:109], v0 offset:16384
    v_mfma_f32_16x16x32_bf16 v[200:203], a[72:75], v[168:171], v[200:203]
    s_waitcnt lgkmcnt(7)
    ds_read_b64_tr_b16 v[110:111], v0 offset:16896
    v_mfma_f32_16x16x32_bf16 v[232:235], a[72:75], v[172:175], v[232:235]
    s_barrier
    ds_read_b128 v[92:95], v90
    v_mfma_f32_16x16x32_bf16 v[204:207], a[76:79], v[168:171], v[204:207]
    v_mfma_f32_16x16x32_bf16 v[236:239], a[76:79], v[172:175], v[236:239]
    v_mfma_f32_16x16x32_bf16 v[208:211], a[80:83], v[168:171], v[208:211]
    ds_read_b64_tr_b16 v[112:113], v13 offset:20480
    ds_read_b64_tr_b16 v[114:115], v13 offset:20992
    v_mfma_f32_16x16x32_bf16 v[240:243], a[80:83], v[172:175], v[240:243]
    ds_read_b64_tr_b16 v[116:117], v3 offset:20480
    ds_read_b64_tr_b16 v[118:119], v3 offset:20992
    v_mfma_f32_16x16x32_bf16 v[212:215], a[84:87], v[168:171], v[212:215]
    ds_read_b64_tr_b16 v[120:121], v4 offset:20480
    ds_read_b64_tr_b16 v[122:123], v4 offset:20992
    v_mfma_f32_16x16x32_bf16 v[244:247], a[84:87], v[172:175], v[244:247]
    s_waitcnt lgkmcnt(6)
    ds_read_b64_tr_b16 v[124:125], v0 offset:20480
    ds_read_b64_tr_b16 v[126:127], v0 offset:20992
    v_mfma_f32_16x16x32_bf16 v[216:219], a[88:91], v[168:171], v[216:219]
    v_or3_b32 v88, v92, v93, v94
    v_or_b32 v88, v88, v95
    v_mfma_f32_16x16x32_bf16 v[248:251], a[88:91], v[172:175], v[248:251]
    v_mfma_f32_16x16x32_bf16 v[220:223], a[92:95], v[168:171], v[220:223]
    v_readfirstlane_b32 s82, v88
    v_mfma_f32_16x16x32_bf16 v[252:255], a[92:95], v[172:175], v[252:255]
    v_mfma_f32_16x16x32_bf16 v[192:195], v[96:99], v[176:179], v[192:195]
    s_cmp_gt_u32 s82, s77
    v_mfma_f32_16x16x32_bf16 v[224:227], v[96:99], v[180:183], v[224:227]
    s_cbranch_scc1 att_redo
    v_mfma_f32_16x16x32_bf16 v[196:199], v[100:103], v[176:179], v[196:199]
    v_mfma_f32_16x16x32_bf16 v[228:231], v[100:103], v[180:183], v[228:231]
    v_mfma_f32_16x16x32_bf16 v[200:203], v[104:107], v[176:179], v[200:203]
    v_mfma_f32_16x16x32_bf16 v[232:235], v[104:107], v[180:183], v[232:235]
    v_mfma_f32_16x16x32_bf16 v[204:207], v[108:111], v[176:179], v[204:207]
    v_mfma_f32_16x16x32_bf16 v[236:239], v[108:111], v[180:183], v[236:239]
    s_waitcnt lgkmcnt(0)
    v_mfma_f32_16x16x32_bf16 v[208:211], v[112:115], v[176:179], v[208:211]
    v_accvgpr_read_b32 v132, a152
    v_accvgpr_read_b32 v133, a153
    v_mfma_f32_16x16x32_bf16 v[240:243], v[112:115], v[180:183], v[240:243]
    s_add_u32 m0, s55, 0x10000
    v_mfma_f32_16x16x32_bf16 v[212:215], v[116:119], v[176:179], v[212:215]
    s_xor_b32 s81, s41, 0x60000
    buffer_load_dwordx4 v132, s[8:11], s81 offen offset:0 lds
    v_mfma_f32_16x16x32_bf16 v[244:247], v[116:119], v[180:183], v[244:247]
    buffer_load_dwordx4 v133, s[8:11], s81 offen offset:1024 lds
    v_mfma_f32_16x16x32_bf16 v[216:219], v[120:123], v[176:179], v[216:219]
    s_add_u32 s81, s81, 6144
    buffer_load_dwordx4 v132, s[8:11], s81 offen offset:2048 lds
    v_mfma_f32_16x16x32_bf16 v[248:251], v[120:123], v[180:183], v[248:251]
    buffer_load_dwordx4 v133, s[8:11], s81 offen offset:3072 lds
    v_mfma_f32_16x16x32_bf16 v[220:223], v[124:127], v[176:179], v[220:223]
    s_add_u32 m0, m0, 0x1000
    v_mfma_f32_16x16x32_bf16 v[252:255], v[124:127], v[180:183], v[252:255]
    s_sub_u32 s81, s81, 6016
    buffer_load_dwordx4 v132, s[8:11], s81 offen offset:0 lds
    v_mfma_f32_16x16x32_bf16 v[192:195], a[96:99], v[184:187], v[192:195]
    v_xor_b32 v13, 0x20000, v13
    v_xor_b32 v3, 0x20000, v3
    v_mfma_f32_16x16x32_bf16 v[224:227], a[96:99], v[188:191], v[224:227]
    v_xor_b32 v4, 0x20000, v4
    v_xor_b32 v0, 0x20000, v0
    v_mfma_f32_16x16x32_bf16 v[196:199], a[100:103], v[184:187], v[196:199]
    ds_read_b64_tr_b16 v[96:97], v13 offset:0
    ds_read_b64_tr_b16 v[98:99], v13 offset:512
    v_mfma_f32_16x16x32_bf16 v[228:231], a[100:103], v[188:191], v[228:231]
    ds_read_b64_tr_b16 v[100:101], v3 offset:0
    ds_read_b64_tr_b16 v[102:103], v3 offset:512
    v_mfma_f32_16x16x32_bf16 v[200:203], a[104:107], v[184:187], v[200:203]
    ds_read_b64_tr_b16 v[104:105], v4 offset:0
    ds_read_b64_tr_b16 v[106:107], v4 offset:512
    v_mfma_f32_16x16x32_bf16 v[232:235], a[104:107], v[188:191], v[232:235]
    ds_read_b64_tr_b16 v[108:109], v0 offset:0
    ds_read_b64_tr_b16 v[110:111], v0 offset:512
    v_mfma_f32_16x16x32_bf16 v[204:207], a[108:111], v[184:187], v[204:207]
    buffer_load_dwordx4 v133, s[8:11], s81 offen offset:1024 lds
    v_mfma_f32_16x16x32_bf16 v[236:239], a[108:111], v[188:191], v[236:239]
    s_add_u32 s81, s81, 6144
    buffer_load_dwordx4 v132, s[8:11], s81 offen offset:2048 lds
    v_mfma_f32_16x16x32_bf16 v[208:211], a[112:115], v[184:187], v[208:211]
    ds_read_b64_tr_b16 v[112:113], v13 offset:4096
    ds_read_b64_tr_b16 v[114:115], v13 offset:4608
    v_mfma_f32_16x16x32_bf16 v[240:243], a[112:115], v[188:191], v[240:243]
    ds_read_b64_tr_b16 v[116:117], v3 offset:4096
    ds_read_b64_tr_b16 v[118:119], v3 offset:4608
    v_mfma_f32_16x16x32_bf16 v[212:215], a[116:119], v[184:187], v[212:215]
    ds_read_b64_tr_b16 v[120:121], v4 offset:4096
    ds_read_b64_tr_b16 v[122:123], v4 offset:4608
    v_mfma_f32_16x16x32_bf16 v[244:247], a[116:119], v[188:191], v[244:247]
    ds_read_b64_tr_b16 v[124:125], v0 offset:4096
    ds_read_b64_tr_b16 v[126:127], v0 offset:4608
    v_mfma_f32_16x16x32_bf16 v[216:219], a[120:123], v[184:187], v[216:219]
    buffer_load_dwordx4 v133, s[8:11], s81 offen offset:3072 lds
    v_mfma_f32_16x16x32_bf16 v[248:251], a[120:123], v[188:191], v[248:251]
    v_min_u32 v91, 55, v1
    v_and_b32 v90, 3, v91
    v_mfma_f32_16x16x32_bf16 v[220:223], a[124:127], v[184:187], v[220:223]
    v_lshrrev_b32 v91, 2, v91
    v_lshlrev_b32 v91, 6, v91
    v_mfma_f32_16x16x32_bf16 v[252:255], a[124:127], v[188:191], v[252:255]
    v_lshl_add_u32 v91, v90, 3, v91
    s_lshr_b32 s50, s2, 6
    s_lshl_b32 s50, s50, 2
    s_add_u32 s50, s50, s3
    s_mul_i32 s50, s50, 896
    s_add_u32 s50, s50, 0x340a000
    buffer_load_dwordx2 v[128:129], v91, s[28:31], s50 offen offset:0 sc1
    buffer_load_dwordx2 v[130:131], v91, s[28:31], s50 offen offset:32 sc1
    s_cmp_lg_u32 s36, 0
    s_cbranch_scc1 s_slow
s_slow_ok:
    s_waitcnt lgkmcnt(8)
    s_waitcnt vmcnt(40)
    v_mfma_f32_16x16x32_bf16 v[16:19], v[96:99], a[160:163], v[16:19]
    ds_read_b64_tr_b16 a[64:65], v13 offset:8192
    ds_read_b64_tr_b16 a[66:67], v13 offset:8704
    v_mfma_f32_16x16x32_bf16 v[48:51], v[96:99], a[164:167], v[48:51]
    ds_read_b64_tr_b16 a[68:69], v3 offset:8192
    ds_read_b64_tr_b16 a[70:71], v3 offset:8704
    v_mfma_f32_16x16x32_bf16 v[20:23], v[100:103], a[160:163], v[20:23]
    ds_read_b64_tr_b16 a[72:73], v4 offset:8192
    ds_read_b64_tr_b16 a[74:75], v4 offset:8704
    v_mfma_f32_16x16x32_bf16 v[52:55], v[100:103], a[164:167], v[52:55]
    ds_read_b64_tr_b16 a[76:77], v0 offset:8192
    ds_read_b64_tr_b16 a[78:79], v0 offset:8704
    v_mfma_f32_16x16x32_bf16 v[24:27], v[104:107], a[160:163], v[24:27]
    v_lshlrev_b32 v144, 16, v80
    v_and_b32 v145, 0xffff0000, v80
    v_mfma_f32_16x16x32_bf16 v[56:59], v[104:107], a[164:167], v[56:59]
    v_lshlrev_b32 v146, 16, v81
    v_and_b32 v147, 0xffff0000, v81
    v_mfma_f32_16x16x32_bf16 v[28:31], v[108:111], a[160:163], v[28:31]
    v_lshlrev_b32 v148, 16, v82
    v_and_b32 v149, 0xffff0000, v82
    v_mfma_f32_16x16x32_bf16 v[60:63], v[108:111], a[164:167], v[60:63]
    v_lshlrev_b32 v150, 16, v83
    v_and_b32 v151, 0xffff0000, v83
    s_waitcnt lgkmcnt(8)
    v_mfma_f32_16x16x32_bf16 v[32:35], v[112:115], a[160:163], v[32:35]
    ds_read_b64_tr_b16 a[80:81], v13 offset:12288
    ds_read_b64_tr_b16 a[82:83], v13 offset:12800
    v_mfma_f32_16x16x32_bf16 v[64:67], v[112:115], a[164:167], v[64:67]
    ds_read_b64_tr_b16 a[84:85], v3 offset:12288
    ds_read_b64_tr_b16 a[86:87], v3 offset:12800
    v_mfma_f32_16x16x32_bf16 v[36:39], v[116:119], a[160:163], v[36:39]
    ds_read_b64_tr_b16 a[88:89], v4 offset:12288
    ds_read_b64_tr_b16 a[90:91], v4 offset:12800
    v_mfma_f32_16x16x32_bf16 v[68:71], v[116:119], a[164:167], v[68:71]
    ds_read_b64_tr_b16 a[92:93], v0 offset:12288
    ds_read_b64_tr_b16 a[94:95], v0 offset:12800
    v_mfma_f32_16x16x32_bf16 v[40:43], v[120:123], a[160:163], v[40:43]
    v_lshlrev_b32 v152, 16, v84
    v_and_b32 v153, 0xffff0000, v84
    v_mfma_f32_16x16x32_bf16 v[72:75], v[120:123], a[164:167], v[72:75]
    v_lshlrev_b32 v154, 16, v85
    v_and_b32 v155, 0xffff0000, v85
    v_mfma_f32_16x16x32_bf16 v[44:47], v[124:127], a[160:163], v[44:47]
    v_lshlrev_b32 v156, 16, v86
    v_and_b32 v157, 0xffff0000, v86
    v_mfma_f32_16x16x32_bf16 v[76:79], v[124:127], a[164:167], v[76:79]
    v_lshlrev_b32 v158, 16, v87
    v_and_b32 v159, 0xffff0000, v87
    s_waitcnt lgkmcnt(8)
    s_waitcnt vmcnt(38)
    v_mfma_f32_16x16x32_bf16 v[16:19], a[64:67], a[168:171], v[16:19]
    s_waitcnt vmcnt(0)
    ds_read_b64_tr_b16 v[96:97], v13 offset:16384
    ds_read_b64_tr_b16 v[98:99], v13 offset:16896
    v_mfma_f32_16x16x32_bf16 v[48:51], a[64:67], a[172:175], v[48:51]
    ds_read_b64_tr_b16 v[100:101], v3 offset:16384
    ds_read_b64_tr_b16 v[102:103], v3 offset:16896
    v_mfma_f32_16x16x32_bf16 v[20:23], a[68:71], a[168:171], v[20:23]
    ds_read_b64_tr_b16 v[104:105], v4 offset:16384
    ds_read_b64_tr_b16 v[106:107], v4 offset:16896
    v_mfma_f32_16x16x32_bf16 v[52:55], a[68:71], a[172:175], v[52:55]
    ds_read_b64_tr_b16 v[108:109], v0 offset:16384
    ds_read_b64_tr_b16 v[110:111], v0 offset:16896
    v_mfma_f32_16x16x32_bf16 v[24:27], a[72:75], a[168:171], v[24:27]
    v_mov_b32 v89, 2
    v_min3_u32 v88, v128, v129, v130
    v_mfma_f32_16x16x32_bf16 v[56:59], a[72:75], a[172:175], v[56:59]
    v_min_u32 v88, v88, v131
    v_mfma_f32_16x16x32_bf16 v[28:31], a[76:79], a[168:171], v[28:31]
    s_waitcnt vmcnt(26)
    s_mov_b64 exec, 1
    buffer_store_dword v89, off, s[28:31], s26 sc1
    s_mov_b64 exec, -1
    v_mfma_f32_16x16x32_bf16 v[60:63], a[76:79], a[172:175], v[60:63]
    v_cmp_eq_u32 vcc, 0, v88
    s_nop 0
    s_cmp_lg_u64 vcc, 0
    s_cbranch_scc1 h_spin
    h_spin_ok:
    s_waitcnt lgkmcnt(8)
    v_mfma_f32_16x16x32_bf16 v[32:35], a[80:83], a[168:171], v[32:35]
    ds_read_b64_tr_b16 v[112:113], v13 offset:20480
    ds_read_b64_tr_b16 v[114:115], v13 offset:20992
    v_mfma_f32_16x16x32_bf16 v[64:67], a[80:83], a[172:175], v[64:67]
    ds_read_b64_tr_b16 v[116:117], v3 offset:20480
    ds_read_b64_tr_b16 v[118:119], v3 offset:20992
    v_mfma_f32_16x16x32_bf16 v[36:39], a[84:87], a[168:171], v[36:39]
    ds_read_b64_tr_b16 v[120:121], v4 offset:20480
    ds_read_b64_tr_b16 v[122:123], v4 offset:20992
    v_mfma_f32_16x16x32_bf16 v[68:71], a[84:87], a[172:175], v[68:71]
    ds_read_b64_tr_b16 v[124:125], v0 offset:20480
    ds_read_b64_tr_b16 v[126:127], v0 offset:20992
    v_mfma_f32_16x16x32_bf16 v[40:43], a[88:91], a[168:171], v[40:43]
    v_mul_f32 v160, v128, v144
    v_mul_f32 v161, v128, v145
    v_mfma_f32_16x16x32_bf16 v[72:75], a[88:91], a[172:175], v[72:75]
    v_mul_f32 v162, v128, v146
    v_mul_f32 v163, v128, v147
    v_mfma_f32_16x16x32_bf16 v[44:47], a[92:95], a[168:171], v[44:47]
    v_mul_f32 v164, v128, v148
    v_mul_f32 v165, v128, v149
    v_mfma_f32_16x16x32_bf16 v[76:79], a[92:95], a[172:175], v[76:79]
    v_mul_f32 v166, v128, v150
    v_mul_f32 v167, v128, v151
    s_waitcnt lgkmcnt(8)
    s_waitcnt vmcnt(37)
    v_mfma_f32_16x16x32_bf16 v[16:19], v[96:99], a[176:179], v[16:19]
    ds_read_b64_tr_b16 a[64:65], v13 offset:24576
    ds_read_b64_tr_b16 a[66:67], v13 offset:25088
    v_mfma_f32_16x16x32_bf16 v[48:51], v[96:99], a[180:183], v[48:51]
    ds_read_b64_tr_b16 a[68:69], v3 offset:24576
    ds_read_b64_tr_b16 a[70:71], v3 offset:25088
    v_mfma_f32_16x16x32_bf16 v[20:23], v[100:103], a[176:179], v[20:23]
    ds_read_b64_tr_b16 a[72:73], v4 offset:24576
    ds_read_b64_tr_b16 a[74:75], v4 offset:25088
    v_mfma_f32_16x16x32_bf16 v[52:55], v[100:103], a[180:183], v[52:55]
    ds_read_b64_tr_b16 a[76:77], v0 offset:24576
    ds_read_b64_tr_b16 a[78:79], v0 offset:25088
    v_mfma_f32_16x16x32_bf16 v[24:27], v[104:107], a[176:179], v[24:27]
    v_mul_f32 v168, v130, v144
    v_mul_f32 v169, v130, v145
    v_mfma_f32_16x16x32_bf16 v[56:59], v[104:107], a[180:183], v[56:59]
    v_mul_f32 v170, v130, v146
    v_mul_f32 v171, v130, v147
    v_mfma_f32_16x16x32_bf16 v[28:31], v[108:111], a[176:179], v[28:31]
    v_mul_f32 v172, v130, v148
    v_mul_f32 v173, v130, v149
    v_mfma_f32_16x16x32_bf16 v[60:63], v[108:111], a[180:183], v[60:63]
    v_mul_f32 v174, v130, v150
    v_mul_f32 v175, v130, v151
    s_waitcnt lgkmcnt(8)
    v_mfma_f32_16x16x32_bf16 v[32:35], v[112:115], a[176:179], v[32:35]
    ds_read_b64_tr_b16 a[80:81], v13 offset:28672
    ds_read_b64_tr_b16 a[82:83], v13 offset:29184
    v_mfma_f32_16x16x32_bf16 v[64:67], v[112:115], a[180:183], v[64:67]
    ds_read_b64_tr_b16 a[84:85], v3 offset:28672
    ds_read_b64_tr_b16 a[86:87], v3 offset:29184
    v_mfma_f32_16x16x32_bf16 v[36:39], v[116:119], a[176:179], v[36:39]
    ds_read_b64_tr_b16 a[88:89], v4 offset:28672
    ds_read_b64_tr_b16 a[90:91], v4 offset:29184
    v_mfma_f32_16x16x32_bf16 v[68:71], v[116:119], a[180:183], v[68:71]
    ds_read_b64_tr_b16 a[92:93], v0 offset:28672
    ds_read_b64_tr_b16 a[94:95], v0 offset:29184
    v_mfma_f32_16x16x32_bf16 v[40:43], v[120:123], a[176:179], v[40:43]
    v_fmac_f32 v160, v129, v152
    v_fmac_f32 v161, v129, v153
    v_mfma_f32_16x16x32_bf16 v[72:75], v[120:123], a[180:183], v[72:75]
    v_fmac_f32 v162, v129, v154
    v_fmac_f32 v163, v129, v155
    v_mfma_f32_16x16x32_bf16 v[44:47], v[124:127], a[176:179], v[44:47]
    v_fmac_f32 v164, v129, v156
    v_fmac_f32 v165, v129, v157
    v_mfma_f32_16x16x32_bf16 v[76:79], v[124:127], a[180:183], v[76:79]
    v_fmac_f32 v166, v129, v158
    v_fmac_f32 v167, v129, v159
    s_waitcnt lgkmcnt(8)
    s_waitcnt vmcnt(35)
    v_mfma_f32_16x16x32_bf16 v[16:19], a[64:67], a[184:187], v[16:19]
    ds_read_b64_tr_b16 v[96:97], v13 offset:32768
    ds_read_b64_tr_b16 v[98:99], v13 offset:33280
    v_mfma_f32_16x16x32_bf16 v[48:51], a[64:67], a[188:191], v[48:51]
    ds_read_b64_tr_b16 v[100:101], v3 offset:32768
    ds_read_b64_tr_b16 v[102:103], v3 offset:33280
    v_mfma_f32_16x16x32_bf16 v[20:23], a[68:71], a[184:187], v[20:23]
    ds_read_b64_tr_b16 v[104:105], v4 offset:32768
    ds_read_b64_tr_b16 v[106:107], v4 offset:33280
    v_mfma_f32_16x16x32_bf16 v[52:55], a[68:71], a[188:191], v[52:55]
    ds_read_b64_tr_b16 v[108:109], v0 offset:32768
    ds_read_b64_tr_b16 v[110:111], v0 offset:33280
    v_mfma_f32_16x16x32_bf16 v[24:27], a[72:75], a[184:187], v[24:27]
    buffer_load_dwordx4 a[96:99], v2, s[28:31], s23 offen offset:0 sc1
    v_mfma_f32_16x16x32_bf16 v[56:59], a[72:75], a[188:191], v[56:59]
    v_fmac_f32 v168, v131, v152
    v_fmac_f32 v169, v131, v153
    v_mfma_f32_16x16x32_bf16 v[28:31], a[76:79], a[184:187], v[28:31]
    v_fmac_f32 v170, v131, v154
    v_fmac_f32 v171, v131, v155
    v_mfma_f32_16x16x32_bf16 v[60:63], a[76:79], a[188:191], v[60:63]
    buffer_load_dwordx4 a[100:103], v2, s[28:31], s23 offen offset:1024 sc1
    s_waitcnt lgkmcnt(8)
    v_mfma_f32_16x16x32_bf16 v[32:35], a[80:83], a[184:187], v[32:35]
    ds_read_b64_tr_b16 v[112:113], v13 offset:36864
    ds_read_b64_tr_b16 v[114:115], v13 offset:37376
    v_mfma_f32_16x16x32_bf16 v[64:67], a[80:83], a[188:191], v[64:67]
    ds_read_b64_tr_b16 v[116:117], v3 offset:36864
    ds_read_b64_tr_b16 v[118:119], v3 offset:37376
    v_mfma_f32_16x16x32_bf16 v[36:39], a[84:87], a[184:187], v[36:39]
    ds_read_b64_tr_b16 v[120:121], v4 offset:36864
    ds_read_b64_tr_b16 v[122:123], v4 offset:37376
    v_mfma_f32_16x16x32_bf16 v[68:71], a[84:87], a[188:191], v[68:71]
    ds_read_b64_tr_b16 v[124:125], v0 offset:36864
    ds_read_b64_tr_b16 v[126:127], v0 offset:37376
    v_mfma_f32_16x16x32_bf16 v[40:43], a[88:91], a[184:187], v[40:43]
    buffer_load_dwordx4 a[104:107], v2, s[28:31], s23 offen offset:2048 sc1
    v_mfma_f32_16x16x32_bf16 v[72:75], a[88:91], a[188:191], v[72:75]
    v_fmac_f32 v172, v131, v156
    v_fmac_f32 v173, v131, v157
    v_mfma_f32_16x16x32_bf16 v[44:47], a[92:95], a[184:187], v[44:47]
    v_fmac_f32 v174, v131, v158
    v_fmac_f32 v175, v131, v159
    v_mfma_f32_16x16x32_bf16 v[76:79], a[92:95], a[188:191], v[76:79]
    s_lshl_b32 s50, s3, 6
    buffer_load_dwordx4 a[108:111], v2, s[28:31], s23 offen offset:3072 sc1
    s_waitcnt lgkmcnt(8)
    s_waitcnt vmcnt(29)
    v_mfma_f32_16x16x32_bf16 v[16:19], v[96:99], a[192:195], v[16:19]
    s_add_u32 s50, s50, 0x1a040
    ds_read_b64_tr_b16 a[64:65], v13 offset:40960
    ds_read_b64_tr_b16 a[66:67], v13 offset:41472
    v_mfma_f32_16x16x32_bf16 v[48:51], v[96:99], a[196:199], v[48:51]
    ds_read_b64_tr_b16 a[68:69], v3 offset:40960
    ds_read_b64_tr_b16 a[70:71], v3 offset:41472
    v_mfma_f32_16x16x32_bf16 v[20:23], v[100:103], a[192:195], v[20:23]
    ds_read_b64_tr_b16 a[72:73], v4 offset:40960
    ds_read_b64_tr_b16 a[74:75], v4 offset:41472
    v_mfma_f32_16x16x32_bf16 v[52:55], v[100:103], a[196:199], v[52:55]
    ds_read_b64_tr_b16 a[76:77], v0 offset:40960
    ds_read_b64_tr_b16 a[78:79], v0 offset:41472
    v_mfma_f32_16x16x32_bf16 v[24:27], v[104:107], a[192:195], v[24:27]
    buffer_load_dwordx4 a[112:115], v12, s[28:31], s23 offen offset:0 sc1
    v_mfma_f32_16x16x32_bf16 v[56:59], v[104:107], a[196:199], v[56:59]
    v_lshrrev_b32 v128, 4, v1
    v_lshlrev_b32 v128, 4, v128
    v_mfma_f32_16x16x32_bf16 v[28:31], v[108:111], a[192:195], v[28:31]
    v_add_u32 v128, s50, v128
    v_permlane32_swap_b32 v160, v168
    v_mfma_f32_16x16x32_bf16 v[60:63], v[108:111], a[196:199], v[60:63]
    buffer_load_dwordx4 a[116:119], v12, s[28:31], s23 offen offset:1024 sc1
    s_waitcnt lgkmcnt(8)
    v_mfma_f32_16x16x32_bf16 v[32:35], v[112:115], a[192:195], v[32:35]
    ds_read_b64_tr_b16 a[80:81], v13 offset:45056
    ds_read_b64_tr_b16 a[82:83], v13 offset:45568
    v_mfma_f32_16x16x32_bf16 v[64:67], v[112:115], a[196:199], v[64:67]
    ds_read_b64_tr_b16 a[84:85], v3 offset:45056
    ds_read_b64_tr_b16 a[86:87], v3 offset:45568
    v_mfma_f32_16x16x32_bf16 v[36:39], v[116:119], a[192:195], v[36:39]
    ds_read_b64_tr_b16 a[88:89], v4 offset:45056
    ds_read_b64_tr_b16 a[90:91], v4 offset:45568
    v_mfma_f32_16x16x32_bf16 v[68:71], v[116:119], a[196:199], v[68:71]
    ds_read_b64_tr_b16 a[92:93], v0 offset:45056
    ds_read_b64_tr_b16 a[94:95], v0 offset:45568
    v_mfma_f32_16x16x32_bf16 v[40:43], v[120:123], a[192:195], v[40:43]
    buffer_load_dwordx4 a[120:123], v12, s[28:31], s23 offen offset:2048 sc1
    v_mfma_f32_16x16x32_bf16 v[72:75], v[120:123], a[196:199], v[72:75]
    v_permlane32_swap_b32 v161, v169
    v_permlane32_swap_b32 v162, v170
    v_mfma_f32_16x16x32_bf16 v[44:47], v[124:127], a[192:195], v[44:47]
    v_permlane32_swap_b32 v163, v171
    v_permlane32_swap_b32 v164, v172
    v_mfma_f32_16x16x32_bf16 v[76:79], v[124:127], a[196:199], v[76:79]
    buffer_load_dwordx4 a[124:127], v12, s[28:31], s23 offen offset:3072 sc1
    s_waitcnt lgkmcnt(8)
    s_waitcnt vmcnt(31)
    v_mfma_f32_16x16x32_bf16 v[16:19], a[64:67], a[200:203], v[16:19]
    ds_read_b64_tr_b16 v[96:97], v13 offset:49152
    ds_read_b64_tr_b16 v[98:99], v13 offset:49664
    v_mfma_f32_16x16x32_bf16 v[48:51], a[64:67], a[204:207], v[48:51]
    ds_read_b64_tr_b16 v[100:101], v3 offset:49152
    ds_read_b64_tr_b16 v[102:103], v3 offset:49664
    v_mfma_f32_16x16x32_bf16 v[20:23], a[68:71], a[200:203], v[20:23]
    ds_read_b64_tr_b16 v[104:105], v4 offset:49152
    ds_read_b64_tr_b16 v[106:107], v4 offset:49664
    v_mfma_f32_16x16x32_bf16 v[52:55], a[68:71], a[204:207], v[52:55]
    ds_read_b64_tr_b16 v[108:109], v0 offset:49152
    ds_read_b64_tr_b16 v[110:111], v0 offset:49664
    v_mfma_f32_16x16x32_bf16 v[24:27], a[72:75], a[200:203], v[24:27]
    buffer_load_dwordx4 a[128:131], v2, s[28:31], s24 offen offset:0 sc1
    v_mfma_f32_16x16x32_bf16 v[56:59], a[72:75], a[204:207], v[56:59]
    v_permlane32_swap_b32 v165, v173
    v_permlane32_swap_b32 v166, v174
    v_mfma_f32_16x16x32_bf16 v[28:31], a[76:79], a[200:203], v[28:31]
    v_permlane32_swap_b32 v167, v175
    v_add_f32 v160, v160, v168
    v_mfma_f32_16x16x32_bf16 v[60:63], a[76:79], a[204:207], v[60:63]
    buffer_load_dwordx4 a[132:135], v2, s[28:31], s24 offen offset:1024 sc1
    s_waitcnt lgkmcnt(8)
    v_mfma_f32_16x16x32_bf16 v[32:35], a[80:83], a[200:203], v[32:35]
    ds_read_b64_tr_b16 v[112:113], v13 offset:53248
    ds_read_b64_tr_b16 v[114:115], v13 offset:53760
    v_mfma_f32_16x16x32_bf16 v[64:67], a[80:83], a[204:207], v[64:67]
    ds_read_b64_tr_b16 v[116:117], v3 offset:53248
    ds_read_b64_tr_b16 v[118:119], v3 offset:53760
    v_mfma_f32_16x16x32_bf16 v[36:39], a[84:87], a[200:203], v[36:39]
    ds_read_b64_tr_b16 v[120:121], v4 offset:53248
    ds_read_b64_tr_b16 v[122:123], v4 offset:53760
    v_mfma_f32_16x16x32_bf16 v[68:71], a[84:87], a[204:207], v[68:71]
    ds_read_b64_tr_b16 v[124:125], v0 offset:53248
    ds_read_b64_tr_b16 v[126:127], v0 offset:53760
    v_mfma_f32_16x16x32_bf16 v[40:43], a[88:91], a[200:203], v[40:43]
    buffer_load_dwordx4 a[136:139], v2, s[28:31], s24 offen offset:2048 sc1
    v_mfma_f32_16x16x32_bf16 v[72:75], a[88:91], a[204:207], v[72:75]
    v_add_f32 v161, v161, v169
    v_add_f32 v162, v162, v170
    v_mfma_f32_16x16x32_bf16 v[44:47], a[92:95], a[200:203], v[44:47]
    v_add_f32 v163, v163, v171
    v_add_f32 v164, v164, v172
    v_mfma_f32_16x16x32_bf16 v[76:79], a[92:95], a[204:207], v[76:79]
    buffer_load_dwordx4 a[140:143], v2, s[28:31], s24 offen offset:3072 sc1
    s_waitcnt lgkmcnt(8)
    s_waitcnt vmcnt(33)
    v_mfma_f32_16x16x32_bf16 v[16:19], v[96:99], a[208:211], v[16:19]
    ds_read_b64_tr_b16 a[64:65], v13 offset:57344
    ds_read_b64_tr_b16 a[66:67], v13 offset:57856
    v_mfma_f32_16x16x32_bf16 v[48:51], v[96:99], a[212:215], v[48:51]
    ds_read_b64_tr_b16 a[68:69], v3 offset:57344
    ds_read_b64_tr_b16 a[70:71], v3 offset:57856
    v_mfma_f32_16x16x32_bf16 v[20:23], v[100:103], a[208:211], v[20:23]
    ds_read_b64_tr_b16 a[72:73], v4 offset:57344
    ds_read_b64_tr_b16 a[74:75], v4 offset:57856
    v_mfma_f32_16x16x32_bf16 v[52:55], v[100:103], a[212:215], v[52:55]
    ds_read_b64_tr_b16 a[76:77], v0 offset:57344
    ds_read_b64_tr_b16 a[78:79], v0 offset:57856
    v_mfma_f32_16x16x32_bf16 v[24:27], v[104:107], a[208:211], v[24:27]
    buffer_load_dwordx4 a[144:147], v12, s[28:31], s24 offen offset:0 sc1
    v_mfma_f32_16x16x32_bf16 v[56:59], v[104:107], a[212:215], v[56:59]
    v_add_f32 v165, v165, v173
    v_add_f32 v166, v166, v174
    v_mfma_f32_16x16x32_bf16 v[28:31], v[108:111], a[208:211], v[28:31]
    v_add_f32 v167, v167, v175
    v_permlane16_swap_b32 v160, v164
    v_mfma_f32_16x16x32_bf16 v[60:63], v[108:111], a[212:215], v[60:63]
    buffer_load_dwordx4 a[148:151], v12, s[28:31], s24 offen offset:1024 sc1
    s_waitcnt lgkmcnt(8)
    v_mfma_f32_16x16x32_bf16 v[32:35], v[112:115], a[208:211], v[32:35]
    ds_read_b64_tr_b16 a[80:81], v13 offset:61440
    ds_read_b64_tr_b16 a[82:83], v13 offset:61952
    v_mfma_f32_16x16x32_bf16 v[64:67], v[112:115], a[212:215], v[64:67]
    ds_read_b64_tr_b16 a[84:85], v3 offset:61440
    ds_read_b64_tr_b16 a[86:87], v3 offset:61952
    v_mfma_f32_16x16x32_bf16 v[36:39], v[116:119], a[208:211], v[36:39]
    ds_read_b64_tr_b16 a[88:89], v4 offset:61440
    ds_read_b64_tr_b16 a[90:91], v4 offset:61952
    v_mfma_f32_16x16x32_bf16 v[68:71], v[116:119], a[212:215], v[68:71]
    ds_read_b64_tr_b16 a[92:93], v0 offset:61440
    ds_read_b64_tr_b16 a[94:95], v0 offset:61952
    v_mfma_f32_16x16x32_bf16 v[40:43], v[120:123], a[208:211], v[40:43]
    buffer_load_dwordx4 a[152:155], v12, s[28:31], s24 offen offset:2048 sc1
    v_mfma_f32_16x16x32_bf16 v[72:75], v[120:123], a[212:215], v[72:75]
    v_permlane16_swap_b32 v161, v165
    v_permlane16_swap_b32 v162, v166
    v_mfma_f32_16x16x32_bf16 v[44:47], v[124:127], a[208:211], v[44:47]
    v_permlane16_swap_b32 v163, v167
    v_add_f32 v160, v160, v164
    v_mfma_f32_16x16x32_bf16 v[76:79], v[124:127], a[212:215], v[76:79]
    buffer_load_dwordx4 a[156:159], v12, s[28:31], s24 offen offset:3072 sc1
    v_add_f32 v161, v161, v165
    v_add_f32 v162, v162, v166
    v_add_f32 v163, v163, v167
    v_add_f32_dpp v160, v160, v160 row_shr:1 row_mask:0xf bank_mask:0xf bound_ctrl:0
    v_add_f32_dpp v161, v161, v161 row_shr:1 row_mask:0xf bank_mask:0xf bound_ctrl:0
    v_add_f32_dpp v162, v162, v162 row_shr:1 row_mask:0xf bank_mask:0xf bound_ctrl:0
    v_add_f32_dpp v163, v163, v163 row_shr:1 row_mask:0xf bank_mask:0xf bound_ctrl:0
    v_add_f32_dpp v160, v160, v160 row_shr:2 row_mask:0xf bank_mask:0xf bound_ctrl:0
    v_add_f32_dpp v161, v161, v161 row_shr:2 row_mask:0xf bank_mask:0xf bound_ctrl:0
    v_add_f32_dpp v162, v162, v162 row_shr:2 row_mask:0xf bank_mask:0xf bound_ctrl:0
    v_add_f32_dpp v163, v163, v163 row_shr:2 row_mask:0xf bank_mask:0xf bound_ctrl:0
    v_add_f32_dpp v160, v160, v160 row_shr:4 row_mask:0xf bank_mask:0xf bound_ctrl:0
    v_add_f32_dpp v161, v161, v161 row_shr:4 row_mask:0xf bank_mask:0xf bound_ctrl:0
    v_add_f32_dpp v162, v162, v162 row_shr:4 row_mask:0xf bank_mask:0xf bound_ctrl:0
    v_add_f32_dpp v163, v163, v163 row_shr:4 row_mask:0xf bank_mask:0xf bound_ctrl:0
    v_add_f32_dpp v160, v160, v160 row_shr:8 row_mask:0xf bank_mask:0xf bound_ctrl:0
    v_add_f32_dpp v161, v161, v161 row_shr:8 row_mask:0xf bank_mask:0xf bound_ctrl:0
    v_add_f32_dpp v162, v162, v162 row_shr:8 row_mask:0xf bank_mask:0xf bound_ctrl:0
    v_add_f32_dpp v163, v163, v163 row_shr:8 row_mask:0xf bank_mask:0xf bound_ctrl:0
    s_mov_b32 s50, 0x80008000
    s_mov_b32 s51, 0x80008000
    s_mov_b64 exec, s[50:51]
    ds_write_b128 v128, v[160:163]
    s_mov_b64 exec, -1
    s_waitcnt vmcnt(19) lgkmcnt(0)
    s_barrier
    s_waitcnt vmcnt(35)
    v_mfma_f32_16x16x32_bf16 v[16:19], a[64:67], a[216:219], v[16:19]
    v_xor_b32 v13, 0x10000, v13
    v_xor_b32 v3, 0x10000, v3
    v_mfma_f32_16x16x32_bf16 v[48:51], a[64:67], a[220:223], v[48:51]
    v_xor_b32 v4, 0x10000, v4
    v_xor_b32 v0, 0x10000, v0
    v_mfma_f32_16x16x32_bf16 v[20:23], a[68:71], a[216:219], v[20:23]
    ds_read_b64_tr_b16 v[96:97], v13 offset:0
    ds_read_b64_tr_b16 v[98:99], v13 offset:512
    v_mfma_f32_16x16x32_bf16 v[52:55], a[68:71], a[220:223], v[52:55]
    ds_read_b64_tr_b16 v[100:101], v3 offset:0
    ds_read_b64_tr_b16 v[102:103], v3 offset:512
    v_mfma_f32_16x16x32_bf16 v[24:27], a[72:75], a[216:219], v[24:27]
    ds_read_b64_tr_b16 v[104:105], v4 offset:0
    ds_read_b64_tr_b16 v[106:107], v4 offset:512
    v_mfma_f32_16x16x32_bf16 v[56:59], a[72:75], a[220:223], v[56:59]
    ds_read_b64_tr_b16 v[108:109], v0 offset:0
    ds_read_b64_tr_b16 v[110:111], v0 offset:512
    v_mfma_f32_16x16x32_bf16 v[28:31], a[76:79], a[216:219], v[28:31]
    buffer_load_dwordx4 a[0:3], v2, s[28:31], s25 offen offset:0 sc1
    v_mfma_f32_16x16x32_bf16 v[60:63], a[76:79], a[220:223], v[60:63]
    v_and_b32 v128, 3, v1
    v_lshlrev_b32 v129, 4, v128
    v_mfma_f32_16x16x32_bf16 v[32:35], a[80:83], a[216:219], v[32:35]
    ds_read_b64_tr_b16 v[112:113], v13 offset:4096
    ds_read_b64_tr_b16 v[114:115], v13 offset:4608
    v_mfma_f32_16x16x32_bf16 v[64:67], a[80:83], a[220:223], v[64:67]
    ds_read_b64_tr_b16 v[116:117], v3 offset:4096
    ds_read_b64_tr_b16 v[118:119], v3 offset:4608
    v_mfma_f32_16x16x32_bf16 v[36:39], a[84:87], a[216:219], v[36:39]
    ds_read_b64_tr_b16 v[120:121], v4 offset:4096
    ds_read_b64_tr_b16 v[122:123], v4 offset:4608
    v_mfma_f32_16x16x32_bf16 v[68:71], a[84:87], a[220:223], v[68:71]
    ds_read_b64_tr_b16 v[124:125], v0 offset:4096
    ds_read_b64_tr_b16 v[126:127], v0 offset:4608
    v_mfma_f32_16x16x32_bf16 v[40:43], a[88:91], a[216:219], v[40:43]
    buffer_load_dwordx4 a[4:7], v2, s[28:31], s25 offen offset:1024 sc1
    v_mfma_f32_16x16x32_bf16 v[72:75], a[88:91], a[220:223], v[72:75]
    v_add_u32 v130, 0x1a040, v129
    ds_read_b128 v[160:163], v130 offset:0
    v_mfma_f32_16x16x32_bf16 v[44:47], a[92:95], a[216:219], v[44:47]
    ds_read_b128 v[164:167], v130 offset:64
    ds_read_b128 v[168:171], v130 offset:128
    v_mfma_f32_16x16x32_bf16 v[76:79], a[92:95], a[220:223], v[76:79]
    buffer_load_dwordx4 a[8:11], v2, s[28:31], s25 offen offset:2048 sc1
    s_waitcnt lgkmcnt(11)
    s_waitcnt vmcnt(36)
    v_mfma_f32_16x16x32_bf16 v[16:19], v[96:99], a[224:227], v[16:19]
    ds_read_b64_tr_b16 a[64:65], v13 offset:8192
    ds_read_b64_tr_b16 a[66:67], v13 offset:8704
    v_mfma_f32_16x16x32_bf16 v[48:51], v[96:99], a[228:231], v[48:51]
    ds_read_b64_tr_b16 a[68:69], v3 offset:8192
    ds_read_b64_tr_b16 a[70:71], v3 offset:8704
    v_mfma_f32_16x16x32_bf16 v[20:23], v[100:103], a[224:227], v[20:23]
    ds_read_b64_tr_b16 a[72:73], v4 offset:8192
    ds_read_b64_tr_b16 a[74:75], v4 offset:8704
    v_mfma_f32_16x16x32_bf16 v[52:55], v[100:103], a[228:231], v[52:55]
    ds_read_b64_tr_b16 a[76:77], v0 offset:8192
    ds_read_b64_tr_b16 a[78:79], v0 offset:8704
    v_mfma_f32_16x16x32_bf16 v[24:27], v[104:107], a[224:227], v[24:27]
    buffer_load_dwordx4 a[12:15], v2, s[28:31], s25 offen offset:3072 sc1
    v_mfma_f32_16x16x32_bf16 v[56:59], v[104:107], a[228:231], v[56:59]
    ds_read_b128 v[172:175], v130 offset:192
    v_lshrrev_b32 v128, 1, v128
    v_mfma_f32_16x16x32_bf16 v[28:31], v[108:111], a[224:227], v[28:31]
    v_mul_u32_u24 v128, 2016, v128
    v_add_u32 v128, v128, v129
    v_mfma_f32_16x16x32_bf16 v[60:63], v[108:111], a[228:231], v[60:63]
    s_lshr_b32 s50, s2, 6
    buffer_load_dwordx4 a[16:19], v12, s[28:31], s25 offen offset:0 sc1
    s_waitcnt lgkmcnt(12)
    v_mfma_f32_16x16x32_bf16 v[32:35], v[112:115], a[224:227], v[32:35]
    s_lshl_b32 s50, s50, 4
    ds_read_b64_tr_b16 a[80:81], v13 offset:12288
    ds_read_b64_tr_b16 a[82:83], v13 offset:12800
    v_mfma_f32_16x16x32_bf16 v[64:67], v[112:115], a[228:231], v[64:67]
    s_and_b32 s51, s2, 7
    ds_read_b64_tr_b16 a[84:85], v3 offset:12288
    ds_read_b64_tr_b16 a[86:87], v3 offset:12800
    v_mfma_f32_16x16x32_bf16 v[36:39], v[116:119], a[224:227], v[36:39]
    s_add_u32 s50, s50, s51
    ds_read_b64_tr_b16 a[88:89], v4 offset:12288
    ds_read_b64_tr_b16 a[90:91], v4 offset:12800
    v_mfma_f32_16x16x32_bf16 v[68:71], v[116:119], a[228:231], v[68:71]
    s_lshl_b32 s50, s50, 3
    ds_read_b64_tr_b16 a[92:93], v0 offset:12288
    ds_read_b64_tr_b16 a[94:95], v0 offset:12800
    v_mfma_f32_16x16x32_bf16 v[40:43], v[120:123], a[224:227], v[40:43]
    s_bfe_u32 s51, s2, 0x30003
    buffer_load_dwordx4 a[20:23], v12, s[28:31], s25 offen offset:1024 sc1
    v_mfma_f32_16x16x32_bf16 v[72:75], v[120:123], a[228:231], v[72:75]
    s_add_u32 s50, s50, s51
    v_mfma_f32_16x16x32_bf16 v[44:47], v[124:127], a[224:227], v[44:47]
    s_lshl_b32 s50, s50, 5
    v_mfma_f32_16x16x32_bf16 v[76:79], v[124:127], a[228:231], v[76:79]
    s_add_u32 s50, s50, 0x3406000
    buffer_load_dwordx4 a[24:27], v12, s[28:31], s25 offen offset:2048 sc1
    s_waitcnt lgkmcnt(9)
    s_waitcnt vmcnt(38)
    v_mfma_f32_16x16x32_bf16 v[16:19], a[64:67], a[232:235], v[16:19]
    ds_read_b64_tr_b16 v[96:97], v13 offset:16384
    ds_read_b64_tr_b16 v[98:99], v13 offset:16896
    v_mfma_f32_16x16x32_bf16 v[48:51], a[64:67], a[236:239], v[48:51]
    ds_read_b64_tr_b16 v[100:101], v3 offset:16384
    ds_read_b64_tr_b16 v[102:103], v3 offset:16896
    v_mfma_f32_16x16x32_bf16 v[20:23], a[68:71], a[232:235], v[20:23]
    ds_read_b64_tr_b16 v[104:105], v4 offset:16384
    ds_read_b64_tr_b16 v[106:107], v4 offset:16896
    v_mfma_f32_16x16x32_bf16 v[52:55], a[68:71], a[236:239], v[52:55]
    ds_read_b64_tr_b16 v[108:109], v0 offset:16384
    ds_read_b64_tr_b16 v[110:111], v0 offset:16896
    v_mfma_f32_16x16x32_bf16 v[24:27], a[72:75], a[232:235], v[24:27]
    buffer_load_dwordx4 a[28:31], v12, s[28:31], s25 offen offset:3072 sc1
    v_mfma_f32_16x16x32_bf16 v[56:59], a[72:75], a[236:239], v[56:59]
    s_cmp_lg_u32 s3, 0
    s_cselect_b32 s50, s45, s50
    v_mfma_f32_16x16x32_bf16 v[28:31], a[76:79], a[232:235], v[28:31]
    s_waitcnt lgkmcnt(15)
    v_add_f32 v160, v160, v164
    v_add_f32 v161, v161, v165
    v_mfma_f32_16x16x32_bf16 v[60:63], a[76:79], a[236:239], v[60:63]
    v_add_f32 v162, v162, v166
    v_add_f32 v163, v163, v167
    s_waitcnt lgkmcnt(8)
    v_mfma_f32_16x16x32_bf16 v[32:35], a[80:83], a[232:235], v[32:35]
    ds_read_b64_tr_b16 v[112:113], v13 offset:20480
    ds_read_b64_tr_b16 v[114:115], v13 offset:20992
    v_mfma_f32_16x16x32_bf16 v[64:67], a[80:83], a[236:239], v[64:67]
    ds_read_b64_tr_b16 v[116:117], v3 offset:20480
    ds_read_b64_tr_b16 v[118:119], v3 offset:20992
    v_mfma_f32_16x16x32_bf16 v[36:39], a[84:87], a[232:235], v[36:39]
    ds_read_b64_tr_b16 v[120:121], v4 offset:20480
    ds_read_b64_tr_b16 v[122:123], v4 offset:20992
    v_mfma_f32_16x16x32_bf16 v[68:71], a[84:87], a[236:239], v[68:71]
    ds_read_b64_tr_b16 v[124:125], v0 offset:20480
    ds_read_b64_tr_b16 v[126:127], v0 offset:20992
    v_mfma_f32_16x16x32_bf16 v[40:43], a[88:91], a[232:235], v[40:43]
    v_add_f32 v168, v168, v172
    v_add_f32 v169, v169, v173
    v_mfma_f32_16x16x32_bf16 v[72:75], a[88:91], a[236:239], v[72:75]
    v_add_f32 v170, v170, v174
    v_add_f32 v171, v171, v175
    v_mfma_f32_16x16x32_bf16 v[44:47], a[92:95], a[232:235], v[44:47]
    v_add_f32 v160, v160, v168
    v_add_f32 v161, v161, v169
    v_mfma_f32_16x16x32_bf16 v[76:79], a[92:95], a[236:239], v[76:79]
    v_add_f32 v162, v162, v170
    v_add_f32 v163, v163, v171
    s_waitcnt lgkmcnt(8)
    s_waitcnt vmcnt(37)
    v_mfma_f32_16x16x32_bf16 v[16:19], v[96:99], a[240:243], v[16:19]
    ds_read_b64_tr_b16 a[64:65], v13 offset:24576
    ds_read_b64_tr_b16 a[66:67], v13 offset:25088
    v_mfma_f32_16x16x32_bf16 v[48:51], v[96:99], a[244:247], v[48:51]
    ds_read_b64_tr_b16 a[68:69], v3 offset:24576
    ds_read_b64_tr_b16 a[70:71], v3 offset:25088
    v_mfma_f32_16x16x32_bf16 v[20:23], v[100:103], a[240:243], v[20:23]
    ds_read_b64_tr_b16 a[72:73], v4 offset:24576
    ds_read_b64_tr_b16 a[74:75], v4 offset:25088
    v_mfma_f32_16x16x32_bf16 v[52:55], v[100:103], a[244:247], v[52:55]
    ds_read_b64_tr_b16 a[76:77], v0 offset:24576
    ds_read_b64_tr_b16 a[78:79], v0 offset:25088
    v_mfma_f32_16x16x32_bf16 v[24:27], v[104:107], a[240:243], v[24:27]
    v_or_b32 v160, 1, v160
    v_or_b32 v161, 1, v161
    v_mfma_f32_16x16x32_bf16 v[56:59], v[104:107], a[244:247], v[56:59]
    v_or_b32 v162, 1, v162
    v_or_b32 v163, 1, v163
    v_mfma_f32_16x16x32_bf16 v[28:31], v[108:111], a[240:243], v[28:31]
    s_mov_b64 exec, 15
    buffer_store_dwordx4 v[160:163], v128, s[28:31], s50 offen sc1
    s_mov_b64 exec, -1
    v_mfma_f32_16x16x32_bf16 v[60:63], v[108:111], a[244:247], v[60:63]
    s_waitcnt lgkmcnt(8)
    v_mfma_f32_16x16x32_bf16 v[32:35], v[112:115], a[240:243], v[32:35]
    ds_read_b64_tr_b16 a[80:81], v13 offset:28672
    ds_read_b64_tr_b16 a[82:83], v13 offset:29184
    v_mfma_f32_16x16x32_bf16 v[64:67], v[112:115], a[244:247], v[64:67]
    ds_read_b64_tr_b16 a[84:85], v3 offset:28672
    ds_read_b64_tr_b16 a[86:87], v3 offset:29184
    v_mfma_f32_16x16x32_bf16 v[36:39], v[116:119], a[240:243], v[36:39]
    ds_read_b64_tr_b16 a[88:89], v4 offset:28672
    ds_read_b64_tr_b16 a[90:91], v4 offset:29184
    v_mfma_f32_16x16x32_bf16 v[68:71], v[116:119], a[244:247], v[68:71]
    ds_read_b64_tr_b16 a[92:93], v0 offset:28672
    ds_read_b64_tr_b16 a[94:95], v0 offset:29184
    v_mfma_f32_16x16x32_bf16 v[40:43], v[120:123], a[240:243], v[40:43]
    v_mfma_f32_16x16x32_bf16 v[72:75], v[120:123], a[244:247], v[72:75]
    v_mfma_f32_16x16x32_bf16 v[44:47], v[124:127], a[240:243], v[44:47]
    v_mfma_f32_16x16x32_bf16 v[76:79], v[124:127], a[244:247], v[76:79]
    s_waitcnt lgkmcnt(8)
    s_waitcnt vmcnt(36)
    v_mfma_f32_16x16x32_bf16 v[16:19], a[64:67], a[248:251], v[16:19]
    v_xor_b32 v13, 0x10000, v13
    v_xor_b32 v3, 0x10000, v3
    v_mfma_f32_16x16x32_bf16 v[48:51], a[64:67], a[252:255], v[48:51]
    v_xor_b32 v4, 0x10000, v4
    v_xor_b32 v0, 0x10000, v0
    v_mfma_f32_16x16x32_bf16 v[20:23], a[68:71], a[248:251], v[20:23]
    ds_read_b64_tr_b16 v[96:97], v13 offset:0
    ds_read_b64_tr_b16 v[98:99], v13 offset:512
    v_mfma_f32_16x16x32_bf16 v[52:55], a[68:71], a[252:255], v[52:55]
    ds_read_b64_tr_b16 v[100:101], v3 offset:0
    ds_read_b64_tr_b16 v[102:103], v3 offset:512
    v_mfma_f32_16x16x32_bf16 v[24:27], a[72:75], a[248:251], v[24:27]
    ds_read_b64_tr_b16 v[104:105], v4 offset:0
    ds_read_b64_tr_b16 v[106:107], v4 offset:512
    v_mfma_f32_16x16x32_bf16 v[56:59], a[72:75], a[252:255], v[56:59]
    ds_read_b64_tr_b16 v[108:109], v0 offset:0
    ds_read_b64_tr_b16 v[110:111], v0 offset:512
    v_mfma_f32_16x16x32_bf16 v[28:31], a[76:79], a[248:251], v[28:31]
    v_mfma_f32_16x16x32_bf16 v[60:63], a[76:79], a[252:255], v[60:63]
    s_waitcnt vmcnt(17)
    v_mfma_f32_16x16x32_bf16 v[92:95], a[96:99], a[100:103], 0
    v_mfma_f32_16x16x32_bf16 v[92:95], a[104:107], a[108:111], v[92:95]
    v_mfma_f32_16x16x32_bf16 v[92:95], a[112:115], a[116:119], v[92:95]
    v_mfma_f32_16x16x32_bf16 v[92:95], a[120:123], a[124:127], v[92:95]
    s_waitcnt lgkmcnt(8)
    v_mfma_f32_16x16x32_bf16 v[32:35], a[80:83], a[248:251], v[32:35]
    ds_read_b64_tr_b16 v[112:113], v13 offset:8192
    ds_read_b64_tr_b16 v[114:115], v13 offset:8704
    v_mfma_f32_16x16x32_bf16 v[64:67], a[80:83], a[252:255], v[64:67]
    ds_read_b64_tr_b16 v[116:117], v3 offset:8192
    ds_read_b64_tr_b16 v[118:119], v3 offset:8704
    v_mfma_f32_16x16x32_bf16 v[36:39], a[84:87], a[248:251], v[36:39]
    v_add_f32 v92, |v92|, |v93|
    v_add_f32 v94, |v94|, |v95|
    v_mfma_f32_16x16x32_bf16 v[68:71], a[84:87], a[252:255], v[68:71]
    v_add_f32 v92, v92, v94
    ds_read_b64_tr_b16 v[120:121], v4 offset:8192
    v_mfma_f32_16x16x32_bf16 v[40:43], a[88:91], a[248:251], v[40:43]
    v_cmp_ngt_f32 vcc, -v6, v92
    s_nop 0
    s_cmp_lg_u64 vcc, 0
    s_cbranch_scc1 l_spin1
    l_spin1_ok:
    v_mfma_f32_16x16x32_bf16 v[72:75], a[88:91], a[252:255], v[72:75]
    ds_read_b64_tr_b16 v[122:123], v4 offset:8704
    ds_read_b64_tr_b16 v[124:125], v0 offset:8192
    v_mfma_f32_16x16x32_bf16 v[44:47], a[92:95], a[248:251], v[44:47]
    ds_read_b64_tr_b16 v[126:127], v0 offset:8704
    v_mfma_f32_16x16x32_bf16 v[76:79], a[92:95], a[252:255], v[76:79]
    s_waitcnt lgkmcnt(8)
    v_mfma_f32_16x16x32_bf16 v[192:195], v[96:99], a[96:99], v[192:195]
    ds_read_b64_tr_b16 a[64:65], v13 offset:16384
    ds_read_b64_tr_b16 a[66:67], v13 offset:16896
    v_mfma_f32_16x16x32_bf16 v[224:227], v[96:99], a[100:103], v[224:227]
    ds_read_b64_tr_b16 a[68:69], v3 offset:16384
    ds_read_b64_tr_b16 a[70:71], v3 offset:16896
    v_mfma_f32_16x16x32_bf16 v[196:199], v[100:103], a[96:99], v[196:199]
    ds_read_b64_tr_b16 a[72:73], v4 offset:16384
    ds_read_b64_tr_b16 a[74:75], v4 offset:16896
    v_mfma_f32_16x16x32_bf16 v[228:231], v[100:103], a[100:103], v[228:231]
    ds_read_b64_tr_b16 a[76:77], v0 offset:16384
    ds_read_b64_tr_b16 a[78:79], v0 offset:16896
    v_mfma_f32_16x16x32_bf16 v[200:203], v[104:107], a[96:99], v[200:203]
    v_and_b32 v138, 15, v1
    v_lshrrev_b32 v139, 4, v1
    v_mfma_f32_16x16x32_bf16 v[232:235], v[104:107], a[100:103], v[232:235]
    v_lshlrev_b32 v137, 10, v138
    v_lshl_add_u32 v137, v139, 5, v137
    v_mfma_f32_16x16x32_bf16 v[204:207], v[108:111], a[96:99], v[204:207]
    v_and_b32 v88, 16, v1
    v_lshrrev_b32 v139, 1, v139
    v_mfma_f32_16x16x32_bf16 v[236:239], v[108:111], a[100:103], v[236:239]
    v_lshl_add_u32 v139, v139, 7, v88
    v_add_u32 v138, s40, v138
    s_waitcnt lgkmcnt(8)
    v_mfma_f32_16x16x32_bf16 v[192:195], v[112:115], a[104:107], v[192:195]
    s_add_u32 s83, s32, 0
    ds_read_b64_tr_b16 a[80:81], v13 offset:24576
    ds_read_b64_tr_b16 a[82:83], v13 offset:25088
    v_mfma_f32_16x16x32_bf16 v[224:227], v[112:115], a[108:111], v[224:227]
    s_and_b32 s73, s4, 3
    ds_read_b64_tr_b16 a[84:85], v3 offset:24576
    ds_read_b64_tr_b16 a[86:87], v3 offset:25088
    v_mfma_f32_16x16x32_bf16 v[196:199], v[116:119], a[104:107], v[196:199]
    s_lshl_b32 s72, 0x11111111, s73
    ds_read_b64_tr_b16 a[88:89], v4 offset:24576
    ds_read_b64_tr_b16 a[90:91], v4 offset:25088
    v_mfma_f32_16x16x32_bf16 v[228:231], v[116:119], a[108:111], v[228:231]
    s_mov_b32 s73, 0
    ds_read_b64_tr_b16 a[92:93], v0 offset:24576
    ds_read_b64_tr_b16 a[94:95], v0 offset:25088
    v_mfma_f32_16x16x32_bf16 v[200:203], v[120:123], a[104:107], v[200:203]
    v_cvt_pk_bf16_f32 v160, v16, v17
    v_cvt_pk_bf16_f32 v161, v18, v19
    v_mfma_f32_16x16x32_bf16 v[232:235], v[120:123], a[108:111], v[232:235]
    v_cvt_pk_bf16_f32 v162, v20, v21
    v_cvt_pk_bf16_f32 v163, v22, v23
    v_mfma_f32_16x16x32_bf16 v[204:207], v[124:127], a[104:107], v[204:207]
    buffer_store_dwordx4 v[160:163], v2, s[28:31], s83 offen offset:0 sc1
    v_mfma_f32_16x16x32_bf16 v[236:239], v[124:127], a[108:111], v[236:239]
    v_cvt_pk_bf16_f32 v164, v24, v25
    v_cvt_pk_bf16_f32 v165, v26, v27
    s_waitcnt lgkmcnt(8)
    v_mfma_f32_16x16x32_bf16 v[192:195], a[64:67], a[112:115], v[192:195]
    ds_read_b64_tr_b16 v[96:97], v13 offset:32768
    ds_read_b64_tr_b16 v[98:99], v13 offset:33280
    v_mfma_f32_16x16x32_bf16 v[224:227], a[64:67], a[116:119], v[224:227]
    ds_read_b64_tr_b16 v[100:101], v3 offset:32768
    ds_read_b64_tr_b16 v[102:103], v3 offset:33280
    v_mfma_f32_16x16x32_bf16 v[196:199], a[68:71], a[112:115], v[196:199]
    ds_read_b64_tr_b16 v[104:105], v4 offset:32768
    ds_read_b64_tr_b16 v[106:107], v4 offset:33280
    v_mfma_f32_16x16x32_bf16 v[228:231], a[68:71], a[116:119], v[228:231]
    ds_read_b64_tr_b16 v[108:109], v0 offset:32768
    ds_read_b64_tr_b16 v[110:111], v0 offset:33280
    v_mfma_f32_16x16x32_bf16 v[200:203], a[72:75], a[112:115], v[200:203]
    v_cvt_pk_bf16_f32 v166, v28, v29
    v_cvt_pk_bf16_f32 v167, v30, v31
    v_mfma_f32_16x16x32_bf16 v[232:235], a[72:75], a[116:119], v[232:235]
    buffer_store_dwordx4 v[164:167], v2, s[28:31], s83 offen offset:1024 sc1
    v_mfma_f32_16x16x32_bf16 v[204:207], a[76:79], a[112:115], v[204:207]
    s_add_u32 s83, s32, 2048
    v_cvt_pk_bf16_f32 v168, v32, v33
    v_cvt_pk_bf16_f32 v169, v34, v35
    v_mfma_f32_16x16x32_bf16 v[236:239], a[76:79], a[116:119], v[236:239]
    s_waitcnt vmcnt(11)
    v_cvt_pk_bf16_f32 v170, v36, v37
    v_cvt_pk_bf16_f32 v171, v38, v39
    v_mfma_f32_16x16x32_bf16 v[92:95], a[128:131], a[132:135], 0
    buffer_store_dwordx4 v[168:171], v2, s[28:31], s83 offen offset:0 sc1
    v_mfma_f32_16x16x32_bf16 v[92:95], a[136:139], a[140:143], v[92:95]
    v_cvt_pk_bf16_f32 v172, v40, v41
    v_cvt_pk_bf16_f32 v173, v42, v43
    v_mfma_f32_16x16x32_bf16 v[92:95], a[144:147], a[148:151], v[92:95]
    v_cvt_pk_bf16_f32 v174, v44, v45
    v_cvt_pk_bf16_f32 v175, v46, v47
    v_mfma_f32_16x16x32_bf16 v[92:95], a[152:155], a[156:159], v[92:95]
    buffer_store_dwordx4 v[172:175], v2, s[28:31], s83 offen offset:1024 sc1
    s_waitcnt lgkmcnt(8)
    v_mfma_f32_16x16x32_bf16 v[192:195], a[80:83], a[120:123], v[192:195]
    s_add_u32 s83, s32, 4096
    ds_read_b64_tr_b16 v[112:113], v13 offset:40960
    ds_read_b64_tr_b16 v[114:115], v13 offset:41472
    v_mfma_f32_16x16x32_bf16 v[224:227], a[80:83], a[124:127], v[224:227]
    ds_read_b64_tr_b16 v[116:117], v3 offset:40960
    ds_read_b64_tr_b16 v[118:119], v3 offset:41472
    v_mfma_f32_16x16x32_bf16 v[196:199], a[84:87], a[120:123], v[196:199]
    v_add_f32 v92, |v92|, |v93|
    v_add_f32 v94, |v94|, |v95|
    v_mfma_f32_16x16x32_bf16 v[228:231], a[84:87], a[124:127], v[228:231]
    v_add_f32 v92, v92, v94
    ds_read_b64_tr_b16 v[120:121], v4 offset:40960
    v_mfma_f32_16x16x32_bf16 v[200:203], a[88:91], a[120:123], v[200:203]
    v_cmp_ngt_f32 vcc, -v6, v92
    s_nop 0
    s_cmp_lg_u64 vcc, 0
    s_cbranch_scc1 l_spin2
    l_spin2_ok:
    v_mfma_f32_16x16x32_bf16 v[232:235], a[88:91], a[124:127], v[232:235]
    ds_read_b64_tr_b16 v[122:123], v4 offset:41472
    ds_read_b64_tr_b16 v[124:125], v0 offset:40960
    v_mfma_f32_16x16x32_bf16 v[204:207], a[92:95], a[120:123], v[204:207]
    ds_read_b64_tr_b16 v[126:127], v0 offset:41472
    v_cvt_pk_bf16_f32 v176, v48, v49
    v_mfma_f32_16x16x32_bf16 v[236:239], a[92:95], a[124:127], v[236:239]
    v_cvt_pk_bf16_f32 v177, v50, v51
    v_cvt_pk_bf16_f32 v178, v52, v53
    s_waitcnt lgkmcnt(8)
    v_mfma_f32_16x16x32_bf16 v[192:195], v[96:99], a[128:131], v[192:195]
    ds_read_b64_tr_b16 a[64:65], v13 offset:49152
    ds_read_b64_tr_b16 a[66:67], v13 offset:49664
    v_mfma_f32_16x16x32_bf16 v[224:227], v[96:99], a[132:135], v[224:227]
    ds_read_b64_tr_b16 a[68:69], v3 offset:49152
    ds_read_b64_tr_b16 a[70:71], v3 offset:49664
    v_mfma_f32_16x16x32_bf16 v[196:199], v[100:103], a[128:131], v[196:199]
    ds_read_b64_tr_b16 a[72:73], v4 offset:49152
    ds_read_b64_tr_b16 a[74:75], v4 offset:49664
    v_mfma_f32_16x16x32_bf16 v[228:231], v[100:103], a[132:135], v[228:231]
    ds_read_b64_tr_b16 a[76:77], v0 offset:49152
    ds_read_b64_tr_b16 a[78:79], v0 offset:49664
    v_mfma_f32_16x16x32_bf16 v[200:203], v[104:107], a[128:131], v[200:203]
    v_cvt_pk_bf16_f32 v179, v54, v55
    v_cmp_eq_u32 s[46:47], s37, v138
    v_mfma_f32_16x16x32_bf16 v[232:235], v[104:107], a[132:135], v[232:235]
    buffer_store_dwordx4 v[176:179], v2, s[28:31], s83 offen offset:0 sc1
    v_mfma_f32_16x16x32_bf16 v[204:207], v[108:111], a[128:131], v[204:207]
    v_cvt_pk_bf16_f32 v180, v56, v57
    v_cvt_pk_bf16_f32 v181, v58, v59
    v_mfma_f32_16x16x32_bf16 v[236:239], v[108:111], a[132:135], v[236:239]
    v_cvt_pk_bf16_f32 v182, v60, v61
    v_cvt_pk_bf16_f32 v183, v62, v63
    s_waitcnt lgkmcnt(8)
    v_mfma_f32_16x16x32_bf16 v[192:195], v[112:115], a[136:139], v[192:195]
    ds_read_b64_tr_b16 a[80:81], v13 offset:57344
    ds_read_b64_tr_b16 a[82:83], v13 offset:57856
    v_mfma_f32_16x16x32_bf16 v[224:227], v[112:115], a[140:143], v[224:227]
    ds_read_b64_tr_b16 a[84:85], v3 offset:57344
    ds_read_b64_tr_b16 a[86:87], v3 offset:57856
    v_mfma_f32_16x16x32_bf16 v[196:199], v[116:119], a[136:139], v[196:199]
    ds_read_b64_tr_b16 a[88:89], v4 offset:57344
    ds_read_b64_tr_b16 a[90:91], v4 offset:57856
    v_mfma_f32_16x16x32_bf16 v[228:231], v[116:119], a[140:143], v[228:231]
    ds_read_b64_tr_b16 a[92:93], v0 offset:57344
    ds_read_b64_tr_b16 a[94:95], v0 offset:57856
    v_mfma_f32_16x16x32_bf16 v[200:203], v[120:123], a[136:139], v[200:203]
    buffer_store_dwordx4 v[180:183], v2, s[28:31], s83 offen offset:1024 sc1
    v_mfma_f32_16x16x32_bf16 v[232:235], v[120:123], a[140:143], v[232:235]
    s_add_u32 s83, s32, 6144
    v_cvt_pk_bf16_f32 v184, v64, v65
    v_cvt_pk_bf16_f32 v185, v66, v67
    v_mfma_f32_16x16x32_bf16 v[204:207], v[124:127], a[136:139], v[204:207]
    v_cvt_pk_bf16_f32 v186, v68, v69
    v_cvt_pk_bf16_f32 v187, v70, v71
    v_mfma_f32_16x16x32_bf16 v[236:239], v[124:127], a[140:143], v[236:239]
    buffer_store_dwordx4 v[184:187], v2, s[28:31], s83 offen offset:0 sc1
    s_waitcnt lgkmcnt(8)
    v_mfma_f32_16x16x32_bf16 v[192:195], a[64:67], a[144:147], v[192:195]
    v_xor_b32 v13, 0x10000, v13
    v_xor_b32 v3, 0x10000, v3
    v_mfma_f32_16x16x32_bf16 v[224:227], a[64:67], a[148:151], v[224:227]
    v_xor_b32 v4, 0x10000, v4
    v_xor_b32 v0, 0x10000, v0
    v_mfma_f32_16x16x32_bf16 v[196:199], a[68:71], a[144:147], v[196:199]
    ds_read_b64_tr_b16 v[96:97], v13 offset:0
    ds_read_b64_tr_b16 v[98:99], v13 offset:512
    v_mfma_f32_16x16x32_bf16 v[228:231], a[68:71], a[148:151], v[228:231]
    ds_read_b64_tr_b16 v[100:101], v3 offset:0
    ds_read_b64_tr_b16 v[102:103], v3 offset:512
    v_mfma_f32_16x16x32_bf16 v[200:203], a[72:75], a[144:147], v[200:203]
    ds_read_b64_tr_b16 v[104:105], v4 offset:0
    ds_read_b64_tr_b16 v[106:107], v4 offset:512
    v_mfma_f32_16x16x32_bf16 v[232:235], a[72:75], a[148:151], v[232:235]
    ds_read_b64_tr_b16 v[108:109], v0 offset:0
    ds_read_b64_tr_b16 v[110:111], v0 offset:512
    v_mfma_f32_16x16x32_bf16 v[204:207], a[76:79], a[144:147], v[204:207]
    v_cvt_pk_bf16_f32 v188, v72, v73
    v_cvt_pk_bf16_f32 v189, v74, v75
    v_mfma_f32_16x16x32_bf16 v[236:239], a[76:79], a[148:151], v[236:239]
    s_waitcnt vmcnt(8)
    v_cvt_pk_bf16_f32 v190, v76, v77
    v_cvt_pk_bf16_f32 v191, v78, v79
    v_mfma_f32_16x16x32_bf16 v[92:95], a[0:3], a[4:7], 0
    buffer_store_dwordx4 v[188:191], v2, s[28:31], s83 offen offset:1024 sc1
    v_mfma_f32_16x16x32_bf16 v[92:95], a[8:11], a[12:15], v[92:95]
    v_cmp_eq_u32 s[64:65], s43, v138
    v_add_u32 v88, 0x800, v139
    v_mfma_f32_16x16x32_bf16 v[92:95], a[16:19], a[20:23], v[92:95]
    v_mov_b32 v89, 0x7f000000
    v_lshlrev_b32 v138, 2, v138
    v_mfma_f32_16x16x32_bf16 v[92:95], a[24:27], a[28:31], v[92:95]
    buffer_load_dword v14, v15, s[28:31], s27 offen sc1
    s_waitcnt lgkmcnt(8)
    v_mfma_f32_16x16x32_bf16 v[192:195], a[80:83], a[152:155], v[192:195]
    ds_read_b64_tr_b16 v[112:113], v13 offset:8192
    ds_read_b64_tr_b16 v[114:115], v13 offset:8704
    v_mfma_f32_16x16x32_bf16 v[224:227], a[80:83], a[156:159], v[224:227]
    ds_read_b64_tr_b16 v[116:117], v3 offset:8192
    ds_read_b64_tr_b16 v[118:119], v3 offset:8704
    v_mfma_f32_16x16x32_bf16 v[196:199], a[84:87], a[152:155], v[196:199]
    v_add_f32 v92, |v92|, |v93|
    v_add_f32 v94, |v94|, |v95|
    v_mfma_f32_16x16x32_bf16 v[228:231], a[84:87], a[156:159], v[228:231]
    v_add_f32 v92, v92, v94
    ds_read_b64_tr_b16 v[120:121], v4 offset:8192
    v_mfma_f32_16x16x32_bf16 v[200:203], a[88:91], a[152:155], v[200:203]
    v_cmp_ngt_f32 vcc, -v6, v92
    s_nop 0
    s_cmp_lg_u64 vcc, 0
    s_cbranch_scc1 l_spin3
    l_spin3_ok:
    v_mfma_f32_16x16x32_bf16 v[232:235], a[88:91], a[156:159], v[232:235]
    ds_read_b64_tr_b16 v[122:123], v4 offset:8704
    ds_read_b64_tr_b16 v[124:125], v0 offset:8192
    v_mfma_f32_16x16x32_bf16 v[204:207], a[92:95], a[152:155], v[204:207]
    ds_read_b64_tr_b16 v[126:127], v0 offset:8704
    v_cndmask_b32 v139, v89, v139, s[46:47]
    v_mfma_f32_16x16x32_bf16 v[236:239], a[92:95], a[156:159], v[236:239]
    v_cndmask_b32 v139, v139, v88, s[64:65]
    s_waitcnt lgkmcnt(8)
    v_mfma_f32_16x16x32_bf16 v[192:195], v[96:99], a[0:3], v[192:195]
    s_or_b64 s[46:47], s[46:47], s[64:65]
    ds_read_b64_tr_b16 a[64:65], v13 offset:16384
    ds_read_b64_tr_b16 a[66:67], v13 offset:16896
    v_mfma_f32_16x16x32_bf16 v[224:227], v[96:99], a[4:7], v[224:227]
    s_mov_b32 s50, 0x3404000
    ds_read_b64_tr_b16 a[68:69], v3 offset:16384
    ds_read_b64_tr_b16 a[70:71], v3 offset:16896
    v_mfma_f32_16x16x32_bf16 v[196:199], v[100:103], a[0:3], v[196:199]
    s_lshl_b32 s51, s42, 1
    ds_read_b64_tr_b16 a[72:73], v4 offset:16384
    ds_read_b64_tr_b16 a[74:75], v4 offset:16896
    v_mfma_f32_16x16x32_bf16 v[228:231], v[100:103], a[4:7], v[228:231]
    s_add_u32 s51, s51, 0x3406000
    ds_read_b64_tr_b16 a[76:77], v0 offset:16384
    ds_read_b64_tr_b16 a[78:79], v0 offset:16896
    v_mfma_f32_16x16x32_bf16 v[200:203], v[104:107], a[0:3], v[200:203]
    buffer_load_dwordx4 v[128:131], v137, s[12:15], s34 offen offset:0
    v_mfma_f32_16x16x32_bf16 v[232:235], v[104:107], a[4:7], v[232:235]
    v_mfma_f32_16x16x32_bf16 v[204:207], v[108:111], a[0:3], v[204:207]
    v_mfma_f32_16x16x32_bf16 v[236:239], v[108:111], a[4:7], v[236:239]
    buffer_load_dwordx4 v[132:135], v137, s[12:15], s34 offen offset:16
    s_waitcnt lgkmcnt(8)
    v_mfma_f32_16x16x32_bf16 v[192:195], v[112:115], a[8:11], v[192:195]
    ds_read_b64_tr_b16 a[80:81], v13 offset:24576
    ds_read_b64_tr_b16 a[82:83], v13 offset:25088
    v_mfma_f32_16x16x32_bf16 v[224:227], v[112:115], a[12:15], v[224:227]
    ds_read_b64_tr_b16 a[84:85], v3 offset:24576
    ds_read_b64_tr_b16 a[86:87], v3 offset:25088
    v_mfma_f32_16x16x32_bf16 v[196:199], v[116:119], a[8:11], v[196:199]
    ds_read_b64_tr_b16 a[88:89], v4 offset:24576
    ds_read_b64_tr_b16 a[90:91], v4 offset:25088
    v_mfma_f32_16x16x32_bf16 v[228:231], v[116:119], a[12:15], v[228:231]
    ds_read_b64_tr_b16 a[92:93], v0 offset:24576
    ds_read_b64_tr_b16 a[94:95], v0 offset:25088
    v_mfma_f32_16x16x32_bf16 v[200:203], v[120:123], a[8:11], v[200:203]
    buffer_load_dword v136, v138, s[28:31], s50 offen sc1
    v_mfma_f32_16x16x32_bf16 v[232:235], v[120:123], a[12:15], v[232:235]
    v_mfma_f32_16x16x32_bf16 v[204:207], v[124:127], a[8:11], v[204:207]
    v_mfma_f32_16x16x32_bf16 v[236:239], v[124:127], a[12:15], v[236:239]
    s_waitcnt lgkmcnt(8)
    v_mfma_f32_16x16x32_bf16 v[192:195], a[64:67], a[16:19], v[192:195]
    v_xor_b32 v13, 0x10000, v13
    v_xor_b32 v3, 0x10000, v3
    v_mfma_f32_16x16x32_bf16 v[224:227], a[64:67], a[20:23], v[224:227]
    v_xor_b32 v4, 0x10000, v4
    v_xor_b32 v0, 0x10000, v0
    v_mfma_f32_16x16x32_bf16 v[196:199], a[68:71], a[16:19], v[196:199]
    ds_read_b64_tr_b16 v[96:97], v13 offset:4096
    ds_read_b64_tr_b16 v[98:99], v13 offset:4608
    v_mfma_f32_16x16x32_bf16 v[228:231], a[68:71], a[20:23], v[228:231]
    ds_read_b64_tr_b16 v[100:101], v3 offset:4096
    ds_read_b64_tr_b16 v[102:103], v3 offset:4608
    v_mfma_f32_16x16x32_bf16 v[200:203], a[72:75], a[16:19], v[200:203]
    ds_read_b64_tr_b16 v[104:105], v4 offset:4096
    ds_read_b64_tr_b16 v[106:107], v4 offset:4608
    v_mfma_f32_16x16x32_bf16 v[232:235], a[72:75], a[20:23], v[232:235]
    ds_read_b64_tr_b16 v[108:109], v0 offset:4096
    ds_read_b64_tr_b16 v[110:111], v0 offset:4608
    v_mfma_f32_16x16x32_bf16 v[204:207], a[76:79], a[16:19], v[204:207]
    v_mfma_f32_16x16x32_bf16 v[236:239], a[76:79], a[20:23], v[236:239]
    s_waitcnt lgkmcnt(8)
    v_mfma_f32_16x16x32_bf16 v[192:195], a[80:83], a[24:27], v[192:195]
    ds_read_b64_tr_b16 v[112:113], v13 offset:12288
    ds_read_b64_tr_b16 v[114:115], v13 offset:12800
    v_mfma_f32_16x16x32_bf16 v[224:227], a[80:83], a[28:31], v[224:227]
    ds_read_b64_tr_b16 v[116:117], v3 offset:12288
    ds_read_b64_tr_b16 v[118:119], v3 offset:12800
    v_mfma_f32_16x16x32_bf16 v[196:199], a[84:87], a[24:27], v[196:199]
    ds_read_b64_tr_b16 v[120:121], v4 offset:12288
    ds_read_b64_tr_b16 v[122:123], v4 offset:12800
    v_mfma_f32_16x16x32_bf16 v[228:231], a[84:87], a[28:31], v[228:231]
    ds_read_b64_tr_b16 v[124:125], v0 offset:12288
    ds_read_b64_tr_b16 v[126:127], v0 offset:12800
    v_mfma_f32_16x16x32_bf16 v[200:203], a[88:91], a[24:27], v[200:203]
    v_mfma_f32_16x16x32_bf16 v[232:235], a[88:91], a[28:31], v[232:235]
    v_mfma_f32_16x16x32_bf16 v[204:207], a[92:95], a[24:27], v[204:207]
    v_mfma_f32_16x16x32_bf16 v[236:239], a[92:95], a[28:31], v[236:239]
    s_waitcnt lgkmcnt(8)
    v_mfma_f32_16x16x32_bf16 v[208:211], v[96:99], a[96:99], v[208:211]
    ds_read_b64_tr_b16 a[64:65], v13 offset:20480
    ds_read_b64_tr_b16 a[66:67], v13 offset:20992
    v_mfma_f32_16x16x32_bf16 v[240:243], v[96:99], a[100:103], v[240:243]
    ds_read_b64_tr_b16 a[68:69], v3 offset:20480
    ds_read_b64_tr_b16 a[70:71], v3 offset:20992
    v_mfma_f32_16x16x32_bf16 v[212:215], v[100:103], a[96:99], v[212:215]
    ds_read_b64_tr_b16 a[72:73], v4 offset:20480
    ds_read_b64_tr_b16 a[74:75], v4 offset:20992
    v_mfma_f32_16x16x32_bf16 v[244:247], v[100:103], a[100:103], v[244:247]
    ds_read_b64_tr_b16 a[76:77], v0 offset:20480
    ds_read_b64_tr_b16 a[78:79], v0 offset:20992
    v_mfma_f32_16x16x32_bf16 v[216:219], v[104:107], a[96:99], v[216:219]
    v_mfma_f32_16x16x32_bf16 v[248:251], v[104:107], a[100:103], v[248:251]
    v_mfma_f32_16x16x32_bf16 v[220:223], v[108:111], a[96:99], v[220:223]
    v_mfma_f32_16x16x32_bf16 v[252:255], v[108:111], a[100:103], v[252:255]
    s_waitcnt lgkmcnt(8)
    v_mfma_f32_16x16x32_bf16 v[208:211], v[112:115], a[104:107], v[208:211]
    s_add_u32 s83, s32, 8192
    ds_read_b64_tr_b16 a[80:81], v13 offset:28672
    ds_read_b64_tr_b16 a[82:83], v13 offset:29184
    v_mfma_f32_16x16x32_bf16 v[240:243], v[112:115], a[108:111], v[240:243]
    ds_read_b64_tr_b16 a[84:85], v3 offset:28672
    ds_read_b64_tr_b16 a[86:87], v3 offset:29184
    v_mfma_f32_16x16x32_bf16 v[212:215], v[116:119], a[104:107], v[212:215]
    ds_read_b64_tr_b16 a[88:89], v4 offset:28672
    ds_read_b64_tr_b16 a[90:91], v4 offset:29184
    v_mfma_f32_16x16x32_bf16 v[244:247], v[116:119], a[108:111], v[244:247]
    ds_read_b64_tr_b16 a[92:93], v0 offset:28672
    ds_read_b64_tr_b16 a[94:95], v0 offset:29184
    v_mfma_f32_16x16x32_bf16 v[216:219], v[120:123], a[104:107], v[216:219]
    v_cvt_pk_bf16_f32 v160, v192, v193
    v_cvt_pk_bf16_f32 v161, v194, v195
    v_mfma_f32_16x16x32_bf16 v[248:251], v[120:123], a[108:111], v[248:251]
    v_cvt_pk_bf16_f32 v162, v196, v197
    v_cvt_pk_bf16_f32 v163, v198, v199
    v_mfma_f32_16x16x32_bf16 v[220:223], v[124:127], a[104:107], v[220:223]
    buffer_store_dwordx4 v[160:163], v2, s[28:31], s83 offen offset:0 sc1
    v_mfma_f32_16x16x32_bf16 v[252:255], v[124:127], a[108:111], v[252:255]
    v_cvt_pk_bf16_f32 v164, v200, v201
    v_cvt_pk_bf16_f32 v165, v202, v203
    s_waitcnt lgkmcnt(8)
    v_mfma_f32_16x16x32_bf16 v[208:211], a[64:67], a[112:115], v[208:211]
    ds_read_b64_tr_b16 v[96:97], v13 offset:36864
    ds_read_b64_tr_b16 v[98:99], v13 offset:37376
    v_mfma_f32_16x16x32_bf16 v[240:243], a[64:67], a[116:119], v[240:243]
    ds_read_b64_tr_b16 v[100:101], v3 offset:36864
    ds_read_b64_tr_b16 v[102:103], v3 offset:37376
    v_mfma_f32_16x16x32_bf16 v[212:215], a[68:71], a[112:115], v[212:215]
    ds_read_b64_tr_b16 v[104:105], v4 offset:36864
    ds_read_b64_tr_b16 v[106:107], v4 offset:37376
    v_mfma_f32_16x16x32_bf16 v[244:247], a[68:71], a[116:119], v[244:247]
    ds_read_b64_tr_b16 v[108:109], v0 offset:36864
    ds_read_b64_tr_b16 v[110:111], v0 offset:37376
    v_mfma_f32_16x16x32_bf16 v[216:219], a[72:75], a[112:115], v[216:219]
    v_cvt_pk_bf16_f32 v166, v204, v205
    v_cvt_pk_bf16_f32 v167, v206, v207
    v_mfma_f32_16x16x32_bf16 v[248:251], a[72:75], a[116:119], v[248:251]
    buffer_store_dwordx4 v[164:167], v2, s[28:31], s83 offen offset:1024 sc1
    v_mfma_f32_16x16x32_bf16 v[220:223], a[76:79], a[112:115], v[220:223]
    s_add_u32 s83, s32, 12288
    v_cvt_pk_bf16_f32 v176, v224, v225
    v_cvt_pk_bf16_f32 v177, v226, v227
    v_mfma_f32_16x16x32_bf16 v[252:255], a[76:79], a[116:119], v[252:255]
    v_cvt_pk_bf16_f32 v178, v228, v229
    v_cvt_pk_bf16_f32 v179, v230, v231
    s_waitcnt lgkmcnt(8)
    v_mfma_f32_16x16x32_bf16 v[208:211], a[80:83], a[120:123], v[208:211]
    ds_read_b64_tr_b16 v[112:113], v13 offset:45056
    ds_read_b64_tr_b16 v[114:115], v13 offset:45568
    v_mfma_f32_16x16x32_bf16 v[240:243], a[80:83], a[124:127], v[240:243]
    ds_read_b64_tr_b16 v[116:117], v3 offset:45056
    ds_read_b64_tr_b16 v[118:119], v3 offset:45568
    v_mfma_f32_16x16x32_bf16 v[212:215], a[84:87], a[120:123], v[212:215]
    ds_read_b64_tr_b16 v[120:121], v4 offset:45056
    ds_read_b64_tr_b16 v[122:123], v4 offset:45568
    v_mfma_f32_16x16x32_bf16 v[244:247], a[84:87], a[124:127], v[244:247]
    ds_read_b64_tr_b16 v[124:125], v0 offset:45056
    ds_read_b64_tr_b16 v[126:127], v0 offset:45568
    v_mfma_f32_16x16x32_bf16 v[216:219], a[88:91], a[120:123], v[216:219]
    buffer_store_dwordx4 v[176:179], v2, s[28:31], s83 offen offset:0 sc1
    v_mfma_f32_16x16x32_bf16 v[248:251], a[88:91], a[124:127], v[248:251]
    v_cvt_pk_bf16_f32 v180, v232, v233
    v_cvt_pk_bf16_f32 v181, v234, v235
    v_mfma_f32_16x16x32_bf16 v[220:223], a[92:95], a[120:123], v[220:223]
    v_cvt_pk_bf16_f32 v182, v236, v237
    v_cvt_pk_bf16_f32 v183, v238, v239
    v_mfma_f32_16x16x32_bf16 v[252:255], a[92:95], a[124:127], v[252:255]
    buffer_store_dwordx4 v[180:183], v2, s[28:31], s83 offen offset:1024 sc1
    s_waitcnt lgkmcnt(8)
    v_mfma_f32_16x16x32_bf16 v[208:211], v[96:99], a[128:131], v[208:211]
    ds_read_b64_tr_b16 a[64:65], v13 offset:53248
    ds_read_b64_tr_b16 a[66:67], v13 offset:53760
    v_mfma_f32_16x16x32_bf16 v[240:243], v[96:99], a[132:135], v[240:243]
    ds_read_b64_tr_b16 a[68:69], v3 offset:53248
    ds_read_b64_tr_b16 a[70:71], v3 offset:53760
    v_mfma_f32_16x16x32_bf16 v[212:215], v[100:103], a[128:131], v[212:215]
    ds_read_b64_tr_b16 a[72:73], v4 offset:53248
    ds_read_b64_tr_b16 a[74:75], v4 offset:53760
    v_mfma_f32_16x16x32_bf16 v[244:247], v[100:103], a[132:135], v[244:247]
    ds_read_b64_tr_b16 a[76:77], v0 offset:53248
    ds_read_b64_tr_b16 a[78:79], v0 offset:53760
    v_mfma_f32_16x16x32_bf16 v[216:219], v[104:107], a[128:131], v[216:219]
    v_mfma_f32_16x16x32_bf16 v[248:251], v[104:107], a[132:135], v[248:251]
    v_mfma_f32_16x16x32_bf16 v[220:223], v[108:111], a[128:131], v[220:223]
    v_mfma_f32_16x16x32_bf16 v[252:255], v[108:111], a[132:135], v[252:255]
    s_waitcnt lgkmcnt(8)
    v_mfma_f32_16x16x32_bf16 v[208:211], v[112:115], a[136:139], v[208:211]
    ds_read_b64_tr_b16 a[80:81], v13 offset:61440
    ds_read_b64_tr_b16 a[82:83], v13 offset:61952
    v_mfma_f32_16x16x32_bf16 v[240:243], v[112:115], a[140:143], v[240:243]
    ds_read_b64_tr_b16 a[84:85], v3 offset:61440
    ds_read_b64_tr_b16 a[86:87], v3 offset:61952
    v_mfma_f32_16x16x32_bf16 v[212:215], v[116:119], a[136:139], v[212:215]
    ds_read_b64_tr_b16 a[88:89], v4 offset:61440
    ds_read_b64_tr_b16 a[90:91], v4 offset:61952
    v_mfma_f32_16x16x32_bf16 v[244:247], v[116:119], a[140:143], v[244:247]
    ds_read_b64_tr_b16 a[92:93], v0 offset:61440
    ds_read_b64_tr_b16 a[94:95], v0 offset:61952
    v_mfma_f32_16x16x32_bf16 v[216:219], v[120:123], a[136:139], v[216:219]
    v_mfma_f32_16x16x32_bf16 v[248:251], v[120:123], a[140:143], v[248:251]
    v_mfma_f32_16x16x32_bf16 v[220:223], v[124:127], a[136:139], v[220:223]
    v_mfma_f32_16x16x32_bf16 v[252:255], v[124:127], a[140:143], v[252:255]
    s_waitcnt lgkmcnt(8)
    v_mfma_f32_16x16x32_bf16 v[208:211], a[64:67], a[144:147], v[208:211]
    v_xor_b32 v13, 0x10000, v13
    v_xor_b32 v3, 0x10000, v3
    v_mfma_f32_16x16x32_bf16 v[240:243], a[64:67], a[148:151], v[240:243]
    v_xor_b32 v4, 0x10000, v4
    v_xor_b32 v0, 0x10000, v0
    v_mfma_f32_16x16x32_bf16 v[212:215], a[68:71], a[144:147], v[212:215]
    ds_read_b64_tr_b16 v[96:97], v13 offset:4096
    ds_read_b64_tr_b16 v[98:99], v13 offset:4608
    v_mfma_f32_16x16x32_bf16 v[244:247], a[68:71], a[148:151], v[244:247]
    ds_read_b64_tr_b16 v[100:101], v3 offset:4096
    ds_read_b64_tr_b16 v[102:103], v3 offset:4608
    v_mfma_f32_16x16x32_bf16 v[216:219], a[72:75], a[144:147], v[216:219]
    ds_read_b64_tr_b16 v[104:105], v4 offset:4096
    ds_read_b64_tr_b16 v[106:107], v4 offset:4608
    v_mfma_f32_16x16x32_bf16 v[248:251], a[72:75], a[148:151], v[248:251]
    ds_read_b64_tr_b16 v[108:109], v0 offset:4096
    ds_read_b64_tr_b16 v[110:111], v0 offset:4608
    v_mfma_f32_16x16x32_bf16 v[220:223], a[76:79], a[144:147], v[220:223]
    v_mfma_f32_16x16x32_bf16 v[252:255], a[76:79], a[148:151], v[252:255]
    s_waitcnt lgkmcnt(8)
    v_mfma_f32_16x16x32_bf16 v[208:211], a[80:83], a[152:155], v[208:211]
    ds_read_b64_tr_b16 v[112:113], v13 offset:12288
    ds_read_b64_tr_b16 v[114:115], v13 offset:12800
    v_mfma_f32_16x16x32_bf16 v[240:243], a[80:83], a[156:159], v[240:243]
    ds_read_b64_tr_b16 v[116:117], v3 offset:12288
    ds_read_b64_tr_b16 v[118:119], v3 offset:12800
    v_mfma_f32_16x16x32_bf16 v[212:215], a[84:87], a[152:155], v[212:215]
    ds_read_b64_tr_b16 v[120:121], v4 offset:12288
    ds_read_b64_tr_b16 v[122:123], v4 offset:12800
    v_mfma_f32_16x16x32_bf16 v[244:247], a[84:87], a[156:159], v[244:247]
    ds_read_b64_tr_b16 v[124:125], v0 offset:12288
    ds_read_b64_tr_b16 v[126:127], v0 offset:12800
    v_mfma_f32_16x16x32_bf16 v[216:219], a[88:91], a[152:155], v[216:219]
    v_mfma_f32_16x16x32_bf16 v[248:251], a[88:91], a[156:159], v[248:251]
    v_mfma_f32_16x16x32_bf16 v[220:223], a[92:95], a[152:155], v[220:223]
    v_mfma_f32_16x16x32_bf16 v[252:255], a[92:95], a[156:159], v[252:255]
    s_waitcnt lgkmcnt(8)
    v_mfma_f32_16x16x32_bf16 v[208:211], v[96:99], a[0:3], v[208:211]
    s_waitcnt vmcnt(4)
    ds_read_b64_tr_b16 a[64:65], v13 offset:20480
    ds_read_b64_tr_b16 a[66:67], v13 offset:20992
    v_mfma_f32_16x16x32_bf16 v[240:243], v[96:99], a[4:7], v[240:243]
    ds_read_b64_tr_b16 a[68:69], v3 offset:20480
    ds_read_b64_tr_b16 a[70:71], v3 offset:20992
    v_mfma_f32_16x16x32_bf16 v[212:215], v[100:103], a[0:3], v[212:215]
    ds_read_b64_tr_b16 a[72:73], v4 offset:20480
    ds_read_b64_tr_b16 a[74:75], v4 offset:20992
    v_mfma_f32_16x16x32_bf16 v[244:247], v[100:103], a[4:7], v[244:247]
    ds_read_b64_tr_b16 a[76:77], v0 offset:20480
    ds_read_b64_tr_b16 a[78:79], v0 offset:20992
    v_mfma_f32_16x16x32_bf16 v[216:219], v[104:107], a[0:3], v[216:219]
    v_and_b32 v14, 2, v14
    v_cndmask_b32 v14, 1, v14, s[72:73]
    v_mfma_f32_16x16x32_bf16 v[248:251], v[104:107], a[4:7], v[248:251]
    v_min_u32 v88, v136, v14
    v_mfma_f32_16x16x32_bf16 v[220:223], v[108:111], a[0:3], v[220:223]
    v_cmp_eq_u32 vcc, 0, v88
    s_nop 0
    s_cmp_lg_u64 vcc, 0
    s_cbranch_scc1 f_spin
    f_spin_ok:
    v_mfma_f32_16x16x32_bf16 v[252:255], v[108:111], a[4:7], v[252:255]
    v_permlane16_swap_b32 v128, v130
    v_permlane16_swap_b32 v129, v131
    s_waitcnt lgkmcnt(8)
    v_mfma_f32_16x16x32_bf16 v[208:211], v[112:115], a[8:11], v[208:211]
    ds_read_b64_tr_b16 a[80:81], v13 offset:28672
    ds_read_b64_tr_b16 a[82:83], v13 offset:29184
    v_mfma_f32_16x16x32_bf16 v[240:243], v[112:115], a[12:15], v[240:243]
    ds_read_b64_tr_b16 a[84:85], v3 offset:28672
    ds_read_b64_tr_b16 a[86:87], v3 offset:29184
    v_mfma_f32_16x16x32_bf16 v[212:215], v[116:119], a[8:11], v[212:215]
    ds_read_b64_tr_b16 a[88:89], v4 offset:28672
    ds_read_b64_tr_b16 a[90:91], v4 offset:29184
    v_mfma_f32_16x16x32_bf16 v[244:247], v[116:119], a[12:15], v[244:247]
    ds_read_b64_tr_b16 a[92:93], v0 offset:28672
    ds_read_b64_tr_b16 a[94:95], v0 offset:29184
    v_mfma_f32_16x16x32_bf16 v[216:219], v[120:123], a[8:11], v[216:219]
    v_permlane16_swap_b32 v132, v134
    v_permlane16_swap_b32 v133, v135
    v_mfma_f32_16x16x32_bf16 v[248:251], v[120:123], a[12:15], v[248:251]
    s_nop 0
    v_lshlrev_b32 v140, 16, v128
    v_and_b32 v141, 0xffff0000, v128
    v_mfma_f32_16x16x32_bf16 v[220:223], v[124:127], a[8:11], v[220:223]
    v_lshlrev_b32 v142, 16, v129
    v_and_b32 v143, 0xffff0000, v129
    v_mfma_f32_16x16x32_bf16 v[252:255], v[124:127], a[12:15], v[252:255]
    v_lshlrev_b32 v144, 16, v132
    v_and_b32 v145, 0xffff0000, v132
    s_waitcnt lgkmcnt(8)
    v_mfma_f32_16x16x32_bf16 v[208:211], a[64:67], a[16:19], v[208:211]
    v_lshlrev_b32 v146, 16, v133
    v_and_b32 v147, 0xffff0000, v133
    v_mfma_f32_16x16x32_bf16 v[240:243], a[64:67], a[20:23], v[240:243]
    v_lshlrev_b32 v148, 16, v130
    v_and_b32 v149, 0xffff0000, v130
    v_mfma_f32_16x16x32_bf16 v[212:215], a[68:71], a[16:19], v[212:215]
    v_lshlrev_b32 v150, 16, v131
    v_and_b32 v151, 0xffff0000, v131
    v_mfma_f32_16x16x32_bf16 v[244:247], a[68:71], a[20:23], v[244:247]
    v_lshlrev_b32 v152, 16, v134
    v_and_b32 v153, 0xffff0000, v134
    v_mfma_f32_16x16x32_bf16 v[216:219], a[72:75], a[16:19], v[216:219]
    v_lshlrev_b32 v154, 16, v135
    v_and_b32 v155, 0xffff0000, v135
    v_mfma_f32_16x16x32_bf16 v[248:251], a[72:75], a[20:23], v[248:251]
    s_add_u32 s65, s33, 0x40000
    v_mfma_f32_16x16x32_bf16 v[220:223], a[76:79], a[16:19], v[220:223]
    s_add_u32 s66, s33, 0x80000
    v_mfma_f32_16x16x32_bf16 v[252:255], a[76:79], a[20:23], v[252:255]
    s_add_u32 s67, s33, 0xc0000
    s_waitcnt lgkmcnt(0)
    v_mfma_f32_16x16x32_bf16 v[208:211], a[80:83], a[24:27], v[208:211]
    s_add_u32 s68, s33, 0x100000
    v_mfma_f32_16x16x32_bf16 v[240:243], a[80:83], a[28:31], v[240:243]
    s_add_u32 s69, s33, 0x140000
    v_mfma_f32_16x16x32_bf16 v[212:215], a[84:87], a[24:27], v[212:215]
    s_add_u32 s70, s33, 0x180000
    v_mfma_f32_16x16x32_bf16 v[244:247], a[84:87], a[28:31], v[244:247]
    s_add_u32 s71, s33, 0x1c0000
    v_mfma_f32_16x16x32_bf16 v[216:219], a[88:91], a[24:27], v[216:219]
    v_mfma_f32_16x16x32_bf16 v[248:251], a[88:91], a[28:31], v[248:251]
    v_mfma_f32_16x16x32_bf16 v[220:223], a[92:95], a[24:27], v[220:223]
    v_mfma_f32_16x16x32_bf16 v[252:255], a[92:95], a[28:31], v[252:255]
    s_nop 5
    s_add_u32 s83, s32, 10240
    v_cvt_pk_bf16_f32 v168, v208, v209
    v_cvt_pk_bf16_f32 v169, v210, v211
    v_cvt_pk_bf16_f32 v170, v212, v213
    v_cvt_pk_bf16_f32 v171, v214, v215
    buffer_store_dwordx4 v[168:171], v2, s[28:31], s83 offen offset:0 sc1
    v_cvt_pk_bf16_f32 v172, v216, v217
    v_cvt_pk_bf16_f32 v173, v218, v219
    v_cvt_pk_bf16_f32 v174, v220, v221
    v_cvt_pk_bf16_f32 v175, v222, v223
    buffer_store_dwordx4 v[172:175], v2, s[28:31], s83 offen offset:1024 sc1
    s_add_u32 s83, s32, 14336
    v_cvt_pk_bf16_f32 v184, v240, v241
    v_cvt_pk_bf16_f32 v185, v242, v243
    v_cvt_pk_bf16_f32 v186, v244, v245
    v_cvt_pk_bf16_f32 v187, v246, v247
    buffer_store_dwordx4 v[184:187], v2, s[28:31], s83 offen offset:0 sc1
    v_cvt_pk_bf16_f32 v188, v248, v249
    v_cvt_pk_bf16_f32 v189, v250, v251
    v_cvt_pk_bf16_f32 v190, v252, v253
    v_cvt_pk_bf16_f32 v191, v254, v255
    buffer_store_dwordx4 v[188:191], v2, s[28:31], s83 offen offset:1024 sc1
    s_cmp_lg_u64 s[46:47], 0
    s_cbranch_scc1 y_spin
y_spin_ok:
    s_mov_b32 s49, 0
g_loop:
    buffer_load_dwordx4 v[192:195], v2, s[28:31], s33 offen offset:0 sc1
    buffer_load_dwordx4 v[196:199], v2, s[28:31], s33 offen offset:1024 sc1
    buffer_load_dwordx4 v[200:203], v2, s[28:31], s65 offen offset:0 sc1
    buffer_load_dwordx4 v[204:207], v2, s[28:31], s65 offen offset:1024 sc1
    buffer_load_dwordx4 v[208:211], v2, s[28:31], s66 offen offset:0 sc1
    buffer_load_dwordx4 v[212:215], v2, s[28:31], s66 offen offset:1024 sc1
    buffer_load_dwordx4 v[216:219], v2, s[28:31], s67 offen offset:0 sc1
    buffer_load_dwordx4 v[220:223], v2, s[28:31], s67 offen offset:1024 sc1
    buffer_load_dwordx4 v[224:227], v2, s[28:31], s68 offen offset:0 sc1
    buffer_load_dwordx4 v[228:231], v2, s[28:31], s68 offen offset:1024 sc1
    buffer_load_dwordx4 v[232:235], v2, s[28:31], s69 offen offset:0 sc1
    buffer_load_dwordx4 v[236:239], v2, s[28:31], s69 offen offset:1024 sc1
    buffer_load_dwordx4 v[240:243], v2, s[28:31], s70 offen offset:0 sc1
    buffer_load_dwordx4 v[244:247], v2, s[28:31], s70 offen offset:1024 sc1
    buffer_load_dwordx4 v[248:251], v2, s[28:31], s71 offen offset:0 sc1
    buffer_load_dwordx4 v[252:255], v2, s[28:31], s71 offen offset:1024 sc1
    s_waitcnt vmcnt(14)
    v_lshlrev_b32 v32, 16, v192
    v_and_b32 v33, 0xffff0000, v192
    v_lshlrev_b32 v34, 16, v193
    v_and_b32 v35, 0xffff0000, v193
    v_lshlrev_b32 v36, 16, v194
    v_and_b32 v37, 0xffff0000, v194
    v_lshlrev_b32 v38, 16, v195
    v_and_b32 v39, 0xffff0000, v195
    v_lshlrev_b32 v40, 16, v196
    v_and_b32 v41, 0xffff0000, v196
    v_lshlrev_b32 v42, 16, v197
    v_and_b32 v43, 0xffff0000, v197
    v_lshlrev_b32 v44, 16, v198
    v_and_b32 v45, 0xffff0000, v198
    v_lshlrev_b32 v46, 16, v199
    v_and_b32 v47, 0xffff0000, v199
    s_waitcnt vmcnt(12)
    v_lshlrev_b32 v48, 16, v200
    v_and_b32 v49, 0xffff0000, v200
    v_lshlrev_b32 v50, 16, v201
    v_and_b32 v51, 0xffff0000, v201
    v_lshlrev_b32 v52, 16, v202
    v_and_b32 v53, 0xffff0000, v202
    v_lshlrev_b32 v54, 16, v203
    v_and_b32 v55, 0xffff0000, v203
    v_lshlrev_b32 v56, 16, v204
    v_and_b32 v57, 0xffff0000, v204
    v_lshlrev_b32 v58, 16, v205
    v_and_b32 v59, 0xffff0000, v205
    v_lshlrev_b32 v60, 16, v206
    v_and_b32 v61, 0xffff0000, v206
    v_lshlrev_b32 v62, 16, v207
    v_and_b32 v63, 0xffff0000, v207
    v_pk_add_f32 v[32:33], v[32:33], v[48:49]
    v_pk_add_f32 v[34:35], v[34:35], v[50:51]
    v_pk_add_f32 v[36:37], v[36:37], v[52:53]
    v_pk_add_f32 v[38:39], v[38:39], v[54:55]
    v_pk_add_f32 v[40:41], v[40:41], v[56:57]
    v_pk_add_f32 v[42:43], v[42:43], v[58:59]
    v_pk_add_f32 v[44:45], v[44:45], v[60:61]
    v_pk_add_f32 v[46:47], v[46:47], v[62:63]
    s_waitcnt vmcnt(10)
    v_lshlrev_b32 v48, 16, v208
    v_and_b32 v49, 0xffff0000, v208
    v_lshlrev_b32 v50, 16, v209
    v_and_b32 v51, 0xffff0000, v209
    v_lshlrev_b32 v52, 16, v210
    v_and_b32 v53, 0xffff0000, v210
    v_lshlrev_b32 v54, 16, v211
    v_and_b32 v55, 0xffff0000, v211
    v_lshlrev_b32 v56, 16, v212
    v_and_b32 v57, 0xffff0000, v212
    v_lshlrev_b32 v58, 16, v213
    v_and_b32 v59, 0xffff0000, v213
    v_lshlrev_b32 v60, 16, v214
    v_and_b32 v61, 0xffff0000, v214
    v_lshlrev_b32 v62, 16, v215
    v_and_b32 v63, 0xffff0000, v215
    v_pk_add_f32 v[32:33], v[32:33], v[48:49]
    v_pk_add_f32 v[34:35], v[34:35], v[50:51]
    v_pk_add_f32 v[36:37], v[36:37], v[52:53]
    v_pk_add_f32 v[38:39], v[38:39], v[54:55]
    v_pk_add_f32 v[40:41], v[40:41], v[56:57]
    v_pk_add_f32 v[42:43], v[42:43], v[58:59]
    v_pk_add_f32 v[44:45], v[44:45], v[60:61]
    v_pk_add_f32 v[46:47], v[46:47], v[62:63]
    s_waitcnt vmcnt(8)
    v_lshlrev_b32 v48, 16, v216
    v_and_b32 v49, 0xffff0000, v216
    v_lshlrev_b32 v50, 16, v217
    v_and_b32 v51, 0xffff0000, v217
    v_lshlrev_b32 v52, 16, v218
    v_and_b32 v53, 0xffff0000, v218
    v_lshlrev_b32 v54, 16, v219
    v_and_b32 v55, 0xffff0000, v219
    v_lshlrev_b32 v56, 16, v220
    v_and_b32 v57, 0xffff0000, v220
    v_lshlrev_b32 v58, 16, v221
    v_and_b32 v59, 0xffff0000, v221
    v_lshlrev_b32 v60, 16, v222
    v_and_b32 v61, 0xffff0000, v222
    v_lshlrev_b32 v62, 16, v223
    v_and_b32 v63, 0xffff0000, v223
    v_pk_add_f32 v[32:33], v[32:33], v[48:49]
    v_pk_add_f32 v[34:35], v[34:35], v[50:51]
    v_pk_add_f32 v[36:37], v[36:37], v[52:53]
    v_pk_add_f32 v[38:39], v[38:39], v[54:55]
    v_pk_add_f32 v[40:41], v[40:41], v[56:57]
    v_pk_add_f32 v[42:43], v[42:43], v[58:59]
    v_pk_add_f32 v[44:45], v[44:45], v[60:61]
    v_pk_add_f32 v[46:47], v[46:47], v[62:63]
    s_waitcnt vmcnt(6)
    v_lshlrev_b32 v48, 16, v224
    v_and_b32 v49, 0xffff0000, v224
    v_lshlrev_b32 v50, 16, v225
    v_and_b32 v51, 0xffff0000, v225
    v_lshlrev_b32 v52, 16, v226
    v_and_b32 v53, 0xffff0000, v226
    v_lshlrev_b32 v54, 16, v227
    v_and_b32 v55, 0xffff0000, v227
    v_lshlrev_b32 v56, 16, v228
    v_and_b32 v57, 0xffff0000, v228
    v_lshlrev_b32 v58, 16, v229
    v_and_b32 v59, 0xffff0000, v229
    v_lshlrev_b32 v60, 16, v230
    v_and_b32 v61, 0xffff0000, v230
    v_lshlrev_b32 v62, 16, v231
    v_and_b32 v63, 0xffff0000, v231
    v_pk_add_f32 v[32:33], v[32:33], v[48:49]
    v_pk_add_f32 v[34:35], v[34:35], v[50:51]
    v_pk_add_f32 v[36:37], v[36:37], v[52:53]
    v_pk_add_f32 v[38:39], v[38:39], v[54:55]
    v_pk_add_f32 v[40:41], v[40:41], v[56:57]
    v_pk_add_f32 v[42:43], v[42:43], v[58:59]
    v_pk_add_f32 v[44:45], v[44:45], v[60:61]
    v_pk_add_f32 v[46:47], v[46:47], v[62:63]
    s_waitcnt vmcnt(4)
    v_lshlrev_b32 v48, 16, v232
    v_and_b32 v49, 0xffff0000, v232
    v_lshlrev_b32 v50, 16, v233
    v_and_b32 v51, 0xffff0000, v233
    v_lshlrev_b32 v52, 16, v234
    v_and_b32 v53, 0xffff0000, v234
    v_lshlrev_b32 v54, 16, v235
    v_and_b32 v55, 0xffff0000, v235
    v_lshlrev_b32 v56, 16, v236
    v_and_b32 v57, 0xffff0000, v236
    v_lshlrev_b32 v58, 16, v237
    v_and_b32 v59, 0xffff0000, v237
    v_lshlrev_b32 v60, 16, v238
    v_and_b32 v61, 0xffff0000, v238
    v_lshlrev_b32 v62, 16, v239
    v_and_b32 v63, 0xffff0000, v239
    v_pk_add_f32 v[32:33], v[32:33], v[48:49]
    v_pk_add_f32 v[34:35], v[34:35], v[50:51]
    v_pk_add_f32 v[36:37], v[36:37], v[52:53]
    v_pk_add_f32 v[38:39], v[38:39], v[54:55]
    v_pk_add_f32 v[40:41], v[40:41], v[56:57]
    v_pk_add_f32 v[42:43], v[42:43], v[58:59]
    v_pk_add_f32 v[44:45], v[44:45], v[60:61]
    v_pk_add_f32 v[46:47], v[46:47], v[62:63]
    s_waitcnt vmcnt(2)
    v_lshlrev_b32 v48, 16, v240
    v_and_b32 v49, 0xffff0000, v240
    v_lshlrev_b32 v50, 16, v241
    v_and_b32 v51, 0xffff0000, v241
    v_lshlrev_b32 v52, 16, v242
    v_and_b32 v53, 0xffff0000, v242
    v_lshlrev_b32 v54, 16, v243
    v_and_b32 v55, 0xffff0000, v243
    v_lshlrev_b32 v56, 16, v244
    v_and_b32 v57, 0xffff0000, v244
    v_lshlrev_b32 v58, 16, v245
    v_and_b32 v59, 0xffff0000, v245
    v_lshlrev_b32 v60, 16, v246
    v_and_b32 v61, 0xffff0000, v246
    v_lshlrev_b32 v62, 16, v247
    v_and_b32 v63, 0xffff0000, v247
    v_pk_add_f32 v[32:33], v[32:33], v[48:49]
    v_pk_add_f32 v[34:35], v[34:35], v[50:51]
    v_pk_add_f32 v[36:37], v[36:37], v[52:53]
    v_pk_add_f32 v[38:39], v[38:39], v[54:55]
    v_pk_add_f32 v[40:41], v[40:41], v[56:57]
    v_pk_add_f32 v[42:43], v[42:43], v[58:59]
    v_pk_add_f32 v[44:45], v[44:45], v[60:61]
    v_pk_add_f32 v[46:47], v[46:47], v[62:63]
    s_waitcnt vmcnt(0)
    v_lshlrev_b32 v48, 16, v248
    v_and_b32 v49, 0xffff0000, v248
    v_lshlrev_b32 v50, 16, v249
    v_and_b32 v51, 0xffff0000, v249
    v_lshlrev_b32 v52, 16, v250
    v_and_b32 v53, 0xffff0000, v250
    v_lshlrev_b32 v54, 16, v251
    v_and_b32 v55, 0xffff0000, v251
    v_lshlrev_b32 v56, 16, v252
    v_and_b32 v57, 0xffff0000, v252
    v_lshlrev_b32 v58, 16, v253
    v_and_b32 v59, 0xffff0000, v253
    v_lshlrev_b32 v60, 16, v254
    v_and_b32 v61, 0xffff0000, v254
    v_lshlrev_b32 v62, 16, v255
    v_and_b32 v63, 0xffff0000, v255
    v_pk_add_f32 v[32:33], v[32:33], v[48:49]
    v_pk_add_f32 v[34:35], v[34:35], v[50:51]
    v_pk_add_f32 v[36:37], v[36:37], v[52:53]
    v_pk_add_f32 v[38:39], v[38:39], v[54:55]
    v_pk_add_f32 v[40:41], v[40:41], v[56:57]
    v_pk_add_f32 v[42:43], v[42:43], v[58:59]
    v_pk_add_f32 v[44:45], v[44:45], v[60:61]
    v_pk_add_f32 v[46:47], v[46:47], v[62:63]
    v_pk_add_f32 v[48:49], v[32:33], v[40:41]
    v_pk_add_f32 v[50:51], v[34:35], v[42:43]
    v_pk_add_f32 v[52:53], v[36:37], v[44:45]
    v_pk_add_f32 v[54:55], v[38:39], v[46:47]
    v_pk_add_f32 v[32:33], v[32:33], v[140:141] neg_lo:[0,1] neg_hi:[0,1]
    v_pk_add_f32 v[34:35], v[34:35], v[142:143] neg_lo:[0,1] neg_hi:[0,1]
    v_pk_add_f32 v[36:37], v[36:37], v[144:145] neg_lo:[0,1] neg_hi:[0,1]
    v_pk_add_f32 v[38:39], v[38:39], v[146:147] neg_lo:[0,1] neg_hi:[0,1]
    v_pk_add_f32 v[40:41], v[40:41], v[148:149] neg_lo:[0,1] neg_hi:[0,1]
    v_pk_add_f32 v[42:43], v[42:43], v[150:151] neg_lo:[0,1] neg_hi:[0,1]
    v_pk_add_f32 v[44:45], v[44:45], v[152:153] neg_lo:[0,1] neg_hi:[0,1]
    v_pk_add_f32 v[46:47], v[46:47], v[154:155] neg_lo:[0,1] neg_hi:[0,1]
    v_pk_add_f32 v[48:49], v[48:49], v[52:53]
    v_pk_add_f32 v[50:51], v[50:51], v[54:55]
    v_pk_add_f32 v[48:49], v[48:49], v[50:51]
    s_add_u32 s49, s49, 1
    v_cmp_u_f32 vcc, v48, v49
    v_pk_fma_f32 v[32:33], v[32:33], v[136:137], v[140:141] op_sel:[0,0,0] op_sel_hi:[1,0,1]
    v_pk_fma_f32 v[34:35], v[34:35], v[136:137], v[142:143] op_sel:[0,0,0] op_sel_hi:[1,0,1]
    v_pk_fma_f32 v[36:37], v[36:37], v[136:137], v[144:145] op_sel:[0,0,0] op_sel_hi:[1,0,1]
    v_pk_fma_f32 v[38:39], v[38:39], v[136:137], v[146:147] op_sel:[0,0,0] op_sel_hi:[1,0,1]
    v_pk_fma_f32 v[40:41], v[40:41], v[136:137], v[148:149] op_sel:[0,0,0] op_sel_hi:[1,0,1]
    v_pk_fma_f32 v[42:43], v[42:43], v[136:137], v[150:151] op_sel:[0,0,0] op_sel_hi:[1,0,1]
    v_pk_fma_f32 v[44:45], v[44:45], v[136:137], v[152:153] op_sel:[0,0,0] op_sel_hi:[1,0,1]
    v_pk_fma_f32 v[46:47], v[46:47], v[136:137], v[154:155] op_sel:[0,0,0] op_sel_hi:[1,0,1]
    s_cmp_gt_u32 s49, 5000
    s_cbranch_scc1 g_done
    s_cmp_lg_u64 vcc, 0
    s_cbranch_scc1 g_loop
g_done:
    v_cvt_pk_bf16_f32 v48, v32, v33
    v_cvt_pk_bf16_f32 v49, v34, v35
    v_cvt_pk_bf16_f32 v52, v36, v37
    v_cvt_pk_bf16_f32 v53, v38, v39
    v_cvt_pk_bf16_f32 v50, v40, v41
    v_cvt_pk_bf16_f32 v51, v42, v43
    v_cvt_pk_bf16_f32 v54, v44, v45
    v_cvt_pk_bf16_f32 v55, v46, v47
    s_nop 1
    v_permlane16_swap_b32 v48, v50
    v_permlane16_swap_b32 v49, v51
    v_permlane16_swap_b32 v52, v54
    v_permlane16_swap_b32 v53, v55
    s_nop 1
    buffer_store_dwordx4 v[48:51], v137, s[16:19], s34 offen offset:0
    buffer_store_dwordx4 v[52:55], v137, s[16:19], s34 offen offset:16
gated_mix__compressed_kv_cla__moe_arch_mod__prompt_kernel_end:
    s_endpgm
att_redo:
    s_waitcnt vmcnt(0) lgkmcnt(0)
    s_barrier
    s_mov_b32 s77, 1
    s_mov_b32 s52, 0
    s_lshl_b32 s82, s4, 20
redo_loop0:
    s_add_u32 s83, s82, 0x1000
    buffer_load_dwordx4 a[64:67], v2, s[28:31], s82 offen offset:0 sc1
    buffer_load_dwordx4 a[68:71], v2, s[28:31], s82 offen offset:1024 sc1
    buffer_load_dwordx4 a[72:75], v2, s[28:31], s82 offen offset:2048 sc1
    buffer_load_dwordx4 a[76:79], v2, s[28:31], s82 offen offset:3072 sc1
    buffer_load_dwordx4 a[80:83], v2, s[28:31], s83 offen offset:0 sc1
    buffer_load_dwordx4 a[84:87], v2, s[28:31], s83 offen offset:1024 sc1
    buffer_load_dwordx4 a[88:91], v2, s[28:31], s83 offen offset:2048 sc1
    buffer_load_dwordx4 a[92:95], v2, s[28:31], s83 offen offset:3072 sc1
    s_waitcnt vmcnt(0)
    v_mfma_f32_16x16x32_bf16 v[16:19], a[64:67], a[0:3], 0
    v_mfma_f32_16x16x32_bf16 v[20:23], a[68:71], a[0:3], 0
    v_mfma_f32_16x16x32_bf16 v[24:27], a[64:67], a[8:11], 0
    v_mfma_f32_16x16x32_bf16 v[28:31], a[68:71], a[8:11], 0
    v_mfma_f32_16x16x32_bf16 v[16:19], a[72:75], a[4:7], v[16:19]
    v_mfma_f32_16x16x32_bf16 v[20:23], a[76:79], a[4:7], v[20:23]
    v_mfma_f32_16x16x32_bf16 v[24:27], a[72:75], a[12:15], v[24:27]
    v_mfma_f32_16x16x32_bf16 v[28:31], a[76:79], a[12:15], v[28:31]
    v_mfma_f32_16x16x32_bf16 v[16:19], a[80:83], a[32:35], v[16:19]
    v_mfma_f32_16x16x32_bf16 v[20:23], a[84:87], a[32:35], v[20:23]
    v_mfma_f32_16x16x32_bf16 v[24:27], a[80:83], a[40:43], v[24:27]
    v_mfma_f32_16x16x32_bf16 v[28:31], a[84:87], a[40:43], v[28:31]
    v_mfma_f32_16x16x32_bf16 v[16:19], a[88:91], a[36:39], v[16:19]
    v_mfma_f32_16x16x32_bf16 v[20:23], a[92:95], a[36:39], v[20:23]
    v_mfma_f32_16x16x32_bf16 v[24:27], a[88:91], a[44:47], v[24:27]
    v_mfma_f32_16x16x32_bf16 v[28:31], a[92:95], a[44:47], v[28:31]
    s_nop 7
    s_cmp_lg_u32 s52, s6
    s_cbranch_scc1 redo_nm0
    v_cndmask_b32 v16, v16, v6, s[64:65]
    v_cndmask_b32 v17, v17, v6, s[66:67]
    v_cndmask_b32 v18, v18, v6, s[68:69]
    v_cndmask_b32 v19, v19, v6, s[70:71]
    v_mov_b32 v20, v6
    v_mov_b32 v21, v6
    v_mov_b32 v22, v6
    v_mov_b32 v23, v6
    v_cndmask_b32 v28, v28, v6, s[64:65]
    v_cndmask_b32 v29, v29, v6, s[66:67]
    v_cndmask_b32 v30, v30, v6, s[68:69]
    v_cndmask_b32 v31, v31, v6, s[70:71]
redo_nm0:
    v_max3_f32 v8, v8, v16, v17
    v_max3_f32 v8, v8, v18, v19
    v_max3_f32 v8, v8, v20, v21
    v_max3_f32 v8, v8, v22, v23
    v_max3_f32 v9, v9, v24, v25
    v_max3_f32 v9, v9, v26, v27
    v_max3_f32 v9, v9, v28, v29
    v_max3_f32 v9, v9, v30, v31
    s_add_u32 s82, s82, 0x4000
    s_add_u32 s52, s52, 1
    s_cmp_le_u32 s52, s6
    s_cbranch_scc1 redo_loop0
    s_mov_b32 s52, 0
    s_lshl_b32 s82, s4, 20
redo_loop1:
    s_add_u32 s83, s82, 0x1000
    buffer_load_dwordx4 a[64:67], v2, s[28:31], s82 offen offset:0 sc1
    buffer_load_dwordx4 a[68:71], v2, s[28:31], s82 offen offset:1024 sc1
    buffer_load_dwordx4 a[72:75], v2, s[28:31], s82 offen offset:2048 sc1
    buffer_load_dwordx4 a[76:79], v2, s[28:31], s82 offen offset:3072 sc1
    buffer_load_dwordx4 a[80:83], v2, s[28:31], s83 offen offset:0 sc1
    buffer_load_dwordx4 a[84:87], v2, s[28:31], s83 offen offset:1024 sc1
    buffer_load_dwordx4 a[88:91], v2, s[28:31], s83 offen offset:2048 sc1
    buffer_load_dwordx4 a[92:95], v2, s[28:31], s83 offen offset:3072 sc1
    s_waitcnt vmcnt(0)
    v_mfma_f32_16x16x32_bf16 v[16:19], a[64:67], a[16:19], 0
    v_mfma_f32_16x16x32_bf16 v[20:23], a[68:71], a[16:19], 0
    v_mfma_f32_16x16x32_bf16 v[24:27], a[64:67], a[24:27], 0
    v_mfma_f32_16x16x32_bf16 v[28:31], a[68:71], a[24:27], 0
    v_mfma_f32_16x16x32_bf16 v[16:19], a[72:75], a[20:23], v[16:19]
    v_mfma_f32_16x16x32_bf16 v[20:23], a[76:79], a[20:23], v[20:23]
    v_mfma_f32_16x16x32_bf16 v[24:27], a[72:75], a[28:31], v[24:27]
    v_mfma_f32_16x16x32_bf16 v[28:31], a[76:79], a[28:31], v[28:31]
    v_mfma_f32_16x16x32_bf16 v[16:19], a[80:83], a[48:51], v[16:19]
    v_mfma_f32_16x16x32_bf16 v[20:23], a[84:87], a[48:51], v[20:23]
    v_mfma_f32_16x16x32_bf16 v[24:27], a[80:83], a[56:59], v[24:27]
    v_mfma_f32_16x16x32_bf16 v[28:31], a[84:87], a[56:59], v[28:31]
    v_mfma_f32_16x16x32_bf16 v[16:19], a[88:91], a[52:55], v[16:19]
    v_mfma_f32_16x16x32_bf16 v[20:23], a[92:95], a[52:55], v[20:23]
    v_mfma_f32_16x16x32_bf16 v[24:27], a[88:91], a[60:63], v[24:27]
    v_mfma_f32_16x16x32_bf16 v[28:31], a[92:95], a[60:63], v[28:31]
    s_nop 7
    s_cmp_lg_u32 s52, s7
    s_cbranch_scc1 redo_nm1
    v_cndmask_b32 v16, v16, v6, s[64:65]
    v_cndmask_b32 v17, v17, v6, s[66:67]
    v_cndmask_b32 v18, v18, v6, s[68:69]
    v_cndmask_b32 v19, v19, v6, s[70:71]
    v_mov_b32 v20, v6
    v_mov_b32 v21, v6
    v_mov_b32 v22, v6
    v_mov_b32 v23, v6
    v_cndmask_b32 v28, v28, v6, s[64:65]
    v_cndmask_b32 v29, v29, v6, s[66:67]
    v_cndmask_b32 v30, v30, v6, s[68:69]
    v_cndmask_b32 v31, v31, v6, s[70:71]
redo_nm1:
    v_max3_f32 v10, v10, v16, v17
    v_max3_f32 v10, v10, v18, v19
    v_max3_f32 v10, v10, v20, v21
    v_max3_f32 v10, v10, v22, v23
    v_max3_f32 v11, v11, v24, v25
    v_max3_f32 v11, v11, v26, v27
    v_max3_f32 v11, v11, v28, v29
    v_max3_f32 v11, v11, v30, v31
    s_add_u32 s82, s82, 0x4000
    s_add_u32 s52, s52, 1
    s_cmp_le_u32 s52, s7
    s_cbranch_scc1 redo_loop1
    s_mov_b64 s[72:73], 0
    s_mov_b32 s78, 0
    s_mov_b32 s52, -1
    s_mov_b32 s54, 0x8000
    s_movk_i32 s76, 0x1000
    v_mov_b32 v100, 0x7f000000
    s_mov_b32 s48, 0
    s_add_u32 s52, s52, 1
    v_readlane_b32 s81, v5, s52
    s_add_u32 s54, s54, 0x8000
    s_and_b32 s54, s54, 0x1ffff
    s_add_u32 m0, s54, s55
    v_add_u32 v4, s81, v2
    buffer_load_dwordx4 v4, s[28:31], 0 offen offset:0 sc1 lds
    s_cmp_eq_u32 s5, 7
    s_cselect_b32 s44, 0x2000, 0
    s_sub_u32 s44, s80, s44
    v_mov_b32 v96, -1
    v_mov_b32 v97, -1
    buffer_load_dwordx4 v4, s[28:31], 0 offen offset:1024 sc1 lds
    v_mov_b32 v98, -1
    v_mov_b32 v99, -1
    v_accvgpr_write_b32 a96, 0
    buffer_load_dwordx4 v4, s[28:31], 0 offen offset:2048 sc1 lds
    v_accvgpr_write_b32 a97, 0
    v_accvgpr_write_b32 a98, 0
    v_accvgpr_write_b32 a99, 0
    buffer_load_dwordx4 v4, s[28:31], 0 offen offset:3072 sc1 lds
    v_accvgpr_write_b32 a100, 0
    v_accvgpr_write_b32 a101, 0
    v_accvgpr_write_b32 a102, 0
    s_add_u32 m0, m0, 0x1000
    v_accvgpr_write_b32 a103, 0
    buffer_load_dwordx4 v4, s[28:31], s76 offen offset:0 sc1 lds
    v_accvgpr_write_b32 a104, 0
    v_accvgpr_write_b32 a105, 0
    v_accvgpr_write_b32 a106, 0
    buffer_load_dwordx4 v4, s[28:31], s76 offen offset:1024 sc1 lds
    v_accvgpr_write_b32 a107, 0
    v_accvgpr_write_b32 a108, 0
    v_accvgpr_write_b32 a109, 0
    buffer_load_dwordx4 v4, s[28:31], s76 offen offset:2048 sc1 lds
    v_accvgpr_write_b32 a110, 0
    v_accvgpr_write_b32 a111, 0
    v_accvgpr_write_b32 a112, 0
    buffer_load_dwordx4 v4, s[28:31], s76 offen offset:3072 sc1 lds
    v_accvgpr_write_b32 a113, 0
    v_accvgpr_write_b32 a114, 0
    v_accvgpr_write_b32 a115, 0
    s_add_u32 s52, s52, 1
    v_readlane_b32 s81, v5, s52
    s_add_u32 s54, s54, 0x8000
    s_and_b32 s54, s54, 0x1ffff
    s_add_u32 m0, s54, s55
    v_add_u32 v4, s81, v2
    buffer_load_dwordx4 v4, s[28:31], 0 offen offset:0 sc1 lds
    v_accvgpr_write_b32 a116, 0
    v_accvgpr_write_b32 a117, 0
    v_accvgpr_write_b32 a118, 0
    buffer_load_dwordx4 v4, s[28:31], 0 offen offset:1024 sc1 lds
    v_accvgpr_write_b32 a119, 0
    v_accvgpr_write_b32 a120, 0
    v_accvgpr_write_b32 a121, 0
    buffer_load_dwordx4 v4, s[28:31], 0 offen offset:2048 sc1 lds
    v_accvgpr_write_b32 a122, 0
    v_accvgpr_write_b32 a123, 0
    v_accvgpr_write_b32 a124, 0
    buffer_load_dwordx4 v4, s[28:31], 0 offen offset:3072 sc1 lds
    v_accvgpr_write_b32 a125, 0
    v_accvgpr_write_b32 a126, 0
    v_accvgpr_write_b32 a127, 0
    s_add_u32 m0, m0, 0x1000
    v_accvgpr_write_b32 a128, 0
    buffer_load_dwordx4 v4, s[28:31], s76 offen offset:0 sc1 lds
    v_accvgpr_write_b32 a129, 0
    v_accvgpr_write_b32 a130, 0
    v_accvgpr_write_b32 a131, 0
    buffer_load_dwordx4 v4, s[28:31], s76 offen offset:1024 sc1 lds
    v_accvgpr_write_b32 a132, 0
    v_accvgpr_write_b32 a133, 0
    v_accvgpr_write_b32 a134, 0
    buffer_load_dwordx4 v4, s[28:31], s76 offen offset:2048 sc1 lds
    v_accvgpr_write_b32 a135, 0
    v_accvgpr_write_b32 a136, 0
    v_accvgpr_write_b32 a137, 0
    buffer_load_dwordx4 v4, s[28:31], s76 offen offset:3072 sc1 lds
    v_accvgpr_write_b32 a138, 0
    v_accvgpr_write_b32 a139, 0
    v_accvgpr_write_b32 a140, 0
    s_add_u32 s52, s52, 1
    v_readlane_b32 s81, v5, s52
    s_add_u32 s54, s54, 0x8000
    s_and_b32 s54, s54, 0x1ffff
    s_add_u32 m0, s54, s55
    v_add_u32 v4, s81, v2
    buffer_load_dwordx4 v4, s[28:31], 0 offen offset:0 sc1 lds
    v_accvgpr_write_b32 a141, 0
    v_accvgpr_write_b32 a142, 0
    v_accvgpr_write_b32 a143, 0
    buffer_load_dwordx4 v4, s[28:31], 0 offen offset:1024 sc1 lds
    v_mov_b32 v128, 0
    v_mov_b32 v129, 0
    v_mov_b32 v130, 0
    buffer_load_dwordx4 v4, s[28:31], 0 offen offset:2048 sc1 lds
    v_mov_b32 v131, 0
    v_mov_b32 v132, 0
    v_mov_b32 v133, 0
    buffer_load_dwordx4 v4, s[28:31], 0 offen offset:3072 sc1 lds
    v_mov_b32 v134, 0
    v_mov_b32 v135, 0
    v_mov_b32 v136, 0
    s_add_u32 m0, m0, 0x1000
    v_mov_b32 v137, 0
    buffer_load_dwordx4 v4, s[28:31], s76 offen offset:0 sc1 lds
    v_mov_b32 v138, 0
    v_mov_b32 v139, 0
    v_mov_b32 v140, 0
    buffer_load_dwordx4 v4, s[28:31], s76 offen offset:1024 sc1 lds
    v_mov_b32 v141, 0
    v_mov_b32 v142, 0
    v_mov_b32 v143, 0
    buffer_load_dwordx4 v4, s[28:31], s76 offen offset:2048 sc1 lds
    v_mov_b32 v144, 0
    v_mov_b32 v145, 0
    v_mov_b32 v146, 0
    buffer_load_dwordx4 v4, s[28:31], s76 offen offset:3072 sc1 lds
    v_mov_b32 v147, 0
    v_mov_b32 v148, 0
    v_mov_b32 v149, 0
    v_mov_b32 v150, 0
    v_mov_b32 v151, 0
    v_mov_b32 v152, 0
    v_mov_b32 v153, 0
    v_mov_b32 v154, 0
    v_mov_b32 v155, 0
    v_mov_b32 v156, 0
    v_mov_b32 v157, 0
    v_mov_b32 v158, 0
    v_mov_b32 v159, 0
    v_mov_b32 v160, 0
    v_mov_b32 v161, 0
    v_mov_b32 v162, 0
    v_mov_b32 v163, 0
    v_mov_b32 v164, 0
    v_mov_b32 v165, 0
    v_mov_b32 v166, 0
    v_mov_b32 v167, 0
    v_mov_b32 v168, 0
    v_mov_b32 v169, 0
    v_mov_b32 v170, 0
    v_mov_b32 v171, 0
    v_mov_b32 v172, 0
    v_mov_b32 v173, 0
    v_mov_b32 v174, 0
    v_mov_b32 v175, 0
    v_mov_b32 v176, 0
    v_mov_b32 v177, 0
    v_mov_b32 v178, 0
    v_mov_b32 v179, 0
    v_mov_b32 v180, 0
    v_mov_b32 v181, 0
    v_mov_b32 v182, 0
    v_mov_b32 v183, 0
    v_mov_b32 v184, 0
    v_mov_b32 v185, 0
    v_mov_b32 v186, 0
    v_mov_b32 v187, 0
    v_mov_b32 v188, 0
    v_mov_b32 v189, 0
    v_mov_b32 v190, 0
    v_mov_b32 v191, 0
    v_mov_b32 v192, 0
    v_mov_b32 v193, 0
    v_mov_b32 v194, 0
    v_mov_b32 v195, 0
    v_mov_b32 v196, 0
    v_mov_b32 v197, 0
    v_mov_b32 v198, 0
    v_mov_b32 v199, 0
    v_mov_b32 v200, 0
    v_mov_b32 v201, 0
    v_mov_b32 v202, 0
    v_mov_b32 v203, 0
    v_mov_b32 v204, 0
    v_mov_b32 v205, 0
    v_mov_b32 v206, 0
    v_mov_b32 v207, 0
    v_mov_b32 v208, 0
    v_mov_b32 v209, 0
    v_mov_b32 v210, 0
    v_mov_b32 v211, 0
    v_mov_b32 v212, 0
    v_mov_b32 v213, 0
    v_mov_b32 v214, 0
    v_mov_b32 v215, 0
    v_mov_b32 v216, 0
    v_mov_b32 v217, 0
    v_mov_b32 v218, 0
    v_mov_b32 v219, 0
    v_mov_b32 v220, 0
    v_mov_b32 v221, 0
    v_mov_b32 v222, 0
    v_mov_b32 v223, 0
    v_mov_b32 v224, 0
    v_mov_b32 v225, 0
    v_mov_b32 v226, 0
    v_mov_b32 v227, 0
    v_mov_b32 v228, 0
    v_mov_b32 v229, 0
    v_mov_b32 v230, 0
    v_mov_b32 v231, 0
    v_mov_b32 v232, 0
    v_mov_b32 v233, 0
    v_mov_b32 v234, 0
    v_mov_b32 v235, 0
    v_mov_b32 v236, 0
    v_mov_b32 v237, 0
    v_mov_b32 v238, 0
    v_mov_b32 v239, 0
    v_mov_b32 v240, 0
    v_mov_b32 v241, 0
    v_mov_b32 v242, 0
    v_mov_b32 v243, 0
    v_mov_b32 v244, 0
    v_mov_b32 v245, 0
    v_mov_b32 v246, 0
    v_mov_b32 v247, 0
    v_mov_b32 v248, 0
    v_mov_b32 v249, 0
    v_mov_b32 v250, 0
    v_mov_b32 v251, 0
    v_mov_b32 v252, 0
    v_mov_b32 v253, 0
    v_mov_b32 v254, 0
    v_mov_b32 v255, 0
    v_mov_b32 v56, 0
    v_mov_b32 v57, 0
    v_mov_b32 v58, 0
    v_mov_b32 v59, 0
    v_mov_b32 v60, 0
    v_mov_b32 v61, 0
    v_mov_b32 v62, 0
    v_mov_b32 v63, 0
    s_branch att_w0
init_spin:
    s_mov_b32 s49, 0
init_spin_l:
    s_sleep 2
    buffer_load_dword v18, v19, s[60:63], 0 offen sc1
    s_add_u32 s49, s49, 1
    s_waitcnt vmcnt(0)
    v_cmp_eq_u32 vcc, 0, v18
    s_cmp_gt_u32 s49, 20000
    s_cbranch_scc1 init_spin_x
    s_cmp_lg_u64 vcc, 0
    s_cbranch_scc1 init_spin_l
init_spin_x:
    s_branch init_spin_ok
kv_spin:
    s_mov_b32 s49, 0
kv_spin_l:
    s_sleep 2
    buffer_load_dword v21, v20, s[28:31], s44 offen sc1
    s_add_u32 s49, s49, 1
    s_waitcnt vmcnt(0)
    v_cmp_eq_u32 vcc, 0, v21
    s_cmp_gt_u32 s49, 20000
    s_cbranch_scc1 kv_spin_x
    s_cmp_lg_u64 vcc, 0
    s_cbranch_scc1 kv_spin_l
kv_spin_x:
    s_branch kv_spin_ok
key_spin:
    s_mov_b32 s49, 0
key_spin_l:
    s_sleep 2
    s_mov_b32 s50, 0x3402000
    buffer_load_dwordx4 v[32:35], v2, s[28:31], s50 offen offset:0 sc1
    buffer_load_dwordx4 v[36:39], v2, s[28:31], s50 offen offset:1024 sc1
    buffer_load_dwordx4 v[40:43], v2, s[28:31], s50 offen offset:2048 sc1
    buffer_load_dwordx4 v[44:47], v2, s[28:31], s50 offen offset:3072 sc1
    s_mov_b32 s50, 0x3403000
    buffer_load_dwordx4 v[48:51], v2, s[28:31], s50 offen offset:0 sc1
    buffer_load_dwordx4 v[52:55], v2, s[28:31], s50 offen offset:1024 sc1
    buffer_load_dwordx4 v[56:59], v2, s[28:31], s50 offen offset:2048 sc1
    buffer_load_dwordx4 v[60:63], v2, s[28:31], s50 offen offset:3072 sc1
    s_add_u32 s49, s49, 1
    s_waitcnt vmcnt(0)
    v_min3_u32 v20, v32, v33, v34
    v_min3_u32 v20, v20, v35, v36
    v_min3_u32 v20, v20, v37, v38
    v_min3_u32 v20, v20, v39, v40
    v_min3_u32 v20, v20, v41, v42
    v_min3_u32 v20, v20, v43, v44
    v_min3_u32 v20, v20, v45, v46
    v_min3_u32 v20, v20, v47, v48
    v_min3_u32 v20, v20, v49, v50
    v_min3_u32 v20, v20, v51, v52
    v_min3_u32 v20, v20, v53, v54
    v_min3_u32 v20, v20, v55, v56
    v_min3_u32 v20, v20, v57, v58
    v_min3_u32 v20, v20, v59, v60
    v_min3_u32 v20, v20, v61, v62
    v_min_u32 v20, v20, v63
    v_cmp_eq_u32 vcc, 0, v20
    s_cmp_gt_u32 s49, 20000
    s_cbranch_scc1 key_spin_x
    s_cmp_lg_u64 vcc, 0
    s_cbranch_scc1 key_spin_l
key_spin_x:
    s_branch key_spin_ok
s_slow:
    s_cmp_eq_u32 s5, 7
    s_cselect_b32 s48, 7, 3
    v_and_b32 v92, s48, v14
    v_cmp_eq_u32 vcc, 0, v92
    s_nop 0
    s_and_b32 vcc_lo, vcc_lo, s35
    s_mov_b32 vcc_hi, 0
    s_cmp_eq_u64 vcc, 0
    s_cbranch_scc1 s_slow_x
    s_mov_b32 s49, 0
s_slow_l:
    s_sleep 2
    buffer_load_dword v14, v15, s[28:31], s27 offen sc1
    s_add_u32 s49, s49, 1
    s_waitcnt vmcnt(0)
    s_cmp_eq_u32 s5, 7
    s_cselect_b32 s48, 7, 3
    v_and_b32 v92, s48, v14
    v_cmp_eq_u32 vcc, 0, v92
    s_nop 0
    s_and_b32 vcc_lo, vcc_lo, s35
    s_mov_b32 vcc_hi, 0
    s_cmp_gt_u32 s49, 20000
    s_cbranch_scc1 s_slow_x
    s_cmp_lg_u64 vcc, 0
    s_cbranch_scc1 s_slow_l
s_slow_x:
    s_branch s_slow2
s_slow2:
    s_mov_b32 s49, 0
s_slow2_l:
    s_sleep 2
    buffer_load_dwordx4 a[160:163], v2, s[28:31], s20 offen offset:0 sc1
    buffer_load_dwordx4 a[164:167], v2, s[28:31], s20 offen offset:1024 sc1
    buffer_load_dwordx4 a[168:171], v2, s[28:31], s20 offen offset:2048 sc1
    buffer_load_dwordx4 a[172:175], v2, s[28:31], s20 offen offset:3072 sc1
    buffer_load_dwordx4 a[176:179], v12, s[28:31], s20 offen offset:0 sc1
    buffer_load_dwordx4 a[180:183], v12, s[28:31], s20 offen offset:1024 sc1
    buffer_load_dwordx4 a[184:187], v12, s[28:31], s20 offen offset:2048 sc1
    buffer_load_dwordx4 a[188:191], v12, s[28:31], s20 offen offset:3072 sc1
    buffer_load_dwordx4 a[192:195], v2, s[28:31], s21 offen offset:0 sc1
    buffer_load_dwordx4 a[196:199], v2, s[28:31], s21 offen offset:1024 sc1
    buffer_load_dwordx4 a[200:203], v2, s[28:31], s21 offen offset:2048 sc1
    buffer_load_dwordx4 a[204:207], v2, s[28:31], s21 offen offset:3072 sc1
    buffer_load_dwordx4 a[208:211], v12, s[28:31], s21 offen offset:0 sc1
    buffer_load_dwordx4 a[212:215], v12, s[28:31], s21 offen offset:1024 sc1
    buffer_load_dwordx4 a[216:219], v12, s[28:31], s21 offen offset:2048 sc1
    buffer_load_dwordx4 a[220:223], v12, s[28:31], s21 offen offset:3072 sc1
    buffer_load_dwordx4 a[224:227], v2, s[28:31], s22 offen offset:0 sc1
    buffer_load_dwordx4 a[228:231], v2, s[28:31], s22 offen offset:1024 sc1
    buffer_load_dwordx4 a[232:235], v2, s[28:31], s22 offen offset:2048 sc1
    buffer_load_dwordx4 a[236:239], v2, s[28:31], s22 offen offset:3072 sc1
    buffer_load_dwordx4 a[240:243], v12, s[28:31], s22 offen offset:0 sc1
    buffer_load_dwordx4 a[244:247], v12, s[28:31], s22 offen offset:1024 sc1
    buffer_load_dwordx4 a[248:251], v12, s[28:31], s22 offen offset:2048 sc1
    buffer_load_dwordx4 a[252:255], v12, s[28:31], s22 offen offset:3072 sc1
    s_add_u32 s49, s49, 1
    s_waitcnt vmcnt(0)
    v_mfma_f32_16x16x32_bf16 v[92:95], a[160:163], a[164:167], 0
    v_mfma_f32_16x16x32_bf16 v[92:95], a[168:171], a[172:175], v[92:95]
    v_mfma_f32_16x16x32_bf16 v[92:95], a[176:179], a[180:183], v[92:95]
    v_mfma_f32_16x16x32_bf16 v[92:95], a[184:187], a[188:191], v[92:95]
    v_mfma_f32_16x16x32_bf16 v[92:95], a[192:195], a[196:199], v[92:95]
    v_mfma_f32_16x16x32_bf16 v[92:95], a[200:203], a[204:207], v[92:95]
    v_mfma_f32_16x16x32_bf16 v[92:95], a[208:211], a[212:215], v[92:95]
    v_mfma_f32_16x16x32_bf16 v[92:95], a[216:219], a[220:223], v[92:95]
    v_mfma_f32_16x16x32_bf16 v[92:95], a[224:227], a[228:231], v[92:95]
    v_mfma_f32_16x16x32_bf16 v[92:95], a[232:235], a[236:239], v[92:95]
    v_mfma_f32_16x16x32_bf16 v[92:95], a[240:243], a[244:247], v[92:95]
    v_mfma_f32_16x16x32_bf16 v[92:95], a[248:251], a[252:255], v[92:95]
    s_nop 7
    v_add_f32 v92, |v92|, |v93|
    v_add_f32 v94, |v94|, |v95|
    v_add_f32 v92, v92, v94
    v_cmp_ngt_f32 vcc, -v6, v92
    s_nop 0
    s_cmp_gt_u32 s49, 20000
    s_cbranch_scc1 s_slow2_x
    s_cmp_lg_u64 vcc, 0
    s_cbranch_scc1 s_slow2_l
s_slow2_x:
    s_branch s_slow_ok
l_spin1:
    s_mov_b32 s49, 0
l_spin1_l:
    s_sleep 2
    buffer_load_dwordx4 a[96:99], v2, s[28:31], s23 offen offset:0 sc1
    buffer_load_dwordx4 a[100:103], v2, s[28:31], s23 offen offset:1024 sc1
    buffer_load_dwordx4 a[104:107], v2, s[28:31], s23 offen offset:2048 sc1
    buffer_load_dwordx4 a[108:111], v2, s[28:31], s23 offen offset:3072 sc1
    buffer_load_dwordx4 a[112:115], v12, s[28:31], s23 offen offset:0 sc1
    buffer_load_dwordx4 a[116:119], v12, s[28:31], s23 offen offset:1024 sc1
    buffer_load_dwordx4 a[120:123], v12, s[28:31], s23 offen offset:2048 sc1
    buffer_load_dwordx4 a[124:127], v12, s[28:31], s23 offen offset:3072 sc1
    s_add_u32 s49, s49, 1
    s_waitcnt vmcnt(0)
    v_mfma_f32_16x16x32_bf16 v[92:95], a[96:99], a[100:103], 0
    v_mfma_f32_16x16x32_bf16 v[92:95], a[104:107], a[108:111], v[92:95]
    v_mfma_f32_16x16x32_bf16 v[92:95], a[112:115], a[116:119], v[92:95]
    v_mfma_f32_16x16x32_bf16 v[92:95], a[120:123], a[124:127], v[92:95]
    s_nop 7
    v_add_f32 v92, |v92|, |v93|
    v_add_f32 v94, |v94|, |v95|
    v_add_f32 v92, v92, v94
    v_cmp_ngt_f32 vcc, -v6, v92
    s_nop 0
    s_cmp_gt_u32 s49, 20000
    s_cbranch_scc1 l_spin1_x
    s_cmp_lg_u64 vcc, 0
    s_cbranch_scc1 l_spin1_l
l_spin1_x:
    s_branch l_spin1_ok
l_spin2:
    s_mov_b32 s49, 0
l_spin2_l:
    s_sleep 2
    buffer_load_dwordx4 a[128:131], v2, s[28:31], s24 offen offset:0 sc1
    buffer_load_dwordx4 a[132:135], v2, s[28:31], s24 offen offset:1024 sc1
    buffer_load_dwordx4 a[136:139], v2, s[28:31], s24 offen offset:2048 sc1
    buffer_load_dwordx4 a[140:143], v2, s[28:31], s24 offen offset:3072 sc1
    buffer_load_dwordx4 a[144:147], v12, s[28:31], s24 offen offset:0 sc1
    buffer_load_dwordx4 a[148:151], v12, s[28:31], s24 offen offset:1024 sc1
    buffer_load_dwordx4 a[152:155], v12, s[28:31], s24 offen offset:2048 sc1
    buffer_load_dwordx4 a[156:159], v12, s[28:31], s24 offen offset:3072 sc1
    s_add_u32 s49, s49, 1
    s_waitcnt vmcnt(0)
    v_mfma_f32_16x16x32_bf16 v[92:95], a[128:131], a[132:135], 0
    v_mfma_f32_16x16x32_bf16 v[92:95], a[136:139], a[140:143], v[92:95]
    v_mfma_f32_16x16x32_bf16 v[92:95], a[144:147], a[148:151], v[92:95]
    v_mfma_f32_16x16x32_bf16 v[92:95], a[152:155], a[156:159], v[92:95]
    s_nop 7
    v_add_f32 v92, |v92|, |v93|
    v_add_f32 v94, |v94|, |v95|
    v_add_f32 v92, v92, v94
    v_cmp_ngt_f32 vcc, -v6, v92
    s_nop 0
    s_cmp_gt_u32 s49, 20000
    s_cbranch_scc1 l_spin2_x
    s_cmp_lg_u64 vcc, 0
    s_cbranch_scc1 l_spin2_l
l_spin2_x:
    s_branch l_spin2_ok
l_spin3:
    s_mov_b32 s49, 0
l_spin3_l:
    s_sleep 2
    buffer_load_dwordx4 a[0:3], v2, s[28:31], s25 offen offset:0 sc1
    buffer_load_dwordx4 a[4:7], v2, s[28:31], s25 offen offset:1024 sc1
    buffer_load_dwordx4 a[8:11], v2, s[28:31], s25 offen offset:2048 sc1
    buffer_load_dwordx4 a[12:15], v2, s[28:31], s25 offen offset:3072 sc1
    buffer_load_dwordx4 a[16:19], v12, s[28:31], s25 offen offset:0 sc1
    buffer_load_dwordx4 a[20:23], v12, s[28:31], s25 offen offset:1024 sc1
    buffer_load_dwordx4 a[24:27], v12, s[28:31], s25 offen offset:2048 sc1
    buffer_load_dwordx4 a[28:31], v12, s[28:31], s25 offen offset:3072 sc1
    s_add_u32 s49, s49, 1
    s_waitcnt vmcnt(0)
    v_mfma_f32_16x16x32_bf16 v[92:95], a[0:3], a[4:7], 0
    v_mfma_f32_16x16x32_bf16 v[92:95], a[8:11], a[12:15], v[92:95]
    v_mfma_f32_16x16x32_bf16 v[92:95], a[16:19], a[20:23], v[92:95]
    v_mfma_f32_16x16x32_bf16 v[92:95], a[24:27], a[28:31], v[92:95]
    s_nop 7
    v_add_f32 v92, |v92|, |v93|
    v_add_f32 v94, |v94|, |v95|
    v_add_f32 v92, v92, v94
    v_cmp_ngt_f32 vcc, -v6, v92
    s_nop 0
    s_cmp_gt_u32 s49, 20000
    s_cbranch_scc1 l_spin3_x
    s_cmp_lg_u64 vcc, 0
    s_cbranch_scc1 l_spin3_l
l_spin3_x:
    s_branch l_spin3_ok
h_spin:
    s_mov_b32 s49, 0
h_spin_l:
    s_sleep 2
    buffer_load_dwordx2 v[128:129], v91, s[28:31], s50 offen offset:0 sc1
    buffer_load_dwordx2 v[130:131], v91, s[28:31], s50 offen offset:32 sc1
    s_add_u32 s49, s49, 1
    s_waitcnt vmcnt(0)
    v_min3_u32 v88, v128, v129, v130
    v_min_u32 v88, v88, v131
    v_cmp_eq_u32 vcc, 0, v88
    s_cmp_gt_u32 s49, 20000
    s_cbranch_scc1 h_spin_x
    s_cmp_lg_u64 vcc, 0
    s_cbranch_scc1 h_spin_l
h_spin_x:
    s_branch h_spin_ok
y_spin:
    s_mov_b32 s49, 0
y_spin_l:
    s_sleep 2
    s_add_u32 s82, s51, 0
    buffer_load_dwordx4 v[16:19], v139, s[28:31], s82 offen offset:0 sc1
    buffer_load_dwordx4 v[20:23], v139, s[28:31], s82 offen offset:32 sc1
    buffer_load_dwordx4 v[24:27], v139, s[28:31], s82 offen offset:64 sc1
    buffer_load_dwordx4 v[28:31], v139, s[28:31], s82 offen offset:96 sc1
    s_add_u32 s82, s51, 4096
    buffer_load_dwordx4 v[32:35], v139, s[28:31], s82 offen offset:0 sc1
    buffer_load_dwordx4 v[36:39], v139, s[28:31], s82 offen offset:32 sc1
    buffer_load_dwordx4 v[40:43], v139, s[28:31], s82 offen offset:64 sc1
    buffer_load_dwordx4 v[44:47], v139, s[28:31], s82 offen offset:96 sc1
    s_add_u32 s82, s51, 8192
    buffer_load_dwordx4 v[48:51], v139, s[28:31], s82 offen offset:0 sc1
    buffer_load_dwordx4 v[52:55], v139, s[28:31], s82 offen offset:32 sc1
    buffer_load_dwordx4 v[56:59], v139, s[28:31], s82 offen offset:64 sc1
    buffer_load_dwordx4 v[60:63], v139, s[28:31], s82 offen offset:96 sc1
    s_add_u32 s82, s51, 12288
    buffer_load_dwordx4 v[64:67], v139, s[28:31], s82 offen offset:0 sc1
    buffer_load_dwordx4 v[68:71], v139, s[28:31], s82 offen offset:32 sc1
    buffer_load_dwordx4 v[72:75], v139, s[28:31], s82 offen offset:64 sc1
    buffer_load_dwordx4 v[76:79], v139, s[28:31], s82 offen offset:96 sc1
    s_add_u32 s49, s49, 1
    s_waitcnt vmcnt(0)
    v_min3_u32 v88, v16, v17, v18
    v_min3_u32 v88, v88, v19, v20
    v_min3_u32 v88, v88, v21, v22
    v_min3_u32 v88, v88, v23, v24
    v_min3_u32 v88, v88, v25, v26
    v_min3_u32 v88, v88, v27, v28
    v_min3_u32 v88, v88, v29, v30
    v_min3_u32 v88, v88, v31, v32
    v_min3_u32 v88, v88, v33, v34
    v_min3_u32 v88, v88, v35, v36
    v_min3_u32 v88, v88, v37, v38
    v_min3_u32 v88, v88, v39, v40
    v_min3_u32 v88, v88, v41, v42
    v_min3_u32 v88, v88, v43, v44
    v_min3_u32 v88, v88, v45, v46
    v_min3_u32 v88, v88, v47, v48
    v_min3_u32 v88, v88, v49, v50
    v_min3_u32 v88, v88, v51, v52
    v_min3_u32 v88, v88, v53, v54
    v_min3_u32 v88, v88, v55, v56
    v_min3_u32 v88, v88, v57, v58
    v_min3_u32 v88, v88, v59, v60
    v_min3_u32 v88, v88, v61, v62
    v_min3_u32 v88, v88, v63, v64
    v_min3_u32 v88, v88, v65, v66
    v_min3_u32 v88, v88, v67, v68
    v_min3_u32 v88, v88, v69, v70
    v_min3_u32 v88, v88, v71, v72
    v_min3_u32 v88, v88, v73, v74
    v_min3_u32 v88, v88, v75, v76
    v_min3_u32 v88, v88, v77, v78
    v_min_u32 v88, v88, v79
    v_cndmask_b32 v88, 1, v88, s[46:47]
    v_cmp_eq_u32 vcc, 0, v88
    s_cmp_gt_u32 s49, 20000
    s_cbranch_scc1 y_spin_x
    s_cmp_lg_u64 vcc, 0
    s_cbranch_scc1 y_spin_l
y_spin_x:
    v_add_f32 v16, v16, v32
    v_add_f32 v17, v17, v33
    v_add_f32 v18, v18, v34
    v_add_f32 v19, v19, v35
    v_add_f32 v20, v20, v36
    v_add_f32 v21, v21, v37
    v_add_f32 v22, v22, v38
    v_add_f32 v23, v23, v39
    v_add_f32 v24, v24, v40
    v_add_f32 v25, v25, v41
    v_add_f32 v26, v26, v42
    v_add_f32 v27, v27, v43
    v_add_f32 v28, v28, v44
    v_add_f32 v29, v29, v45
    v_add_f32 v30, v30, v46
    v_add_f32 v31, v31, v47
    v_add_f32 v48, v48, v64
    v_add_f32 v49, v49, v65
    v_add_f32 v50, v50, v66
    v_add_f32 v51, v51, v67
    v_add_f32 v52, v52, v68
    v_add_f32 v53, v53, v69
    v_add_f32 v54, v54, v70
    v_add_f32 v55, v55, v71
    v_add_f32 v56, v56, v72
    v_add_f32 v57, v57, v73
    v_add_f32 v58, v58, v74
    v_add_f32 v59, v59, v75
    v_add_f32 v60, v60, v76
    v_add_f32 v61, v61, v77
    v_add_f32 v62, v62, v78
    v_add_f32 v63, v63, v79
    v_add_f32 v16, v16, v48
    v_add_f32 v17, v17, v49
    v_add_f32 v18, v18, v50
    v_add_f32 v19, v19, v51
    v_add_f32 v20, v20, v52
    v_add_f32 v21, v21, v53
    v_add_f32 v22, v22, v54
    v_add_f32 v23, v23, v55
    v_add_f32 v24, v24, v56
    v_add_f32 v25, v25, v57
    v_add_f32 v26, v26, v58
    v_add_f32 v27, v27, v59
    v_add_f32 v28, v28, v60
    v_add_f32 v29, v29, v61
    v_add_f32 v30, v30, v62
    v_add_f32 v31, v31, v63
    v_add_f32 v140, v140, v16
    v_add_f32 v141, v141, v17
    v_add_f32 v142, v142, v18
    v_add_f32 v143, v143, v19
    v_add_f32 v144, v144, v20
    v_add_f32 v145, v145, v21
    v_add_f32 v146, v146, v22
    v_add_f32 v147, v147, v23
    v_add_f32 v148, v148, v24
    v_add_f32 v149, v149, v25
    v_add_f32 v150, v150, v26
    v_add_f32 v151, v151, v27
    v_add_f32 v152, v152, v28
    v_add_f32 v153, v153, v29
    v_add_f32 v154, v154, v30
    v_add_f32 v155, v155, v31
    s_branch y_spin_ok
f_spin:
    s_mov_b32 s49, 0
f_spin_l:
    s_sleep 2
    buffer_load_dword v136, v138, s[28:31], s50 offen sc1
    buffer_load_dword v14, v15, s[28:31], s27 offen sc1
    s_add_u32 s49, s49, 1
    s_waitcnt vmcnt(0)
    v_and_b32 v14, 2, v14
    v_cndmask_b32 v14, 1, v14, s[72:73]
    v_min_u32 v88, v136, v14
    v_cmp_eq_u32 vcc, 0, v88
    s_cmp_gt_u32 s49, 20000
    s_cbranch_scc1 f_spin_x
    s_cmp_lg_u64 vcc, 0
    s_cbranch_scc1 f_spin_l
f_spin_x:
    s_branch f_spin_ok
.section .rodata,"a"
.p2align 6
.amdhsa_kernel gated_mix__compressed_kv_cla__moe_arch_mod__prompt_kernel
  .amdhsa_next_free_vgpr 512
  .amdhsa_next_free_sgpr 102
  .amdhsa_accum_offset 256
  .amdhsa_group_segment_fixed_size 0
  .amdhsa_kernarg_size 120
  .amdhsa_user_sgpr_count 2
  .amdhsa_user_sgpr_kernarg_segment_ptr 1
  .amdhsa_system_sgpr_workgroup_id_x 1
.end_amdhsa_kernel
```
